```python
import torch

def _softmax(x, axis=-1):
    return torch.softmax(x, dim=axis)
def _gelu(x):
    return torch.nn.functional.gelu(x, approximate="tanh")
def _silu(x):
    return torch.nn.functional.silu(x)
def _sigmoid(x):
    return torch.sigmoid(x)
def _layernorm(x, axis=-1, eps=1e-5):
    m = x.mean(dim=axis, keepdim=True)
    v = x.var(dim=axis, keepdim=True, unbiased=False)
    return (x - m) / torch.sqrt(v + eps)
def _scatter_add(tgt, idx, src, axis=0):
    return tgt.clone().index_add_(axis, idx, src)
def _segment_sum(src, seg, n):
    out = torch.zeros((n,) + src.shape[1:], dtype=src.dtype)
    return out.index_add_(0, seg, src)
def _pad(x, pw):
    flat = tuple(v for pair in reversed(pw) for v in pair)
    return torch.nn.functional.pad(x, flat)

kernel_name = 'parallel_sum__ssm_conv_h3__mixer_s_mlp__prompt'

def setup_inputs():

    _w = (lambda a: (lambda t: t.to(torch.bfloat16) if t.is_floating_point() else t)(torch.as_tensor(a)))
    def _A_setup():
        B, S, D = 1, 2048, 448
        ks = 4
        return {
            "q": _w((lambda *s: torch.randn(*s, dtype=torch.bfloat16) * 0.05)(B, S, D)),
            "k": _w((lambda *s: torch.randn(*s, dtype=torch.bfloat16) * 0.8)(B, S, D)),
            "v": _w((lambda *s: torch.randn(*s, dtype=torch.bfloat16) * 0.8)(B, S, D)),
            "shift_k": _w((lambda *s: torch.randn(*s, dtype=torch.bfloat16) * 0.8)(D, ks) * 0.5),
            "ssm_k": _w((lambda *s: torch.randn(*s, dtype=torch.bfloat16) * 1.6)(D, S) * (1.0 / S ** 0.5)),
            "ssm_D": _w((lambda *s: torch.randn(*s, dtype=torch.bfloat16) * 0.8)(D)),
        }
    _A_in = _A_setup()

    def _B_setup():
        B, S, D, F = 1, 2048, 448, 1792
        return {
            "x":  _w((lambda *s: torch.randn(*s, dtype=torch.bfloat16) * 0.05)(B, S, D)),
            "w1": _w((lambda *s: torch.randn(*s, dtype=torch.bfloat16) * 3.2)(D, D) * (D ** -0.5)),
            "w2": _w((lambda *s: torch.randn(*s, dtype=torch.bfloat16) * 3.2)(D, D) * (D ** -0.5)),
            "w3": _w((lambda *s: torch.randn(*s, dtype=torch.bfloat16) * 3.2)(D, F) * (D ** -0.5)),
            "w4": _w((lambda *s: torch.randn(*s, dtype=torch.bfloat16) * 1.6)(F, D) * (F ** -0.5)),
        }
    _B_in = _B_setup()

    return {
        "A_q": _A_in["q"],
        "A_k": _A_in["k"],
        "A_v": _A_in["v"],
        "A_shift_k": _A_in["shift_k"],
        "A_ssm_k": _A_in["ssm_k"],
        "A_ssm_D": _A_in["ssm_D"],
        "B_x": _B_in["x"],
        "B_w1": _B_in["w1"],
        "B_w2": _B_in["w2"],
        "B_w3": _B_in["w3"],
        "B_w4": _B_in["w4"],
    }

def reference(A_q, A_k, A_v, A_shift_k, A_ssm_k, A_ssm_D, B_x, B_w1, B_w2, B_w3, B_w4):
    def _A_ref(q, k, v, shift_k, ssm_k, ssm_D):
        B, S, D = q.shape
        ks = shift_k.shape[-1]
        k_pad = _pad(k, ((0, 0), (ks - 1, 0), (0, 0)))
        k_shift = torch.zeros_like(k)
        for t in range(ks):
            k_shift = k_shift + k_pad[:, t:t + S, :] * shift_k[:, ks - 1 - t][None, None, :]
        kv = k_shift * v
        L = 2 * S
        kv_pad = _pad(kv, ((0, 0), (0, S), (0, 0)))
        kf_pad = _pad(ssm_k, ((0, 0), (0, S)))
        kv_f = (lambda x, axes=(-2,-1): torch.fft.rfft2(x.float(), dim=axes))(kv_pad[:, None, :, :], axes=(1, 2))
        kf_f = (lambda x, axes=(-2,-1): torch.fft.rfft2(x.float(), dim=axes))(kf_pad[:, None, :], axes=(1, 2))
        kf_f = (lambda x, *d: x.permute(*d))(kf_f, 1, 2, 0)
        y_f = kv_f * kf_f[None, :, :, :]
        y = (lambda x, s, axes=(-2,-1): torch.fft.irfft2(x, s=s, dim=axes).to(torch.bfloat16))(y_f, (1, L), axes=(1, 2))[:, 0, :S, :]
        y = y + kv * ssm_D[None, None, :]
        return q * y

    def _B_ref(x, w1, w2, w3, w4):
        B, S, D = x.shape
        h = _gelu(_layernorm(x, axis=-1) @ w1)
        c = D // 4
        g0 = _pad(h[:, :, 0*c:1*c], ((0, 0), (1, 0), (0, 0)))[:, :S, :]
        g1 = _pad(h[:, :, 1*c:2*c], ((0, 0), (0, 1), (0, 0)))[:, 1:, :]
        g2 = _pad(h[:, :, 2*c:3*c], ((0, 0), (2, 0), (0, 0)))[:, :S, :]
        g3 = _pad(h[:, :, 3*c:   ], ((0, 0), (0, 2), (0, 0)))[:, 2:, :]
        hs = torch.concatenate([g0, g1, g2, g3], axis=-1) @ w2
        x1 = x + hs
        h2 = _gelu(_layernorm(x1, axis=-1) @ w3) @ w4
        return x1 + h2

    x = A_q
    xn = _layernorm(x, axis=-1)
    return x + _A_ref(xn, A_k, A_v, A_shift_k, A_ssm_k, A_ssm_D) + _B_ref(xn, B_w1, B_w2, B_w3, B_w4)
```

```asm
; @launch grid=(256,1,1) block=(256,1,1) lds=163840
.amdgcn_target "amdgcn-amd-amdhsa--gfx950"
.text
.globl parallel_sum__ssm_conv_h3__mixer_s_mlp__prompt_kernel
.p2align 12
.p2align 8
.type parallel_sum__ssm_conv_h3__mixer_s_mlp__prompt_kernel,@function
parallel_sum__ssm_conv_h3__mixer_s_mlp__prompt_kernel:
    s_cmp_ge_u32 s2, 256
    s_cbranch_scc1 L_end
    s_lshr_b32 s57, s2, 3
    s_cmp_ge_u32 s57, 28
    s_cbranch_scc1 L_conv
    s_load_dwordx2 s[4:5], s[0:1], 0
    s_mov_b32 s6, 1835008
    s_mov_b32 s7, 0x20000
    s_load_dwordx2 s[40:41], s[0:1], 104
    s_mov_b32 s42, 17825792
    s_mov_b32 s43, 0x20000
    s_load_dwordx2 s[20:21], s[0:1], 56
    s_mov_b32 s22, 401408
    s_mov_b32 s23, 0x20000
    s_load_dwordx2 s[24:25], s[0:1], 64
    s_mov_b32 s26, 401408
    s_mov_b32 s27, 0x20000
    s_load_dwordx2 s[28:29], s[0:1], 72
    s_mov_b32 s30, 1605632
    s_mov_b32 s31, 0x20000
    s_load_dwordx2 s[44:45], s[0:1], 32
    s_mov_b32 s46, 1835008
    s_mov_b32 s47, 0x20000
    s_load_dwordx2 s[72:73], s[0:1], 40
    v_lshrrev_b32 v2, 6, v0
    v_and_b32 v1, 63, v0
    v_readfirstlane_b32 s48, v2
    s_getreg_b32 s64, hwreg(HW_REG_XCC_ID, 0, 3)
    s_mul_i32 s56, s57, 37
    s_lshr_b32 s56, s56, 8
    s_mul_i32 s58, s56, 7
    s_sub_u32 s50, s57, s58
    s_and_b32 s58, s2, 7
    s_lshl_b32 s58, s58, 2
    s_add_u32 s49, s58, s56
    s_mul_i32 s53, s49, 7
    s_add_u32 s53, s53, s50
    s_mul_i32 s62, s48, 15232
    s_lshl_b32 s81, s48, 10
    v_mov_b32 v11, 0
    v_lshrrev_b32 v10, 3, v1
    v_and_b32 v12, 7, v1
    s_mul_i32 s56, s49, 57344
    s_sub_u32 s56, s56, 1792
    v_and_b32 v101, 6, v10
    v_xor_b32 v101, v12, v101
    v_mul_u32_u24 v6, 896, v10
    v_lshl_add_u32 v102, v101, 4, v6
    s_mul_i32 s57, s48, 14336
    s_add_u32 s57, s57, s56
    v_add_u32 v100, s57, v102
    v_add_u32 v101, 6144, v100
    s_add_u32 s57, s56, 57344
    v_add_u32 v102, s57, v102
    s_lshl_b32 s75, s48, 11
    s_mul_i32 s60, s48, 7168
    v_and_b32 v7, 2, v10
    s_and_b32 s57, s48, 1
    s_lshl_b32 s57, s57, 2
    v_xor_b32 v248, v12, v7
    v_xor_b32 v248, s57, v248
    v_lshl_add_u32 v248, v248, 4, v6
    s_lshl_b32 s58, s50, 7
    s_add_u32 s57, s58, s60
    v_add_u32 v248, s57, v248
    s_add_u32 s57, s56, s58
    s_add_u32 s57, s57, s62
    v_mul_u32_u24 v254, 896, v1
    v_add_u32 v254, s57, v254
    v_lshlrev_b32 v106, 7, v1
    s_lshl_b32 s59, s53, 2
    s_add_u32 s59, s59, s48
    s_lshl_b32 s57, s59, 9
    s_mul_i32 s59, s59, 1792
    s_waitcnt lgkmcnt(0)
    s_mov_b32 s100, 32768
    s_mov_b32 s65, 2064384
    buffer_load_dword v250, v11, s[40:43], s65 offen sc1
    s_mov_b64 exec, 0x1ffff
    buffer_load_dword v254, v254, s[4:7], 0 offen
    s_mov_b64 exec, 15
    buffer_load_dword v255, v106, s[20:23], s57 offen
    buffer_load_dword v255, v106, s[24:27], s57 offen
    s_mov_b64 exec, 0x7fffffff
    s_mov_b32 exec_lo, -1
    s_add_u32 s57, s48, 0
    s_lshl_b32 s54, s57, 7
    s_mul_i32 s57, s57, 8704
    s_add_u32 m0, s57, 8192
    s_nop 0
    buffer_load_dwordx4 v102, s[4:7], s54 offen lds
    s_add_u32 s57, s48, 4
    s_min_u32 s57, s57, 6
    s_lshl_b32 s54, s57, 7
    s_mul_i32 s57, s57, 8704
    s_add_u32 m0, s57, 8192
    s_nop 0
    buffer_load_dwordx4 v102, s[4:7], s54 offen lds
    s_mov_b64 exec, -1
    s_add_u32 m0, s75, 0
    s_nop 0
    buffer_load_dwordx4 v100, s[4:7], 0 offen lds
    buffer_load_dwordx4 v101, s[4:7], 0 offen offset:1024 lds
    s_add_u32 m0, s81, 61440
    s_nop 0
    buffer_load_dwordx4 v248, s[20:23], 0 offen lds
    s_add_u32 m0, s81, 65536
    s_mov_b32 s54, 28672
    buffer_load_dwordx4 v248, s[20:23], s54 offen lds
    s_load_dwordx2 s[32:33], s[0:1], 80
    s_mov_b32 s34, 1605632
    s_mov_b32 s35, 0x20000
    s_load_dwordx2 s[36:37], s[0:1], 88
    s_mov_b32 s38, 1835008
    s_mov_b32 s39, 0x20000
    s_lshl_b32 s56, s53, 12
    s_load_dword s69, s[44:45], s56
    s_lshl_b32 s56, s53, 1
    s_and_b32 s56, s56, 0xfffc
    s_load_dword s68, s[72:73], s56
    s_lshr_b32 s52, s49, 1
    s_mul_i32 s59, s52, 14
    s_sub_u32 s51, s53, s59
    s_mov_b32 s63, 0x3f803f80
    v_lshlrev_b32 v2, 4, v1
    v_and_b32 v244, 15, v1
    v_lshrrev_b32 v245, 4, v1
    s_add_u32 s56, s58, s60
    v_mul_u32_u24 v105, 8704, v10
    v_lshl_add_u32 v105, v12, 4, v105
    s_lshl_b32 s57, s48, 7
    v_add_u32 v105, s57, v105
    v_lshlrev_b32 v7, 1, v7
    v_xor_b32 v7, v12, v7
    v_lshl_add_u32 v6, v7, 4, v6
    v_add_u32 v6, s56, v6
    s_lshl_b32 s56, s53, 7
    s_lshl_b32 s57, s48, 2
    s_add_u32 s56, s56, s57
    v_mov_b32 v8, s56
    v_lshrrev_b32 v10, 2, v1
    v_and_b32 v12, 3, v1
    v_min_u32 v9, 13, v10
    v_add_u32 v9, s59, v9
    v_lshlrev_b32 v9, 7, v9
    v_lshl_add_u32 v9, v12, 2, v9
    s_lshl_b32 s3, s49, 10
    s_add_u32 s3, s3, 1966080
    s_lshl_b32 s89, s52, 10
    s_add_u32 s89, s89, 1998848
    s_add_u32 s97, s89, 16384
    s_lshl_b32 s56, s48, 6
    v_lshl_add_u32 v11, v1, 8, s56
    v_lshl_add_u32 v251, s50, 2, v11
    v_lshl_add_u32 v11, s51, 2, v11
    v_mul_u32_u24 v7, 3584, v10
    v_lshl_add_u32 v7, v12, 4, v7
    s_lshl_b32 s56, s51, 8
    s_lshl_b32 s57, s48, 6
    s_add_u32 s56, s56, s57
    v_add_u32 v7, s56, v7
    v_and_b32 v10, 3, v10
    v_lshrrev_b32 v5, 5, v1
    v_lshl_add_u32 v5, v5, 2, v10
    v_lshlrev_b32 v242, 3, v12
    v_and_b32 v243, 16, v1
    v_lshl_add_u32 v12, v243, 1, v242
    v_lshl_add_u32 v3, v5, 7, v12
    v_lshl_add_u32 v5, v5, 6, v12
    v_add_u32 v5, s60, v5
    v_lshrrev_b32 v12, 1, v10
    s_and_b32 s56, s48, 1
    v_xor_b32 v12, s56, v12
    v_lshl_add_u32 v3, v12, 6, v3
    v_and_b32 v103, 6, v244
    v_xor_b32 v103, v245, v103
    v_lshlrev_b32 v103, 4, v103
    v_lshl_add_u32 v103, v244, 7, v103
    v_add_u32 v103, s75, v103
    v_xor_b32 v104, 64, v103
    v_lshl_add_u32 v10, v245, 3, v10
    v_lshl_add_u32 v242, v10, 7, v242
    v_bfe_u32 v10, v1, 3, 2
    v_xor_b32 v10, s48, v10
    v_lshl_add_u32 v242, v10, 5, v242
    v_add_u32 v242, 61440, v242
    s_lshl_b32 s56, s50, 2
    s_add_u32 s56, s56, s48
    s_mul_i32 s57, s56, 37
    s_lshr_b32 s57, s57, 8
    s_lshl_b32 s57, s57, 2
    s_lshr_b32 s57, 0x4031, s57
    s_and_b32 s57, s57, 15
    v_add_u32 v238, s57, v244
    v_and_b32 v224, 6, v238
    v_xor_b32 v224, v245, v224
    v_lshlrev_b32 v224, 4, v224
    v_lshl_add_u32 v224, v238, 7, v224
    v_xor_b32 v225, 64, v224
    v_lshlrev_b32 v238, 5, v238
    v_add_u32 v238, 149504, v238
    s_mul_i32 s59, s49, 57344
    s_add_u32 s59, s59, 65536
    s_lshl_b32 s56, s56, 10
    s_add_u32 s56, s56, s59
    v_lshlrev_b32 v243, 5, v243
    v_lshrrev_b32 v10, 5, v1
    v_lshl_add_u32 v12, v10, 4, v244
    v_lshl_add_u32 v243, v12, 4, v243
    v_add_u32 v243, s56, v243
    v_min_u32 v249, 15, v1
    v_lshrrev_b32 v12, 3, v249
    v_mul_u32_u24 v12, 27648, v12
    v_lshl_add_u32 v12, v249, 7, v12
    v_add_u32 v106, s56, v12
    s_lshl_b32 s56, s48, 8
    v_and_b32 v12, 8, v1
    v_lshl_add_u32 v12, v12, 4, s56
    v_mov_b32 v102, s3
    v_mov_b32 v246, s89
    v_mov_b32 v247, s97
    v_cmp_eq_u32 vcc, 2, v245
    s_nop 1
    v_cndmask_b32 v102, v102, v246, vcc
    v_cmp_eq_u32 vcc, 3, v245
    s_nop 1
    v_cndmask_b32 v102, v102, v247, vcc
    v_add_u32 v102, v102, v12
    v_cmp_eq_u32 vcc, 0, v245
    s_nop 1
    v_cndmask_b32 v106, v102, v106, vcc
    v_mov_b32 v196, s63
    v_mov_b32 v197, s63
    v_mov_b32 v198, s63
    v_mov_b32 v199, s63
    s_lshr_b32 s57, s48, 1
    s_lshl_b32 s56, s57, 5
    s_add_u32 s56, s56, 2
    v_and_b32 v241, 31, v1
    v_add_u32 v241, s56, v241
    v_and_b32 v240, 6, v241
    s_and_b32 s58, s48, 1
    s_lshl_b32 s56, s58, 2
    v_xor_b32 v240, s56, v240
    v_lshlrev_b32 v240, 4, v240
    v_lshl_add_u32 v239, v241, 7, v240
    v_lshl_add_u32 v239, v10, 3, v239
    s_mul_i32 s56, s50, 8704
    v_add_u32 v239, s56, v239
    v_xor_b32 v240, 32, v239
    v_lshlrev_b32 v241, 5, v241
    v_add_u32 v241, 149504, v241
    s_mul_i32 s61, s57, 28672
    s_lshl_b32 s56, s58, 10
    s_add_u32 s61, s61, s56
    s_add_u32 s59, s59, s61
    v_add_u32 v252, s59, v2
    s_lshl_b32 s56, s49, 1
    s_add_u32 s56, s56, s57
    s_lshl_b32 s57, s50, 1
    s_add_u32 s57, s57, s58
    s_mul_i32 s58, s56, 28672
    s_lshl_b32 s59, s57, 11
    s_add_u32 s58, s58, s59
    s_add_u32 s58, s58, 2097152
    v_add_u32 v14, s58, v2
    s_mul_i32 s56, s56, 3584
    s_lshl_b32 s59, s57, 8
    s_add_u32 s56, s56, s59
    s_add_u32 s56, s56, 4194304
    v_lshl_add_u32 v15, v1, 2, s56
    v_lshl_add_u32 v249, v249, 7, s58
    v_cmp_gt_u32 vcc, 16, v1
    s_nop 1
    v_cndmask_b32 v249, v15, v249, vcc
    v_add_u32 v102, 16384, v102
    v_cmp_gt_u32 vcc, 48, v1
    s_nop 1
    v_cndmask_b32 v249, v102, v249, vcc
    s_lshr_b32 s56, s49, 2
    s_add_u32 s76, s56, 0
    s_and_b32 s76, s76, 3
    s_mul_i32 s76, s76, 401408
    s_add_u32 s77, s56, 1
    s_and_b32 s77, s77, 3
    s_mul_i32 s77, s77, 401408
    s_add_u32 s78, s56, 2
    s_and_b32 s78, s78, 3
    s_mul_i32 s78, s78, 401408
    s_add_u32 s79, s56, 3
    s_and_b32 s79, s79, 3
    s_mul_i32 s79, s79, 401408
    s_add_u32 s80, s56, s48
    s_and_b32 s80, s80, 3
    s_mul_i32 s80, s80, 7168
    v_min_u32 v107, 13, v1
    v_lshlrev_b32 v107, 7, v107
    v_min_u32 v108, 384, v107
    v_mov_b32 v84, 0
    v_mov_b32 v85, 0
    v_and_b32 v86, 3, v1
    v_cmp_eq_u32 s[98:99], 1, v86
    v_cmp_eq_u32 s[90:91], 2, v86
    v_cmp_eq_u32 s[94:95], 3, v86
    v_cmp_eq_u32 s[92:93], 16, v1
    s_lshl_b32 s56, s48, 4
    v_add_u32 v86, s56, v244
    s_add_u32 s56, s48, 64
    v_mov_b32 v87, s56
    v_cndmask_b32 v86, v86, v87, s[92:93]
    v_lshlrev_b32 v86, 5, v86
    v_add_u32 v86, 149504, v86
    s_add_u32 m0, s75, 8704
    s_mov_b32 s54, 128
    buffer_load_dwordx4 v100, s[4:7], s54 offen lds
    buffer_load_dwordx4 v101, s[4:7], s54 offen offset:1024 lds
    s_add_u32 m0, s81, 69632
    s_mov_b32 s54, 57344
    buffer_load_dwordx4 v248, s[20:23], s54 offen lds
    s_add_u32 m0, s81, 73728
    s_mov_b32 s54, 86016
    buffer_load_dwordx4 v248, s[20:23], s54 offen lds
    s_add_u32 m0, s75, 17408
    s_mov_b32 s54, 256
    buffer_load_dwordx4 v100, s[4:7], s54 offen lds
    buffer_load_dwordx4 v101, s[4:7], s54 offen offset:1024 lds
    s_add_u32 m0, s81, 77824
    s_mov_b32 s54, 114688
    buffer_load_dwordx4 v248, s[20:23], s54 offen lds
    s_add_u32 m0, s81, 81920
    s_mov_b32 s54, 143360
    buffer_load_dwordx4 v248, s[20:23], s54 offen lds
    s_add_u32 m0, s75, 26112
    s_mov_b32 s54, 384
    buffer_load_dwordx4 v100, s[4:7], s54 offen lds
    buffer_load_dwordx4 v101, s[4:7], s54 offen offset:1024 lds
    s_add_u32 m0, s81, 86016
    s_mov_b32 s54, 172032
    buffer_load_dwordx4 v248, s[20:23], s54 offen lds
    s_add_u32 m0, s81, 90112
    s_mov_b32 s54, 200704
    buffer_load_dwordx4 v248, s[20:23], s54 offen lds
    s_waitcnt vmcnt(21)
    v_readfirstlane_b32 s65, v250
    s_nop 0
    s_mul_i32 s65, s65, 0x9e3779b1
    s_add_u32 s65, s65, 0x7f4a7c15
    s_xor_b32 s55, s65, s64
    v_mov_b32 v13, s55
    s_mov_b64 exec, 1
    buffer_store_dword v13, v8, s[40:43], 0 offen offset:0
    s_mov_b64 exec, -1
    v_mov_b32 v13, s65
    s_waitcnt lgkmcnt(0)
    s_waitcnt vmcnt(13)
    s_barrier
    ds_read_b128 v[72:75], v105 offset:8192
    ds_read_b64_tr_b16 a[112:113], v242 offset:0
    ds_read_b64_tr_b16 a[114:115], v242 offset:512
    ds_read_b128 v[128:131], v224 offset:0
    ds_read_b128 v[132:135], v224 offset:2048
    ds_read_b128 v[136:139], v224 offset:4096
    ds_read_b128 v[140:143], v224 offset:6144
    ds_read_b128 v[16:19], v103 offset:0
    ds_read_b64_tr_b16 a[116:117], v242 offset:4096
    ds_read_b64_tr_b16 a[118:119], v242 offset:4608
    ds_read_b128 v[144:147], v225 offset:0
    ds_read_b128 v[148:151], v225 offset:2048
    ds_read_b128 v[152:155], v225 offset:4096
    ds_read_b128 v[156:159], v225 offset:6144
    ds_read_b128 v[20:23], v104 offset:0
    s_waitcnt lgkmcnt(14)
    v_dot2c_f32_bf16 v84, s63, v72
    v_dot2c_f32_bf16 v85, v72, v72
    v_dot2c_f32_bf16 v84, s63, v73
    v_dot2c_f32_bf16 v85, v73, v73
    v_dot2c_f32_bf16 v84, s63, v74
    v_dot2c_f32_bf16 v85, v74, v74
    v_dot2c_f32_bf16 v84, s63, v75
    v_dot2c_f32_bf16 v85, v75, v75
    s_waitcnt lgkmcnt(7)
    s_waitcnt vmcnt(9)
    s_barrier
    v_mfma_f32_16x16x32_bf16 v[76:79], v[16:19], v[16:19], 0
    ds_read_b64_tr_b16 a[120:121], v242 offset:8192
    s_add_u32 m0, s75, 34816
    s_mov_b32 s54, 512
    buffer_load_dwordx4 v100, s[4:7], s54 offen lds
    v_mfma_f32_16x16x32_bf16 v[80:83], v[196:199], v[16:19], 0
    ds_read_b64_tr_b16 a[122:123], v242 offset:8704
    v_cmp_gt_u32 vcc, 56, v1
    s_nop 1
    v_cndmask_b32 v84, 0, v84, vcc
    v_mfma_f32_16x16x32_bf16 v[192:195], a[112:115], v[196:199], 0
    ds_read_b128 v[160:163], v224 offset:8704
    v_cndmask_b32 v85, 0, v85, vcc
    s_nop 1
    v_permlane32_swap_b32 v84, v85
    v_add_f32 v84, v84, v85
    v_mfma_f32_16x16x32_bf16 v[176:179], a[112:115], v[128:131], 0
    ds_read_b128 v[164:167], v224 offset:10752
    buffer_load_dwordx4 v101, s[4:7], s54 offen offset:1024 lds
    v_mfma_f32_16x16x32_bf16 v[180:183], a[112:115], v[132:135], 0
    ds_read_b128 v[168:171], v224 offset:12800
    v_add_f32_dpp v84, v84, v84 quad_perm:[1,0,3,2] row_mask:0xf bank_mask:0xf
    s_nop 1
    v_add_f32_dpp v84, v84, v84 quad_perm:[2,3,0,1] row_mask:0xf bank_mask:0xf
    s_nop 1
    v_add_f32_dpp v84, v84, v84 row_half_mirror row_mask:0xf bank_mask:0xf
    v_mfma_f32_16x16x32_bf16 v[184:187], a[112:115], v[136:139], 0
    ds_read_b128 v[172:175], v224 offset:14848
    v_add_f32_dpp v84, v84, v84 row_mirror row_mask:0xf bank_mask:0xf
    v_mov_b32 v85, v84
    s_nop 1
    v_permlane16_swap_b32 v84, v85
    v_mfma_f32_16x16x32_bf16 v[188:191], a[112:115], v[140:143], 0
    ds_read_b128 v[24:27], v103 offset:8704
    v_add_f32 v84, v84, v85
    v_mov_b32 v85, v84
    s_nop 1
    v_permlane32_swap_b32 v84, v85
    s_waitcnt lgkmcnt(7)
    v_mfma_f32_16x16x32_bf16 v[76:79], v[20:23], v[20:23], v[76:79]
    ds_read_b64_tr_b16 a[124:125], v242 offset:12288
    s_add_u32 m0, s81, 94208
    s_mov_b32 s54, 229376
    buffer_load_dwordx4 v248, s[20:23], s54 offen lds
    v_mfma_f32_16x16x32_bf16 v[80:83], v[196:199], v[20:23], v[80:83]
    ds_read_b64_tr_b16 a[126:127], v242 offset:12800
    v_mfma_f32_16x16x32_bf16 v[192:195], a[116:119], v[196:199], v[192:195]
    ds_read_b128 v[128:131], v225 offset:8704
    v_mfma_f32_16x16x32_bf16 v[176:179], a[116:119], v[144:147], v[176:179]
    ds_read_b128 v[132:135], v225 offset:10752
    s_add_u32 m0, s81, 98304
    s_mov_b32 s54, 258048
    buffer_load_dwordx4 v248, s[20:23], s54 offen lds
    v_mfma_f32_16x16x32_bf16 v[180:183], a[116:119], v[148:151], v[180:183]
    ds_read_b128 v[136:139], v225 offset:12800
    v_mfma_f32_16x16x32_bf16 v[184:187], a[116:119], v[152:155], v[184:187]
    ds_read_b128 v[140:143], v225 offset:14848
    v_mfma_f32_16x16x32_bf16 v[188:191], a[116:119], v[156:159], v[188:191]
    ds_read_b128 v[16:19], v104 offset:8704
    s_waitcnt lgkmcnt(7)
    s_waitcnt vmcnt(9)
    s_barrier
    v_mfma_f32_16x16x32_bf16 v[76:79], v[24:27], v[24:27], v[76:79]
    ds_read_b64_tr_b16 a[128:129], v242 offset:16384
    s_add_u32 m0, s75, 43520
    s_mov_b32 s54, 640
    buffer_load_dwordx4 v100, s[4:7], s54 offen lds
    v_mfma_f32_16x16x32_bf16 v[80:83], v[196:199], v[24:27], v[80:83]
    ds_read_b64_tr_b16 a[130:131], v242 offset:16896
    v_mfma_f32_16x16x32_bf16 v[192:195], a[120:123], v[196:199], v[192:195]
    ds_read_b128 v[144:147], v224 offset:17408
    v_mfma_f32_16x16x32_bf16 v[176:179], a[120:123], v[160:163], v[176:179]
    ds_read_b128 v[148:151], v224 offset:19456
    buffer_load_dwordx4 v101, s[4:7], s54 offen offset:1024 lds
    v_mfma_f32_16x16x32_bf16 v[180:183], a[120:123], v[164:167], v[180:183]
    ds_read_b128 v[152:155], v224 offset:21504
    v_mfma_f32_16x16x32_bf16 v[184:187], a[120:123], v[168:171], v[184:187]
    ds_read_b128 v[156:159], v224 offset:23552
    v_mfma_f32_16x16x32_bf16 v[188:191], a[120:123], v[172:175], v[188:191]
    ds_read_b128 v[20:23], v103 offset:17408
    s_waitcnt lgkmcnt(7)
    v_mfma_f32_16x16x32_bf16 v[76:79], v[16:19], v[16:19], v[76:79]
    ds_read_b64_tr_b16 a[132:133], v242 offset:20480
    s_add_u32 m0, s81, 102400
    s_mov_b32 s54, 286720
    buffer_load_dwordx4 v248, s[20:23], s54 offen lds
    v_mfma_f32_16x16x32_bf16 v[80:83], v[196:199], v[16:19], v[80:83]
    ds_read_b64_tr_b16 a[134:135], v242 offset:20992
    v_mfma_f32_16x16x32_bf16 v[192:195], a[124:127], v[196:199], v[192:195]
    ds_read_b128 v[160:163], v225 offset:17408
    v_mfma_f32_16x16x32_bf16 v[176:179], a[124:127], v[128:131], v[176:179]
    ds_read_b128 v[164:167], v225 offset:19456
    s_add_u32 m0, s81, 106496
    s_mov_b32 s54, 315392
    buffer_load_dwordx4 v248, s[20:23], s54 offen lds
    v_mfma_f32_16x16x32_bf16 v[180:183], a[124:127], v[132:135], v[180:183]
    ds_read_b128 v[168:171], v225 offset:21504
    v_mfma_f32_16x16x32_bf16 v[184:187], a[124:127], v[136:139], v[184:187]
    ds_read_b128 v[172:175], v225 offset:23552
    v_mfma_f32_16x16x32_bf16 v[188:191], a[124:127], v[140:143], v[188:191]
    ds_read_b128 v[24:27], v104 offset:17408
    s_waitcnt lgkmcnt(7)
    s_waitcnt vmcnt(9)
    s_barrier
    v_mfma_f32_16x16x32_bf16 v[76:79], v[20:23], v[20:23], v[76:79]
    ds_read_b64_tr_b16 a[136:137], v242 offset:24576
    s_add_u32 m0, s75, 52224
    s_mov_b32 s54, 768
    buffer_load_dwordx4 v100, s[4:7], s54 offen lds
    v_mfma_f32_16x16x32_bf16 v[80:83], v[196:199], v[20:23], v[80:83]
    ds_read_b64_tr_b16 a[138:139], v242 offset:25088
    v_mfma_f32_16x16x32_bf16 v[192:195], a[128:131], v[196:199], v[192:195]
    ds_read_b128 v[128:131], v224 offset:26112
    v_mfma_f32_16x16x32_bf16 v[176:179], a[128:131], v[144:147], v[176:179]
    ds_read_b128 v[132:135], v224 offset:28160
    buffer_load_dwordx4 v101, s[4:7], s54 offen offset:1024 lds
    v_mfma_f32_16x16x32_bf16 v[180:183], a[128:131], v[148:151], v[180:183]
    ds_read_b128 v[136:139], v224 offset:30208
    v_mfma_f32_16x16x32_bf16 v[184:187], a[128:131], v[152:155], v[184:187]
    ds_read_b128 v[140:143], v224 offset:32256
    s_branch L_pggs0
.p2align 12
L_pgg0:
    s_branch L_pgg4
L_pggs0:
    v_mfma_f32_16x16x32_bf16 v[188:191], a[128:131], v[156:159], v[188:191]
    ds_read_b128 v[16:19], v103 offset:26112
    s_waitcnt lgkmcnt(7)
    v_mfma_f32_16x16x32_bf16 v[76:79], v[24:27], v[24:27], v[76:79]
    ds_read_b64_tr_b16 a[140:141], v242 offset:28672
    s_add_u32 m0, s81, 110592
    s_mov_b32 s54, 344064
    buffer_load_dwordx4 v248, s[20:23], s54 offen lds
    v_mfma_f32_16x16x32_bf16 v[80:83], v[196:199], v[24:27], v[80:83]
    ds_read_b64_tr_b16 a[142:143], v242 offset:29184
    v_mfma_f32_16x16x32_bf16 v[192:195], a[132:135], v[196:199], v[192:195]
    ds_read_b128 v[144:147], v225 offset:26112
    v_mfma_f32_16x16x32_bf16 v[176:179], a[132:135], v[160:163], v[176:179]
    ds_read_b128 v[148:151], v225 offset:28160
    s_add_u32 m0, s81, 114688
    s_mov_b32 s54, 372736
    buffer_load_dwordx4 v248, s[20:23], s54 offen lds
    v_mfma_f32_16x16x32_bf16 v[180:183], a[132:135], v[164:167], v[180:183]
    ds_read_b128 v[152:155], v225 offset:30208
    v_mfma_f32_16x16x32_bf16 v[184:187], a[132:135], v[168:171], v[184:187]
    ds_read_b128 v[156:159], v225 offset:32256
    v_mfma_f32_16x16x32_bf16 v[188:191], a[132:135], v[172:175], v[188:191]
    ds_read_b128 v[20:23], v104 offset:26112
    s_waitcnt lgkmcnt(7)
    s_waitcnt vmcnt(8)
    s_barrier
    v_mfma_f32_16x16x32_bf16 v[76:79], v[16:19], v[16:19], v[76:79]
    ds_read_b64_tr_b16 a[144:145], v242 offset:32768
    buffer_load_dword v250, v9, s[40:43], 0 offen offset:0 sc1
    v_mfma_f32_16x16x32_bf16 v[80:83], v[196:199], v[16:19], v[80:83]
    ds_read_b64_tr_b16 a[146:147], v242 offset:33280
    v_mfma_f32_16x16x32_bf16 v[192:195], a[136:139], v[196:199], v[192:195]
    ds_read_b128 v[160:163], v224 offset:34816
    v_mfma_f32_16x16x32_bf16 v[176:179], a[136:139], v[128:131], v[176:179]
    ds_read_b128 v[164:167], v224 offset:36864
    v_mfma_f32_16x16x32_bf16 v[180:183], a[136:139], v[132:135], v[180:183]
    ds_read_b128 v[168:171], v224 offset:38912
    v_mfma_f32_16x16x32_bf16 v[184:187], a[136:139], v[136:139], v[184:187]
    ds_read_b128 v[172:175], v224 offset:40960
    v_mfma_f32_16x16x32_bf16 v[188:191], a[136:139], v[140:143], v[188:191]
    ds_read_b128 v[24:27], v103 offset:34816
    s_waitcnt lgkmcnt(7)
    v_mfma_f32_16x16x32_bf16 v[76:79], v[20:23], v[20:23], v[76:79]
    ds_read_b64_tr_b16 a[148:149], v242 offset:36864
    s_lshl_b32 s56, s53, 2
    s_add_u32 s56, s56, s48
    s_mul_i32 s57, s56, 1792
    s_lshl_b32 s56, s56, 9
    buffer_load_dword v255, v107, s[28:31], s57 offen
    v_mfma_f32_16x16x32_bf16 v[80:83], v[196:199], v[20:23], v[80:83]
    ds_read_b64_tr_b16 a[150:151], v242 offset:37376
    v_mfma_f32_16x16x32_bf16 v[192:195], a[140:143], v[196:199], v[192:195]
    ds_read_b128 v[128:131], v225 offset:34816
    v_mfma_f32_16x16x32_bf16 v[176:179], a[140:143], v[144:147], v[176:179]
    ds_read_b128 v[132:135], v225 offset:36864
    v_mfma_f32_16x16x32_bf16 v[180:183], a[140:143], v[148:151], v[180:183]
    ds_read_b128 v[136:139], v225 offset:38912
    v_mfma_f32_16x16x32_bf16 v[184:187], a[140:143], v[152:155], v[184:187]
    ds_read_b128 v[140:143], v225 offset:40960
    v_mfma_f32_16x16x32_bf16 v[188:191], a[140:143], v[156:159], v[188:191]
    ds_read_b128 v[16:19], v104 offset:34816
    s_waitcnt lgkmcnt(7)
    s_waitcnt vmcnt(6)
    s_barrier
    v_mfma_f32_16x16x32_bf16 v[76:79], v[24:27], v[24:27], v[76:79]
    ds_read_b64_tr_b16 a[152:153], v242 offset:40960
    buffer_load_dword v254, v106, s[40:43], 0 offen sc1
    v_mfma_f32_16x16x32_bf16 v[80:83], v[196:199], v[24:27], v[80:83]
    ds_read_b64_tr_b16 a[154:155], v242 offset:41472
    v_mfma_f32_16x16x32_bf16 v[192:195], a[144:147], v[196:199], v[192:195]
    ds_read_b128 v[144:147], v224 offset:43520
    v_mfma_f32_16x16x32_bf16 v[176:179], a[144:147], v[160:163], v[176:179]
    ds_read_b128 v[148:151], v224 offset:45568
    v_mfma_f32_16x16x32_bf16 v[180:183], a[144:147], v[164:167], v[180:183]
    ds_read_b128 v[152:155], v224 offset:47616
    v_mfma_f32_16x16x32_bf16 v[184:187], a[144:147], v[168:171], v[184:187]
    ds_read_b128 v[156:159], v224 offset:49664
    v_mfma_f32_16x16x32_bf16 v[188:191], a[144:147], v[172:175], v[188:191]
    ds_read_b128 v[20:23], v103 offset:43520
    s_waitcnt lgkmcnt(7)
    v_mfma_f32_16x16x32_bf16 v[76:79], v[16:19], v[16:19], v[76:79]
    ds_read_b64_tr_b16 a[156:157], v242 offset:45056
    buffer_load_dword v254, v249, s[40:43], 0 offen sc1
    v_mfma_f32_16x16x32_bf16 v[80:83], v[196:199], v[16:19], v[80:83]
    ds_read_b64_tr_b16 a[158:159], v242 offset:45568
    v_mfma_f32_16x16x32_bf16 v[192:195], a[148:151], v[196:199], v[192:195]
    ds_read_b128 v[160:163], v225 offset:43520
    v_mfma_f32_16x16x32_bf16 v[176:179], a[148:151], v[128:131], v[176:179]
    ds_read_b128 v[164:167], v225 offset:45568
    v_mfma_f32_16x16x32_bf16 v[180:183], a[148:151], v[132:135], v[180:183]
    ds_read_b128 v[168:171], v225 offset:47616
    v_mfma_f32_16x16x32_bf16 v[184:187], a[148:151], v[136:139], v[184:187]
    ds_read_b128 v[172:175], v225 offset:49664
    v_mfma_f32_16x16x32_bf16 v[188:191], a[148:151], v[140:143], v[188:191]
    ds_read_b128 v[24:27], v104 offset:43520
    s_waitcnt lgkmcnt(7)
    s_cmp_eq_u32 s48, 0
    s_cbranch_scc1 L_pgg0
    s_cmp_eq_u32 s48, 1
    s_cbranch_scc1 L_pgg1
    s_cmp_eq_u32 s48, 2
    s_cbranch_scc1 L_pgg2
    s_branch L_pgg3
L_pggret:
    s_waitcnt vmcnt(4)
    s_barrier
    v_mfma_f32_16x16x32_bf16 v[76:79], v[20:23], v[20:23], v[76:79]
    ds_read_b64_tr_b16 a[160:161], v242 offset:49152
    s_add_u32 m0, s81, 118784
    s_nop 0
    buffer_load_dwordx4 v6, s[24:27], 0 offen lds
    v_mfma_f32_16x16x32_bf16 v[80:83], v[196:199], v[20:23], v[80:83]
    ds_read_b64_tr_b16 a[162:163], v242 offset:49664
    v_mfma_f32_16x16x32_bf16 v[192:195], a[152:155], v[196:199], v[192:195]
    ds_read_b128 v[128:131], v224 offset:52224
    v_mfma_f32_16x16x32_bf16 v[176:179], a[152:155], v[144:147], v[176:179]
    ds_read_b128 v[132:135], v224 offset:54272
    v_mfma_f32_16x16x32_bf16 v[180:183], a[152:155], v[148:151], v[180:183]
    ds_read_b128 v[136:139], v224 offset:56320
    v_mfma_f32_16x16x32_bf16 v[184:187], a[152:155], v[152:155], v[184:187]
    ds_read_b128 v[140:143], v224 offset:58368
    v_mfma_f32_16x16x32_bf16 v[188:191], a[152:155], v[156:159], v[188:191]
    ds_read_b128 v[16:19], v103 offset:52224
    s_waitcnt lgkmcnt(7)
    v_mfma_f32_16x16x32_bf16 v[76:79], v[24:27], v[24:27], v[76:79]
    ds_read_b64_tr_b16 a[164:165], v242 offset:53248
    s_add_u32 m0, s81, 122880
    s_mov_b32 s54, 28672
    buffer_load_dwordx4 v6, s[24:27], s54 offen lds
    v_mfma_f32_16x16x32_bf16 v[80:83], v[196:199], v[24:27], v[80:83]
    ds_read_b64_tr_b16 a[166:167], v242 offset:53760
    v_mfma_f32_16x16x32_bf16 v[192:195], a[156:159], v[196:199], v[192:195]
    ds_read_b128 v[144:147], v225 offset:52224
    v_mfma_f32_16x16x32_bf16 v[176:179], a[156:159], v[160:163], v[176:179]
    ds_read_b128 v[148:151], v225 offset:54272
    v_mfma_f32_16x16x32_bf16 v[180:183], a[156:159], v[164:167], v[180:183]
    ds_read_b128 v[152:155], v225 offset:56320
    v_mfma_f32_16x16x32_bf16 v[184:187], a[156:159], v[168:171], v[184:187]
    ds_read_b128 v[156:159], v225 offset:58368
    v_mfma_f32_16x16x32_bf16 v[188:191], a[156:159], v[172:175], v[188:191]
    ds_read_b128 v[20:23], v104 offset:52224
    s_waitcnt lgkmcnt(7)
    v_mfma_f32_16x16x32_bf16 v[76:79], v[16:19], v[16:19], v[76:79]
    ds_read_b64 v[216:217], v239 offset:0
    s_add_u32 m0, s81, 126976
    s_mov_b32 s54, 57344
    buffer_load_dwordx4 v6, s[24:27], s54 offen lds
    v_mfma_f32_16x16x32_bf16 v[80:83], v[196:199], v[16:19], v[80:83]
    ds_read_b64 v[218:219], v239 offset:16
    v_mfma_f32_16x16x32_bf16 v[192:195], a[160:163], v[196:199], v[192:195]
    ds_read_b64 v[220:221], v240 offset:0
    v_mfma_f32_16x16x32_bf16 v[176:179], a[160:163], v[128:131], v[176:179]
    ds_read_b64 v[222:223], v240 offset:16
    v_mfma_f32_16x16x32_bf16 v[180:183], a[160:163], v[132:135], v[180:183]
    v_mfma_f32_16x16x32_bf16 v[184:187], a[160:163], v[136:139], v[184:187]
    v_mfma_f32_16x16x32_bf16 v[188:191], a[160:163], v[140:143], v[188:191]
    s_waitcnt lgkmcnt(4)
    v_mfma_f32_16x16x32_bf16 v[76:79], v[20:23], v[20:23], v[76:79]
    s_add_u32 m0, s81, 131072
    s_mov_b32 s54, 86016
    buffer_load_dwordx4 v6, s[24:27], s54 offen lds
    v_mfma_f32_16x16x32_bf16 v[80:83], v[196:199], v[20:23], v[80:83]
    v_mfma_f32_16x16x32_bf16 v[192:195], a[164:167], v[196:199], v[192:195]
    v_mfma_f32_16x16x32_bf16 v[176:179], a[164:167], v[144:147], v[176:179]
    v_mfma_f32_16x16x32_bf16 v[180:183], a[164:167], v[148:151], v[180:183]
    v_mfma_f32_16x16x32_bf16 v[184:187], a[164:167], v[152:155], v[184:187]
    v_mfma_f32_16x16x32_bf16 v[188:191], a[164:167], v[156:159], v[188:191]
    v_cndmask_b32 v76, v76, v77, s[98:99]
    s_add_u32 m0, s81, 135168
    s_mov_b32 s54, 114688
    buffer_load_dwordx4 v6, s[24:27], s54 offen lds
    v_cndmask_b32 v76, v76, v78, s[90:91]
    v_cndmask_b32 v76, v76, v79, s[94:95]
    v_cndmask_b32 v80, v80, v84, s[92:93]
    v_cndmask_b32 v76, v76, v85, s[92:93]
    v_mul_f32 v88, 0xbb124925, v80
    v_mul_f32 v76, 0x3b124925, v76
    s_add_u32 m0, s81, 139264
    s_mov_b32 s54, 143360
    buffer_load_dwordx4 v6, s[24:27], s54 offen lds
    v_fma_f32 v76, -v88, v88, v76
    v_max_f32 v76, 0, v76
    v_add_f32 v80, 0x3727c5ac, v76
    v_rsq_f32 v92, v80
    s_nop 0
    v_mul_f32 v76, v76, v92
    v_fmaak_f32 v76, v76, v92, 0x3727c5ac
    s_add_u32 m0, s81, 143360
    s_mov_b32 s54, 172032
    buffer_load_dwordx4 v6, s[24:27], s54 offen lds
    v_rsq_f32 v76, v76
    s_nop 0
    v_mul_f32 v76, v76, v92
    v_rcp_f32 v91, v76
    v_mul_f32 v89, 0xc0135761, v76
    v_mul_f32 v80, v76, v76
    v_mul_f32 v80, 0x3d372713, v80
    v_mul_f32 v90, v89, v80
    s_mov_b32 exec_lo, 0x00f1000f
    s_mov_b32 exec_hi, 0xf0000f00
    ds_write_b128 v86, v[88:91]
    ds_write_b32 v86, v92 offset:16
    s_mov_b64 exec, -1
    s_waitcnt vmcnt(10)
    v_xor_b32 v250, s65, v250
    v_cmp_lt_u32 vcc, 7, v250
    s_cbranch_vccz L_ok1
    s_mov_b32 s55, 0
L_spin2:
    buffer_load_dword v250, v9, s[40:43], 0 offen offset:0 sc1
    s_waitcnt vmcnt(0)
    v_xor_b32 v250, s65, v250
    v_cmp_lt_u32 vcc, 7, v250
    s_cbranch_vccz L_spun3
    s_add_u32 s55, s55, 1
    s_cmp_lt_u32 s55, 12
    s_cbranch_scc1 L_spin2
L_spun3:
L_ok1:
    v_cmp_ne_u32 vcc, s64, v250
    s_waitcnt lgkmcnt(0)
    s_barrier
    ds_read_b128 v[200:203], v238 offset:0
    ds_read_b128 v[204:207], v238 offset:512
    ds_read_b128 v[208:211], v238 offset:1024
    ds_read_b128 v[212:215], v238 offset:1536
    ds_read_b32 v246, v241 offset:0
    ds_read_b32 v247, v241 offset:16
    s_mov_b32 s64, s65
    s_cbranch_vccnz L_far
    s_waitcnt lgkmcnt(4)
    v_pk_fma_f32 v[176:177], v[192:193], v[200:201], v[176:177] op_sel_hi:[1,0,1]
    s_add_u32 m0, s81, 61440
    s_mov_b32 s54, 200704
    buffer_load_dwordx4 v6, s[24:27], s54 offen lds
    v_pk_fma_f32 v[178:179], v[194:195], v[200:201], v[178:179] op_sel_hi:[1,0,1]
    v_pk_fma_f32 v[180:181], v[192:193], v[204:205], v[180:181] op_sel_hi:[1,0,1]
    v_pk_fma_f32 v[182:183], v[194:195], v[204:205], v[182:183] op_sel_hi:[1,0,1]
    v_pk_mul_f32 v[144:145], v[176:177], v[176:177]
    v_pk_mul_f32 v[146:147], v[178:179], v[178:179]
    v_pk_mul_f32 v[148:149], v[180:181], v[180:181]
    v_pk_mul_f32 v[150:151], v[182:183], v[182:183]
    v_pk_fma_f32 v[144:145], v[144:145], v[202:203], v[200:201] op_sel:[0,0,1] op_sel_hi:[1,0,1]
    s_add_u32 m0, s81, 65536
    s_mov_b32 s54, 229376
    buffer_load_dwordx4 v6, s[24:27], s54 offen lds
    v_pk_fma_f32 v[146:147], v[146:147], v[202:203], v[200:201] op_sel:[0,0,1] op_sel_hi:[1,0,1]
    v_pk_fma_f32 v[148:149], v[148:149], v[206:207], v[204:205] op_sel:[0,0,1] op_sel_hi:[1,0,1]
    v_pk_fma_f32 v[150:151], v[150:151], v[206:207], v[204:205] op_sel:[0,0,1] op_sel_hi:[1,0,1]
    v_pk_mul_f32 v[144:145], v[176:177], v[144:145]
    v_pk_mul_f32 v[146:147], v[178:179], v[146:147]
    v_pk_mul_f32 v[148:149], v[180:181], v[148:149]
    v_pk_mul_f32 v[150:151], v[182:183], v[150:151]
    v_exp_f32 v144, v144
    v_exp_f32 v145, v145
    s_add_u32 m0, s81, 69632
    s_mov_b32 s54, 258048
    buffer_load_dwordx4 v6, s[24:27], s54 offen lds
    v_exp_f32 v146, v146
    v_exp_f32 v147, v147
    v_exp_f32 v148, v148
    v_exp_f32 v149, v149
    v_exp_f32 v150, v150
    v_exp_f32 v151, v151
    v_pk_fma_f32 v[144:145], v[144:145], v[202:203], v[202:203] op_sel:[0,1,1] op_sel_hi:[1,1,1]
    v_pk_fma_f32 v[146:147], v[146:147], v[202:203], v[202:203] op_sel:[0,1,1] op_sel_hi:[1,1,1]
    s_add_u32 m0, s81, 73728
    s_mov_b32 s54, 286720
    buffer_load_dwordx4 v6, s[24:27], s54 offen lds
    v_pk_fma_f32 v[148:149], v[148:149], v[206:207], v[206:207] op_sel:[0,1,1] op_sel_hi:[1,1,1]
    v_pk_fma_f32 v[150:151], v[150:151], v[206:207], v[206:207] op_sel:[0,1,1] op_sel_hi:[1,1,1]
    v_rcp_f32 v144, v144
    v_rcp_f32 v145, v145
    v_rcp_f32 v146, v146
    v_rcp_f32 v147, v147
    v_rcp_f32 v148, v148
    v_rcp_f32 v149, v149
    v_rcp_f32 v150, v150
    s_add_u32 m0, s81, 77824
    s_mov_b32 s54, 315392
    buffer_load_dwordx4 v6, s[24:27], s54 offen lds
    v_rcp_f32 v151, v151
    v_pk_mul_f32 v[144:145], v[176:177], v[144:145]
    v_pk_mul_f32 v[146:147], v[178:179], v[146:147]
    v_pk_mul_f32 v[148:149], v[180:181], v[148:149]
    v_pk_mul_f32 v[150:151], v[182:183], v[150:151]
    v_cvt_pk_bf16_f32 v136, v144, v145
    v_cvt_pk_bf16_f32 v137, v146, v147
    v_cvt_pk_bf16_f32 v138, v148, v149
    s_add_u32 m0, s81, 81920
    s_mov_b32 s54, 344064
    buffer_load_dwordx4 v6, s[24:27], s54 offen lds
    v_cvt_pk_bf16_f32 v139, v150, v151
    v_permlane32_swap_b32 v136, v138
    s_nop 0
    v_permlane32_swap_b32 v137, v139
    buffer_store_dwordx4 v[136:139], v243, s[40:43], 0 offen
    s_waitcnt lgkmcnt(2)
    v_pk_fma_f32 v[184:185], v[192:193], v[208:209], v[184:185] op_sel_hi:[1,0,1]
    v_pk_fma_f32 v[186:187], v[194:195], v[208:209], v[186:187] op_sel_hi:[1,0,1]
    v_pk_fma_f32 v[188:189], v[192:193], v[212:213], v[188:189] op_sel_hi:[1,0,1]
    v_pk_fma_f32 v[190:191], v[194:195], v[212:213], v[190:191] op_sel_hi:[1,0,1]
    v_pk_mul_f32 v[144:145], v[184:185], v[184:185]
    s_add_u32 m0, s81, 86016
    s_mov_b32 s54, 372736
    buffer_load_dwordx4 v6, s[24:27], s54 offen lds
    v_pk_mul_f32 v[146:147], v[186:187], v[186:187]
    v_pk_mul_f32 v[148:149], v[188:189], v[188:189]
    v_pk_mul_f32 v[150:151], v[190:191], v[190:191]
    v_pk_fma_f32 v[144:145], v[144:145], v[210:211], v[208:209] op_sel:[0,0,1] op_sel_hi:[1,0,1]
    v_pk_fma_f32 v[146:147], v[146:147], v[210:211], v[208:209] op_sel:[0,0,1] op_sel_hi:[1,0,1]
    v_pk_fma_f32 v[148:149], v[148:149], v[214:215], v[212:213] op_sel:[0,0,1] op_sel_hi:[1,0,1]
    v_pk_fma_f32 v[150:151], v[150:151], v[214:215], v[212:213] op_sel:[0,0,1] op_sel_hi:[1,0,1]
    v_pk_mul_f32 v[144:145], v[184:185], v[144:145]
    v_pk_mul_f32 v[146:147], v[186:187], v[146:147]
    v_pk_mul_f32 v[148:149], v[188:189], v[148:149]
    v_pk_mul_f32 v[150:151], v[190:191], v[150:151]
    v_exp_f32 v144, v144
    v_exp_f32 v145, v145
    v_exp_f32 v146, v146
    v_exp_f32 v147, v147
    v_exp_f32 v148, v148
    v_exp_f32 v149, v149
    v_exp_f32 v150, v150
    v_exp_f32 v151, v151
    v_pk_fma_f32 v[144:145], v[144:145], v[210:211], v[210:211] op_sel:[0,1,1] op_sel_hi:[1,1,1]
    v_pk_fma_f32 v[146:147], v[146:147], v[210:211], v[210:211] op_sel:[0,1,1] op_sel_hi:[1,1,1]
    v_pk_fma_f32 v[148:149], v[148:149], v[214:215], v[214:215] op_sel:[0,1,1] op_sel_hi:[1,1,1]
    v_pk_fma_f32 v[150:151], v[150:151], v[214:215], v[214:215] op_sel:[0,1,1] op_sel_hi:[1,1,1]
    v_rcp_f32 v144, v144
    v_rcp_f32 v145, v145
    v_rcp_f32 v146, v146
    v_rcp_f32 v147, v147
    v_rcp_f32 v148, v148
    v_rcp_f32 v149, v149
    v_rcp_f32 v150, v150
    v_rcp_f32 v151, v151
    v_pk_mul_f32 v[144:145], v[184:185], v[144:145]
    v_pk_mul_f32 v[146:147], v[186:187], v[146:147]
    v_pk_mul_f32 v[148:149], v[188:189], v[148:149]
    v_pk_mul_f32 v[150:151], v[190:191], v[150:151]
    v_cvt_pk_bf16_f32 v140, v144, v145
    v_cvt_pk_bf16_f32 v141, v146, v147
    v_cvt_pk_bf16_f32 v142, v148, v149
    v_cvt_pk_bf16_f32 v143, v150, v151
    s_mov_b32 s56, 28672
    v_permlane32_swap_b32 v140, v142
    v_permlane32_swap_b32 v141, v143
    buffer_store_dwordx4 v[140:143], v243, s[40:43], s56 offen
    s_waitcnt lgkmcnt(0)
    s_and_b32 s71, s50, 0
    s_add_u32 m0, s60, 90112
    s_add_u32 s54, s76, 0
    buffer_load_dwordx4 v7, s[28:31], s54 offen offset:0 lds
    s_lshl_b32 s71, s71, 1
    s_xor_b32 s71, s71, s48
    s_mul_i32 s56, s71, 401408
    s_sub_u32 s56, s56, s60
    v_add_u32 v6, s56, v6
    v_lshlrev_b32 v176, 16, v216
    v_and_b32 v177, 0xffff0000, v216
    v_lshlrev_b32 v178, 16, v217
    s_add_u32 s54, s76, 56320
    buffer_load_dwordx4 v7, s[28:31], s54 offen offset:1024 lds
    v_and_b32 v179, 0xffff0000, v217
    v_lshlrev_b32 v180, 16, v218
    v_and_b32 v181, 0xffff0000, v218
    v_lshlrev_b32 v182, 16, v219
    v_and_b32 v183, 0xffff0000, v219
    v_lshlrev_b32 v184, 16, v220
    v_and_b32 v185, 0xffff0000, v220
    v_lshlrev_b32 v186, 16, v221
    s_add_u32 s54, s76, 112640
    buffer_load_dwordx4 v7, s[28:31], s54 offen offset:2048 lds
    v_and_b32 v187, 0xffff0000, v221
    v_lshlrev_b32 v188, 16, v222
    v_and_b32 v189, 0xffff0000, v222
    v_lshlrev_b32 v190, 16, v223
    v_and_b32 v191, 0xffff0000, v223
    v_pk_add_f32 v[176:177], v[176:177], v[246:247] op_sel_hi:[1,0]
    v_pk_add_f32 v[178:179], v[178:179], v[246:247] op_sel_hi:[1,0]
    v_pk_add_f32 v[180:181], v[180:181], v[246:247] op_sel_hi:[1,0]
    s_add_u32 s54, s76, 168960
    buffer_load_dwordx4 v7, s[28:31], s54 offen offset:3072 lds
    v_pk_add_f32 v[182:183], v[182:183], v[246:247] op_sel_hi:[1,0]
    v_pk_add_f32 v[184:185], v[184:185], v[246:247] op_sel_hi:[1,0]
    v_pk_add_f32 v[186:187], v[186:187], v[246:247] op_sel_hi:[1,0]
    v_pk_add_f32 v[188:189], v[188:189], v[246:247] op_sel_hi:[1,0]
    v_pk_add_f32 v[190:191], v[190:191], v[246:247] op_sel_hi:[1,0]
    v_pk_mul_f32 v[176:177], v[176:177], v[246:247] op_sel:[0,1] op_sel_hi:[1,1]
    v_pk_mul_f32 v[178:179], v[178:179], v[246:247] op_sel:[0,1] op_sel_hi:[1,1]
    v_pk_mul_f32 v[180:181], v[180:181], v[246:247] op_sel:[0,1] op_sel_hi:[1,1]
    v_pk_mul_f32 v[182:183], v[182:183], v[246:247] op_sel:[0,1] op_sel_hi:[1,1]
    s_add_u32 m0, s60, 94208
    s_add_u32 s54, s76, 229376
    buffer_load_dwordx4 v7, s[28:31], s54 offen offset:0 lds
    v_pk_mul_f32 v[184:185], v[184:185], v[246:247] op_sel:[0,1] op_sel_hi:[1,1]
    v_pk_mul_f32 v[186:187], v[186:187], v[246:247] op_sel:[0,1] op_sel_hi:[1,1]
    v_pk_mul_f32 v[188:189], v[188:189], v[246:247] op_sel:[0,1] op_sel_hi:[1,1]
    v_pk_mul_f32 v[190:191], v[190:191], v[246:247] op_sel:[0,1] op_sel_hi:[1,1]
    v_accvgpr_write_b32 a224, v176
    v_accvgpr_write_b32 a225, v177
    v_accvgpr_write_b32 a226, v178
    v_accvgpr_write_b32 a227, v179
    s_add_u32 s54, s76, 285696
    buffer_load_dwordx4 v7, s[28:31], s54 offen offset:1024 lds
    v_accvgpr_write_b32 a228, v180
    v_accvgpr_write_b32 a229, v181
    v_accvgpr_write_b32 a230, v182
    v_accvgpr_write_b32 a231, v183
    v_accvgpr_write_b32 a232, v184
    v_accvgpr_write_b32 a233, v185
    v_accvgpr_write_b32 a234, v186
    v_accvgpr_write_b32 a235, v187
    s_add_u32 s54, s76, 342016
    buffer_load_dwordx4 v7, s[28:31], s54 offen offset:2048 lds
    v_accvgpr_write_b32 a236, v188
    v_accvgpr_write_b32 a237, v189
    v_accvgpr_write_b32 a238, v190
    v_accvgpr_write_b32 a239, v191
    s_and_b32 s56, s61, 0xfffffbff
    v_add_u32 v228, s56, v2
    v_add_u32 v12, 118784, v3
    v_add_u32 v4, 61440, v3
    s_waitcnt vmcnt(7)
    s_mov_b64 exec, 15
    buffer_store_dword v13, v251, s[40:43], s3 offen
    s_mov_b64 exec, -1
    s_barrier
    ds_read_b64_tr_b16 a[0:1], v12 offset:0
    ds_read_b64_tr_b16 a[2:3], v12 offset:1024
    ds_read_b64_tr_b16 a[4:5], v12 offset:2048
    ds_read_b64_tr_b16 a[6:7], v12 offset:3072
    ds_read_b64_tr_b16 a[8:9], v12 offset:4096
    ds_read_b64_tr_b16 a[10:11], v12 offset:5120
    ds_read_b64_tr_b16 a[12:13], v12 offset:6144
    ds_read_b64_tr_b16 a[14:15], v12 offset:7168
    ds_read_b64_tr_b16 a[16:17], v12 offset:8192
    ds_read_b64_tr_b16 a[18:19], v12 offset:9216
    ds_read_b64_tr_b16 a[20:21], v12 offset:10240
    ds_read_b64_tr_b16 a[22:23], v12 offset:11264
    ds_read_b64_tr_b16 a[24:25], v12 offset:12288
    ds_read_b64_tr_b16 a[26:27], v12 offset:13312
    ds_read_b64_tr_b16 a[28:29], v12 offset:14336
    ds_read_b64_tr_b16 a[30:31], v12 offset:15360
    ds_read_b64_tr_b16 a[32:33], v12 offset:16384
    ds_read_b64_tr_b16 a[34:35], v12 offset:17408
    ds_read_b64_tr_b16 a[36:37], v12 offset:18432
    ds_read_b64_tr_b16 a[38:39], v12 offset:19456
    ds_read_b64_tr_b16 a[40:41], v12 offset:20480
    ds_read_b64_tr_b16 a[42:43], v12 offset:21504
    ds_read_b64_tr_b16 a[44:45], v12 offset:22528
    ds_read_b64_tr_b16 a[46:47], v12 offset:23552
    ds_read_b64_tr_b16 a[48:49], v12 offset:24576
    ds_read_b64_tr_b16 a[50:51], v12 offset:25600
    ds_read_b64_tr_b16 a[52:53], v12 offset:26624
    ds_read_b64_tr_b16 a[54:55], v12 offset:27648
    s_lshl_b32 s101, s48, 6
    s_add_u32 s101, s101, s3
    s_load_dwordx8 s[4:11], s[40:41], s101
    ds_read_b64_tr_b16 a[56:57], v4 offset:0
    ds_read_b64_tr_b16 a[58:59], v4 offset:1024
    ds_read_b64_tr_b16 a[60:61], v4 offset:2048
    ds_read_b64_tr_b16 a[62:63], v4 offset:3072
    ds_read_b64_tr_b16 a[64:65], v4 offset:4096
    ds_read_b64_tr_b16 a[66:67], v4 offset:5120
    ds_read_b64_tr_b16 a[68:69], v4 offset:6144
    ds_read_b64_tr_b16 a[70:71], v4 offset:7168
    ds_read_b64_tr_b16 a[72:73], v4 offset:8192
    ds_read_b64_tr_b16 a[74:75], v4 offset:9216
    ds_read_b64_tr_b16 a[76:77], v4 offset:10240
    ds_read_b64_tr_b16 a[78:79], v4 offset:11264
    ds_read_b64_tr_b16 a[80:81], v4 offset:12288
    ds_read_b64_tr_b16 a[82:83], v4 offset:13312
    ds_read_b64_tr_b16 a[84:85], v4 offset:14336
    ds_read_b64_tr_b16 a[86:87], v4 offset:15360
    s_mov_b32 s55, 0
L_cl4:
    s_waitcnt lgkmcnt(0)
    s_mov_b32 s11, s10
    s_and_b64 s[20:21], s[4:5], s[6:7]
    s_or_b64 s[22:23], s[4:5], s[6:7]
    s_and_b64 s[20:21], s[20:21], s[8:9]
    s_or_b64 s[22:23], s[22:23], s[8:9]
    s_and_b64 s[20:21], s[20:21], s[10:11]
    s_or_b64 s[22:23], s[22:23], s[10:11]
    s_and_b32 s20, s20, s21
    s_or_b32 s21, s22, s23
    s_cmp_eq_u64 s[20:21], s[64:65]
    s_cbranch_scc1 L_ce5
    s_add_u32 s55, s55, 1
    s_cmp_eq_u32 s55, 4
    s_cbranch_scc1 L_cv7
    s_add_u32 s101, s101, 256
    s_load_dwordx8 s[4:11], s[40:41], s101
    s_branch L_cl4
L_cv7:
    v_and_b32 v9, 15, v1
    v_min_u32 v9, 6, v9
    v_and_b32 v250, 48, v1
    v_add_lshl_u32 v9, v9, v250, 2
    v_add_u32 v9, s3, v9
    v_subrev_u32 v9, 16, v9
    s_mov_b32 s55, 0
L_spin8:
    buffer_load_dword v250, v9, s[40:43], 0 offen offset:16 sc1
    s_waitcnt vmcnt(0)
    v_cmp_ne_u32 vcc, s65, v250
    s_cbranch_vccz L_spun9
    s_add_u32 s55, s55, 1
    s_cmp_lt_u32 s55, 1048576
    s_cbranch_scc1 L_spin8
L_spun9:
L_ce5:
    s_barrier
    s_add_u32 m0, s61, 0
    s_nop 0
    buffer_load_dwordx4 v252, s[40:43], 0 offen offset:0 sc1 lds
    buffer_load_dwordx4 v252, s[40:43], 0 offen offset:2048 sc1 lds
    s_add_u32 m0, s61, 4096
    s_mov_b32 s54, 4096
    buffer_load_dwordx4 v252, s[40:43], s54 offen offset:0 sc1 lds
    ds_read_b64_tr_b16 a[88:89], v4 offset:16384
    buffer_load_dwordx4 v252, s[40:43], s54 offen offset:2048 sc1 lds
    ds_read_b64_tr_b16 a[90:91], v4 offset:17408
    ds_read_b64_tr_b16 a[92:93], v4 offset:18432
    s_add_u32 m0, s61, 8192
    s_mov_b32 s54, 8192
    buffer_load_dwordx4 v252, s[40:43], s54 offen offset:0 sc1 lds
    ds_read_b64_tr_b16 a[94:95], v4 offset:19456
    ds_read_b64_tr_b16 a[96:97], v4 offset:20480
    buffer_load_dwordx4 v252, s[40:43], s54 offen offset:2048 sc1 lds
    ds_read_b64_tr_b16 a[98:99], v4 offset:21504
    ds_read_b64_tr_b16 a[100:101], v4 offset:22528
    ds_read_b64_tr_b16 a[102:103], v4 offset:23552
    s_add_u32 m0, s61, 12288
    s_mov_b32 s54, 12288
    buffer_load_dwordx4 v252, s[40:43], s54 offen offset:0 sc1 lds
    ds_read_b64_tr_b16 a[104:105], v4 offset:24576
    ds_read_b64_tr_b16 a[106:107], v4 offset:25600
    buffer_load_dwordx4 v252, s[40:43], s54 offen offset:2048 sc1 lds
    ds_read_b64_tr_b16 a[108:109], v4 offset:26624
    ds_read_b64_tr_b16 a[110:111], v4 offset:27648
    s_waitcnt lgkmcnt(0)
    s_waitcnt vmcnt(5)
    s_barrier
    ds_read_b128 v[128:131], v228 offset:0
    ds_read_b128 v[132:135], v228 offset:1024
    ds_read_b128 v[136:139], v228 offset:2048
    ds_read_b128 v[140:143], v228 offset:3072
    s_waitcnt lgkmcnt(3)
    v_mfma_f32_32x32x16_bf16 v[176:191], a[0:3], v[128:131], v[176:191]
    ds_read_b128 v[128:131], v228 offset:4096
    s_add_u32 m0, s61, 16384
    s_mov_b32 s54, 16384
    buffer_load_dwordx4 v252, s[40:43], s54 offen offset:0 sc1 lds
    s_waitcnt lgkmcnt(3)
    v_mfma_f32_32x32x16_bf16 v[176:191], a[4:7], v[132:135], v[176:191]
    v_lshlrev_b32 v160, 16, v216
    v_and_b32 v161, 0xffff0000, v216
    buffer_load_dwordx4 v252, s[40:43], s54 offen offset:2048 sc1 lds
    v_add_u32 v10, 90112, v5
    ds_read_b128 v[132:135], v228 offset:5120
    s_waitcnt lgkmcnt(3)
    v_mfma_f32_32x32x16_bf16 v[176:191], a[8:11], v[136:139], v[176:191]
    ds_read_b64_tr_b16 v[16:17], v10 offset:0
    v_lshlrev_b32 v162, 16, v217
    v_and_b32 v163, 0xffff0000, v217
    v_lshlrev_b32 v164, 16, v218
    s_waitcnt vmcnt(3)
    s_barrier
    ds_read_b128 v[136:139], v228 offset:6144
    s_waitcnt lgkmcnt(4)
    v_mfma_f32_32x32x16_bf16 v[176:191], a[12:15], v[140:143], v[176:191]
    ds_read_b64_tr_b16 v[18:19], v10 offset:512
    ds_read_b128 v[140:143], v228 offset:7168
    v_and_b32 v165, 0xffff0000, v218
    s_add_u32 m0, s61, 20480
    s_mov_b32 s54, 20480
    buffer_load_dwordx4 v252, s[40:43], s54 offen offset:0 sc1 lds
    s_waitcnt lgkmcnt(5)
    v_mfma_f32_32x32x16_bf16 v[176:191], a[16:19], v[128:131], v[176:191]
    ds_read_b64_tr_b16 v[20:21], v10 offset:1024
    ds_read_b128 v[128:131], v228 offset:8192
    v_lshlrev_b32 v166, 16, v219
    v_and_b32 v167, 0xffff0000, v219
    v_lshlrev_b32 v168, 16, v220
    buffer_load_dwordx4 v252, s[40:43], s54 offen offset:2048 sc1 lds
    s_waitcnt lgkmcnt(6)
    v_mfma_f32_32x32x16_bf16 v[176:191], a[20:23], v[132:135], v[176:191]
    ds_read_b64_tr_b16 v[22:23], v10 offset:1536
    ds_read_b128 v[132:135], v228 offset:9216
    v_and_b32 v169, 0xffff0000, v220
    v_lshlrev_b32 v170, 16, v221
    v_and_b32 v171, 0xffff0000, v221
    v_lshlrev_b32 v172, 16, v222
    v_and_b32 v173, 0xffff0000, v222
    s_waitcnt lgkmcnt(6)
    v_mfma_f32_32x32x16_bf16 v[176:191], a[24:27], v[136:139], v[176:191]
    ds_read_b64_tr_b16 v[24:25], v10 offset:2048
    ds_read_b128 v[136:139], v228 offset:10240
    v_lshlrev_b32 v174, 16, v223
    s_add_u32 m0, s61, 24576
    s_branch L_pggs1
.p2align 12
L_pgg1:
    s_branch L_pggret
L_pggs1:
    s_mov_b32 s54, 24576
    buffer_load_dwordx4 v252, s[40:43], s54 offen offset:0 sc1 lds
    s_waitcnt lgkmcnt(6)
    v_mfma_f32_32x32x16_bf16 v[176:191], a[28:31], v[140:143], v[176:191]
    ds_read_b64_tr_b16 v[26:27], v10 offset:2560
    ds_read_b128 v[140:143], v228 offset:11264
    v_and_b32 v175, 0xffff0000, v223
    v_mov_b32 v208, 0
    v_mov_b32 v209, 0
    buffer_load_dwordx4 v252, s[40:43], s54 offen offset:2048 sc1 lds
    s_waitcnt lgkmcnt(6)
    v_mfma_f32_32x32x16_bf16 v[176:191], a[32:35], v[128:131], v[176:191]
    ds_read_b64_tr_b16 v[28:29], v10 offset:3072
    ds_read_b128 v[128:131], v228 offset:12288
    v_lshrrev_b32 v153, 4, v1
    v_and_b32 v152, 15, v1
    v_xor_b32 v148, v153, v152
    v_and_b32 v148, 1, v148
    v_subrev_u32 v148, 1, v148
    s_waitcnt lgkmcnt(6)
    v_mfma_f32_32x32x16_bf16 v[176:191], a[36:39], v[132:135], v[176:191]
    ds_read_b64_tr_b16 v[30:31], v10 offset:3584
    ds_read_b128 v[132:135], v228 offset:13312
    v_and_b32 v148, s63, v148
    v_mov_b32 v149, v148
    v_mov_b32 v150, v148
    v_mov_b32 v151, v148
    s_mul_i32 s56, s52, 114688
    s_waitcnt lgkmcnt(6)
    v_mfma_f32_32x32x16_bf16 v[176:191], a[40:43], v[136:139], v[176:191]
    ds_read_b64_tr_b16 v[32:33], v10 offset:4096
    s_add_u32 m0, s60, 118784
    s_add_u32 s54, s77, 0
    buffer_load_dwordx4 v7, s[28:31], s54 offen offset:0 lds
    s_waitcnt vmcnt(4)
    s_barrier
    ds_read_b128 v[136:139], v228 offset:14336
    s_waitcnt lgkmcnt(6)
    v_mfma_f32_32x32x16_bf16 v[176:191], a[44:47], v[140:143], v[176:191]
    ds_read_b64_tr_b16 v[34:35], v10 offset:4608
    ds_read_b128 v[140:143], v228 offset:15360
    s_add_u32 s54, s77, 56320
    buffer_load_dwordx4 v7, s[28:31], s54 offen offset:1024 lds
    s_add_u32 s56, s56, s80
    s_waitcnt lgkmcnt(6)
    v_mfma_f32_32x32x16_bf16 v[176:191], a[48:51], v[128:131], v[176:191]
    ds_read_b64_tr_b16 v[36:37], v10 offset:5120
    ds_read_b128 v[128:131], v228 offset:16384
    s_add_u32 s54, s77, 112640
    buffer_load_dwordx4 v7, s[28:31], s54 offen offset:2048 lds
    v_add_u32 v240, s56, v2
    v_add_u32 v241, 61440, v2
    s_waitcnt lgkmcnt(6)
    v_mfma_f32_32x32x16_bf16 v[176:191], a[52:55], v[132:135], v[176:191]
    ds_read_b64_tr_b16 v[38:39], v10 offset:5632
    ds_read_b128 v[132:135], v228 offset:17408
    s_add_u32 s54, s77, 168960
    buffer_load_dwordx4 v7, s[28:31], s54 offen offset:3072 lds
    s_lshl_b32 s56, s52, 2
    s_add_u32 s56, s56, s48
    s_waitcnt lgkmcnt(6)
    v_mfma_f32_32x32x16_bf16 v[176:191], a[56:59], v[136:139], v[176:191]
    ds_read_b64_tr_b16 v[40:41], v10 offset:6144
    ds_read_b128 v[136:139], v228 offset:18432
    s_mul_i32 s56, s56, 3584
    s_add_u32 s56, s56, 4194304
    v_lshl_add_u32 v242, v1, 2, s56
    v_and_b32 v243, 31, v1
    v_lshlrev_b32 v243, 4, v243
    s_waitcnt lgkmcnt(6)
    v_mfma_f32_32x32x16_bf16 v[176:191], a[60:63], v[140:143], v[176:191]
    ds_read_b64_tr_b16 v[42:43], v10 offset:6656
    ds_read_b128 v[140:143], v228 offset:19456
    s_add_u32 m0, s60, 122880
    s_add_u32 s54, s77, 229376
    buffer_load_dwordx4 v7, s[28:31], s54 offen offset:0 lds
    v_add_u32 v243, 147456, v243
    s_waitcnt lgkmcnt(6)
    v_mfma_f32_32x32x16_bf16 v[176:191], a[64:67], v[128:131], v[176:191]
    ds_read_b128 v[128:131], v228 offset:20480
    s_add_u32 s54, s77, 285696
    buffer_load_dwordx4 v7, s[28:31], s54 offen offset:1024 lds
    s_lshl_b32 s56, s51, 13
    s_add_u32 s56, s56, s75
    v_add_u32 v244, s56, v2
    s_waitcnt lgkmcnt(5)
    v_mfma_f32_32x32x16_bf16 v[176:191], a[68:71], v[132:135], v[176:191]
    ds_read_b128 v[132:135], v228 offset:21504
    s_add_u32 s54, s77, 342016
    buffer_load_dwordx4 v7, s[28:31], s54 offen offset:2048 lds
    s_mul_i32 s56, s52, 458752
    s_mul_i32 s57, s52, 114688
    s_waitcnt lgkmcnt(4)
    v_mfma_f32_32x32x16_bf16 v[176:191], a[72:75], v[136:139], v[176:191]
    s_add_u32 s24, s56, 8912896
    s_add_u32 s25, s57, 65536
    s_add_u32 s26, s56, 9142272
    s_add_u32 s27, s57, 2097152
    s_add_u32 s3, s97, 16384
    s_waitcnt vmcnt(7)
    s_barrier
    ds_read_b128 v[136:139], v228 offset:22528
    s_waitcnt lgkmcnt(3)
    v_mfma_f32_32x32x16_bf16 v[176:191], a[76:79], v[140:143], v[176:191]
    ds_read_b128 v[140:143], v228 offset:23552
    s_add_u32 m0, s60, 61440
    s_add_u32 s54, s78, 0
    buffer_load_dwordx4 v7, s[28:31], s54 offen offset:0 lds
    s_lshl_b32 s56, s48, 7
    s_waitcnt lgkmcnt(3)
    v_mfma_f32_32x32x16_bf16 v[176:191], a[80:83], v[128:131], v[176:191]
    ds_read_b128 v[128:131], v228 offset:24576
    s_add_u32 s54, s78, 56320
    buffer_load_dwordx4 v7, s[28:31], s54 offen offset:1024 lds
    s_add_u32 s56, s56, 149504
    v_add_u32 v236, 1, v152
    v_and_b32 v237, 1, v236
    s_waitcnt lgkmcnt(3)
    v_mfma_f32_32x32x16_bf16 v[176:191], a[84:87], v[132:135], v[176:191]
    ds_read_b128 v[132:135], v228 offset:25600
    s_add_u32 s54, s78, 112640
    buffer_load_dwordx4 v7, s[28:31], s54 offen offset:2048 lds
    v_mul_u32_u24 v237, 4160, v237
    v_and_b32 v236, 30, v236
    v_lshl_add_u32 v236, v153, 3, v236
    s_waitcnt lgkmcnt(3)
    v_mfma_f32_32x32x16_bf16 v[176:191], a[88:91], v[136:139], v[176:191]
    ds_read_b128 v[136:139], v228 offset:26624
    s_add_u32 s54, s78, 168960
    buffer_load_dwordx4 v7, s[28:31], s54 offen offset:3072 lds
    v_lshl_add_u32 v236, v236, 1, v237
    v_add_u32 v232, s56, v236
    v_lshlrev_b32 v236, 4, v153
    s_waitcnt lgkmcnt(3)
    v_mfma_f32_32x32x16_bf16 v[176:191], a[92:95], v[140:143], v[176:191]
    ds_read_b128 v[140:143], v228 offset:27648
    v_lshlrev_b32 v237, 5, v152
    v_sub_u32 v236, v236, v237
    v_add_u32 v236, 8800, v236
    v_add_u32 v246, s56, v236
    s_mov_b32 s98, 0x06543210
    s_mov_b32 s99, 0x10654321
    s_waitcnt lgkmcnt(3)
    v_mfma_f32_32x32x16_bf16 v[176:191], a[96:99], v[128:131], v[176:191]
    s_add_u32 m0, s60, 65536
    s_add_u32 s54, s78, 229376
    buffer_load_dwordx4 v7, s[28:31], s54 offen offset:0 lds
    s_and_b32 s56, s49, 28
    s_lshr_b64 s[98:99], s[98:99], s56
    s_bfe_u32 s90, s98, 196608
    s_waitcnt lgkmcnt(2)
    v_mfma_f32_32x32x16_bf16 v[176:191], a[100:103], v[132:135], v[176:191]
    s_add_u32 s54, s78, 285696
    buffer_load_dwordx4 v7, s[28:31], s54 offen offset:1024 lds
    s_mul_i32 s90, s90, 57344
    s_bfe_u32 s91, s98, 196612
    s_mul_i32 s91, s91, 57344
    s_bfe_u32 s92, s98, 196616
    s_waitcnt lgkmcnt(1)
    v_mfma_f32_32x32x16_bf16 v[176:191], a[104:107], v[136:139], v[176:191]
    s_add_u32 s54, s78, 342016
    buffer_load_dwordx4 v7, s[28:31], s54 offen offset:2048 lds
    s_mul_i32 s92, s92, 57344
    s_bfe_u32 s93, s98, 196620
    s_mul_i32 s93, s93, 57344
    s_bfe_u32 s94, s98, 196624
    s_waitcnt lgkmcnt(0)
    v_mfma_f32_32x32x16_bf16 v[176:191], a[108:111], v[140:143], v[176:191]
    s_mul_i32 s94, s94, 57344
    s_bfe_u32 s95, s98, 196628
    s_mul_i32 s95, s95, 57344
    s_bfe_u32 s96, s98, 196632
    s_mul_i32 s96, s96, 57344
    v_add_u32 v233, 1024, v232
    v_add_u32 v234, 2048, v232
    v_add_u32 v235, 3072, v232
    s_nop 3
    v_cvt_pk_bf16_f32 v200, v176, v177
    v_cvt_pk_bf16_f32 v201, v178, v179
    v_cvt_pk_bf16_f32 v202, v180, v181
    v_cvt_pk_bf16_f32 v203, v182, v183
    v_cvt_pk_bf16_f32 v204, v184, v185
    v_cvt_pk_bf16_f32 v205, v186, v187
    v_cvt_pk_bf16_f32 v206, v188, v189
    v_cvt_pk_bf16_f32 v207, v190, v191
    buffer_store_dwordx4 v[200:203], v14, s[40:43], 0 offen
    buffer_store_dwordx4 v[204:207], v14, s[40:43], 0 offen offset:1024
    v_dot2c_f32_bf16 v208, s63, v200
    v_dot2c_f32_bf16 v209, v200, v200
    v_dot2c_f32_bf16 v208, s63, v201
    v_dot2c_f32_bf16 v209, v201, v201
    v_dot2c_f32_bf16 v208, s63, v202
    v_dot2c_f32_bf16 v209, v202, v202
    v_dot2c_f32_bf16 v208, s63, v203
    v_dot2c_f32_bf16 v209, v203, v203
    v_dot2c_f32_bf16 v208, s63, v204
    v_dot2c_f32_bf16 v209, v204, v204
    v_dot2c_f32_bf16 v208, s63, v205
    v_dot2c_f32_bf16 v209, v205, v205
    v_dot2c_f32_bf16 v208, s63, v206
    v_dot2c_f32_bf16 v209, v206, v206
    v_dot2c_f32_bf16 v208, s63, v207
    v_dot2c_f32_bf16 v209, v207, v207
    s_nop 2
    v_permlane32_swap_b32 v208, v209
    v_add_f32 v208, v208, v209
    buffer_store_dword v208, v15, s[40:43], 0 offen
    v_pk_add_f32 v[176:177], v[176:177], v[160:161]
    v_pk_add_f32 v[178:179], v[178:179], v[162:163]
    v_pk_add_f32 v[180:181], v[180:181], v[164:165]
    v_pk_add_f32 v[182:183], v[182:183], v[166:167]
    v_pk_add_f32 v[184:185], v[184:185], v[168:169]
    v_pk_add_f32 v[186:187], v[186:187], v[170:171]
    v_pk_add_f32 v[188:189], v[188:189], v[172:173]
    v_pk_add_f32 v[190:191], v[190:191], v[174:175]
    v_accvgpr_write_b32 a240, v176
    v_accvgpr_write_b32 a241, v177
    v_accvgpr_write_b32 a242, v178
    v_accvgpr_write_b32 a243, v179
    v_accvgpr_write_b32 a244, v180
    v_accvgpr_write_b32 a245, v181
    v_accvgpr_write_b32 a246, v182
    v_accvgpr_write_b32 a247, v183
    v_accvgpr_write_b32 a248, v184
    v_accvgpr_write_b32 a249, v185
    v_accvgpr_write_b32 a250, v186
    v_accvgpr_write_b32 a251, v187
    v_accvgpr_write_b32 a252, v188
    v_accvgpr_write_b32 a253, v189
    v_accvgpr_write_b32 a254, v190
    v_accvgpr_write_b32 a255, v191
    v_lshrrev_b32 v247, 3, v1
    s_bfe_u32 s56, s53, 0x20004
    s_lshl_b32 s56, s56, 2
    s_sub_u32 s56, s56, s81
    s_add_u32 s56, s56, 31744
    v_lshl_add_u32 v247, v247, 7, s56
    s_and_b32 s56, s53, 1
    s_lshl_b32 s56, s56, 4
    s_lshr_b32 s68, s68, s56
    s_and_b32 s68, s68, 0xffff
    s_min_u32 s56, s48, 1
    s_lshl_b32 s56, s56, 4
    s_lshr_b32 s68, s68, s56
    v_lshl_add_u32 v252, v153, 3, v152
    v_sub_u32 v252, 15, v252
    v_and_b32 v248, 1, v252
    v_lshlrev_b32 v248, 4, v248
    v_lshlrev_b32 v248, v248, s68
    v_lshrrev_b32 v252, 1, v252
    v_cmp_eq_u32 s[4:5], 0, v252
    v_cmp_eq_u32 s[6:7], 1, v252
    v_cmp_eq_u32 s[8:9], 2, v252
    v_cmp_eq_u32 s[10:11], 3, v252
    v_cndmask_b32 v236, 0, v248, s[4:5]
    v_cndmask_b32 v237, 0, v248, s[6:7]
    v_cndmask_b32 v238, 0, v248, s[8:9]
    v_cndmask_b32 v239, 0, v248, s[10:11]
    s_waitcnt vmcnt(0)
    s_mov_b64 exec, 15
    buffer_store_dword v13, v11, s[40:43], s89 offen
    s_mov_b64 exec, -1
    s_add_u32 m0, s60, 90112
    s_add_u32 s54, s79, 0
    buffer_load_dwordx4 v7, s[28:31], s54 offen offset:0 lds
    s_add_u32 s54, s79, 56320
    buffer_load_dwordx4 v7, s[28:31], s54 offen offset:1024 lds
    s_add_u32 s54, s79, 112640
    buffer_load_dwordx4 v7, s[28:31], s54 offen offset:2048 lds
    s_add_u32 s54, s79, 168960
    buffer_load_dwordx4 v7, s[28:31], s54 offen offset:3072 lds
    s_add_u32 m0, s60, 94208
    s_add_u32 s54, s79, 229376
    buffer_load_dwordx4 v7, s[28:31], s54 offen offset:0 lds
    s_add_u32 s54, s79, 285696
    buffer_load_dwordx4 v7, s[28:31], s54 offen offset:1024 lds
    s_add_u32 s54, s79, 342016
    buffer_load_dwordx4 v7, s[28:31], s54 offen offset:2048 lds
    v_mfma_f32_16x16x32_bf16 v[144:147], v[148:151], v[16:19], 0
    v_add_u32 v10, 118784, v5
    ds_read_b64_tr_b16 v[44:45], v10 offset:0
    ds_read_b64_tr_b16 v[46:47], v10 offset:512
    v_mfma_f32_16x16x32_bf16 v[144:147], v[148:151], v[20:23], v[144:147]
    ds_read_b64_tr_b16 v[48:49], v10 offset:1024
    ds_read_b64_tr_b16 v[50:51], v10 offset:1536
    v_mfma_f32_16x16x32_bf16 v[144:147], v[148:151], v[24:27], v[144:147]
    ds_read_b64_tr_b16 v[52:53], v10 offset:2048
    ds_read_b64_tr_b16 v[54:55], v10 offset:2560
    v_mfma_f32_16x16x32_bf16 v[144:147], v[148:151], v[28:31], v[144:147]
    ds_read_b64_tr_b16 v[56:57], v10 offset:3072
    ds_read_b64_tr_b16 v[58:59], v10 offset:3584
    v_mfma_f32_16x16x32_bf16 v[144:147], v[148:151], v[32:35], v[144:147]
    ds_read_b64_tr_b16 v[60:61], v10 offset:4096
    ds_read_b64_tr_b16 v[62:63], v10 offset:4608
    v_mfma_f32_16x16x32_bf16 v[144:147], v[148:151], v[36:39], v[144:147]
    ds_read_b64_tr_b16 v[64:65], v10 offset:5120
    ds_read_b64_tr_b16 v[66:67], v10 offset:5632
    v_mfma_f32_16x16x32_bf16 v[144:147], v[148:151], v[40:43], v[144:147]
    ds_read_b64_tr_b16 v[68:69], v10 offset:6144
    ds_read_b64_tr_b16 v[70:71], v10 offset:6656
    s_waitcnt lgkmcnt(0)
    v_mfma_f32_16x16x32_bf16 v[144:147], v[148:151], v[44:47], v[144:147]
    v_add_u32 v10, 61440, v5
    ds_read_b64_tr_b16 v[72:73], v10 offset:0
    ds_read_b64_tr_b16 v[74:75], v10 offset:512
    v_mfma_f32_16x16x32_bf16 v[144:147], v[148:151], v[48:51], v[144:147]
    ds_read_b64_tr_b16 v[76:77], v10 offset:1024
    ds_read_b64_tr_b16 v[78:79], v10 offset:1536
    v_mfma_f32_16x16x32_bf16 v[144:147], v[148:151], v[52:55], v[144:147]
    ds_read_b64_tr_b16 v[80:81], v10 offset:2048
    ds_read_b64_tr_b16 v[82:83], v10 offset:2560
    v_mfma_f32_16x16x32_bf16 v[144:147], v[148:151], v[56:59], v[144:147]
    ds_read_b64_tr_b16 v[84:85], v10 offset:3072
    ds_read_b64_tr_b16 v[86:87], v10 offset:3584
    v_mfma_f32_16x16x32_bf16 v[144:147], v[148:151], v[60:63], v[144:147]
    ds_read_b64_tr_b16 v[88:89], v10 offset:4096
    ds_read_b64_tr_b16 v[90:91], v10 offset:4608
    v_mfma_f32_16x16x32_bf16 v[144:147], v[148:151], v[64:67], v[144:147]
    ds_read_b64_tr_b16 v[92:93], v10 offset:5120
    ds_read_b64_tr_b16 v[94:95], v10 offset:5632
    v_mfma_f32_16x16x32_bf16 v[144:147], v[148:151], v[68:71], v[144:147]
    ds_read_b64_tr_b16 v[96:97], v10 offset:6144
    ds_read_b64_tr_b16 v[98:99], v10 offset:6656
    s_waitcnt lgkmcnt(0)
    s_lshl_b32 s101, s48, 6
    s_add_u32 s101, s101, s89
    s_load_dwordx16 s[4:19], s[40:41], s101
    v_mfma_f32_16x16x32_bf16 v[144:147], v[148:151], v[72:75], v[144:147]
    v_bfe_u32 v128, v1, 3, 1
    v_mul_u32_u24 v128, 4160, v128
    v_mfma_f32_16x16x32_bf16 v[144:147], v[148:151], v[76:79], v[144:147]
    v_and_b32 v129, 7, v1
    v_lshl_add_u32 v128, v129, 2, v128
    v_add_u32 v128, 149504, v128
    v_mfma_f32_16x16x32_bf16 v[144:147], v[148:151], v[80:83], v[144:147]
    s_lshl_b32 s69, s69, 16
    v_mov_b32 v129, s69
    v_mfma_f32_16x16x32_bf16 v[144:147], v[148:151], v[84:87], v[144:147]
    v_cmp_eq_u32 vcc, 15, v152
    v_lshlrev_b32 v132, 3, v1
    v_mfma_f32_16x16x32_bf16 v[144:147], v[148:151], v[88:91], v[144:147]
    v_add_u32 v132, 161920, v132
    v_cndmask_b32 v129, 0, v129, vcc
    v_mfma_f32_16x16x32_bf16 v[144:147], v[148:151], v[92:95], v[144:147]
    v_mov_b32 v130, 0
    v_mov_b32 v131, 0
    v_mov_b32 v133, 0
    v_mfma_f32_16x16x32_bf16 v[144:147], v[148:151], v[96:99], v[144:147]
    v_mov_b32 v134, 0
    v_mov_b32 v135, 0
    ds_write_b32 v128, v129
    ds_write_b64 v132, v[130:131]
    s_mov_b32 s55, 0
L_cl10:
    s_waitcnt lgkmcnt(0)
    s_and_b64 s[20:21], s[4:5], s[6:7]
    s_or_b64 s[22:23], s[4:5], s[6:7]
    s_and_b64 s[20:21], s[20:21], s[8:9]
    s_or_b64 s[22:23], s[22:23], s[8:9]
    s_and_b64 s[20:21], s[20:21], s[10:11]
    s_or_b64 s[22:23], s[22:23], s[10:11]
    s_and_b64 s[20:21], s[20:21], s[12:13]
    s_or_b64 s[22:23], s[22:23], s[12:13]
    s_and_b64 s[20:21], s[20:21], s[14:15]
    s_or_b64 s[22:23], s[22:23], s[14:15]
    s_and_b64 s[20:21], s[20:21], s[16:17]
    s_or_b64 s[22:23], s[22:23], s[16:17]
    s_and_b32 s20, s20, s21
    s_or_b32 s21, s22, s23
    s_cmp_eq_u64 s[20:21], s[64:65]
    s_cbranch_scc1 L_ce11
    s_add_u32 s55, s55, 1
    s_cmp_eq_u32 s55, 4
    s_cbranch_scc1 L_cv13
    s_add_u32 s101, s101, 256
    s_load_dwordx16 s[4:19], s[40:41], s101
    s_branch L_cl10
L_cv13:
    v_and_b32 v9, 15, v1
    v_min_u32 v9, 13, v9
    v_and_b32 v250, 48, v1
    v_add_lshl_u32 v9, v9, v250, 2
    v_add_u32 v9, s89, v9
    v_subrev_u32 v9, 16, v9
    s_mov_b32 s55, 0
L_spin14:
    buffer_load_dword v250, v9, s[40:43], 0 offen offset:16 sc1
    s_waitcnt vmcnt(0)
    v_cmp_ne_u32 vcc, s65, v250
    s_cbranch_vccz L_spun15
    s_add_u32 s55, s55, 1
    s_cmp_lt_u32 s55, 1048576
    s_cbranch_scc1 L_spin14
L_spun15:
L_ce11:
    s_barrier
    s_add_u32 m0, s60, 0
    s_mov_b32 s54, 2097152
    buffer_load_dwordx4 v240, s[40:43], s54 offen sc1 lds
    buffer_load_dwordx4 v240, s[40:43], s54 offen offset:1024 sc1 lds
    s_waitcnt vmcnt(2)
    v_add_u32 v10, 90112, v5
    buffer_load_dwordx4 v240, s[40:43], s54 offen offset:2048 sc1 lds
    ds_read_b64_tr_b16 v[100:101], v10 offset:0
    ds_read_b64_tr_b16 v[102:103], v10 offset:512
    ds_read_b64_tr_b16 v[104:105], v10 offset:1024
    ds_read_b64_tr_b16 v[106:107], v10 offset:1536
    ds_read_b64_tr_b16 v[108:109], v10 offset:2048
    buffer_load_dwordx4 v240, s[40:43], s54 offen offset:3072 sc1 lds
    ds_read_b64_tr_b16 v[110:111], v10 offset:2560
    ds_read_b64_tr_b16 v[112:113], v10 offset:3072
    ds_read_b64_tr_b16 v[114:115], v10 offset:3584
    ds_read_b64_tr_b16 v[116:117], v10 offset:4096
    ds_read_b64_tr_b16 v[118:119], v10 offset:4608
    s_add_u32 m0, s60, 4096
    s_mov_b32 s54, 2101248
    buffer_load_dwordx4 v240, s[40:43], s54 offen sc1 lds
    ds_read_b64_tr_b16 v[120:121], v10 offset:5120
    ds_read_b64_tr_b16 v[122:123], v10 offset:5632
    ds_read_b64_tr_b16 v[124:125], v10 offset:6144
    ds_read_b64_tr_b16 v[126:127], v10 offset:6656
    s_waitcnt lgkmcnt(0)
    v_mfma_f32_16x16x32_bf16 v[144:147], v[148:151], v[100:103], v[144:147]
    buffer_load_dwordx4 v240, s[40:43], s54 offen offset:1024 sc1 lds
    v_mfma_f32_16x16x32_bf16 v[144:147], v[148:151], v[104:107], v[144:147]
    v_and_b32 v252, 1, v153
    v_cmp_eq_u32 s[82:83], 1, v252
    v_mfma_f32_16x16x32_bf16 v[144:147], v[148:151], v[108:111], v[144:147]
    v_lshlrev_b32 v252, 9, v252
    v_lshl_add_u32 v252, v152, 5, v252
    v_mfma_f32_16x16x32_bf16 v[144:147], v[148:151], v[112:115], v[144:147]
    buffer_load_dwordx4 v240, s[40:43], s54 offen offset:2048 sc1 lds
    v_mfma_f32_16x16x32_bf16 v[144:147], v[148:151], v[116:119], v[144:147]
    v_lshrrev_b32 v153, 1, v153
    v_lshl_add_u32 v252, v153, 4, v252
    v_mfma_f32_16x16x32_bf16 v[144:147], v[148:151], v[120:123], v[144:147]
    s_mul_i32 s70, s53, 4224
    s_add_u32 s70, s70, s81
    v_mfma_f32_16x16x32_bf16 v[144:147], v[148:151], v[124:127], v[144:147]
    v_add_u32 v252, s70, v252
    v_cmp_gt_u32 vcc, 32, v1
    v_add_u32 v3, s60, v3
    s_add_u32 m0, s60, 28672
    s_mov_b32 s54, 2125824
    buffer_load_dwordx4 v240, s[40:43], s54 offen sc1 lds
    v_xor_b32 v4, 64, v3
    v_add_u32 v10, 61440, v3
    v_add_u32 v12, 61440, v4
    v_cndmask_b32 v144, v144, v145, s[82:83]
    v_cvt_pk_bf16_f32 v128, v144, v144
    buffer_load_dwordx4 v240, s[40:43], s54 offen offset:1024 sc1 lds
    v_lshlrev_b32 v145, 16, v128
    v_sub_f32 v145, v144, v145
    v_cvt_pk_bf16_f32 v145, v145, v145
    v_cndmask_b32 v128, v145, v128, vcc
    v_mov_b32 v129, 0
    s_waitcnt vmcnt(2)
    s_barrier
    ds_read_b128 v[176:179], v2 offset:0
    ds_read_b128 v[180:183], v2 offset:1024
    ds_read_b128 v[184:187], v2 offset:2048
    ds_read_b128 v[188:191], v2 offset:3072
    ds_read_b128 v[192:195], v2 offset:4096
    ds_read_b128 v[196:199], v2 offset:5120
    ds_read_b128 v[200:203], v2 offset:6144
    buffer_load_dword v216, v242, s[40:43], 0 offen offset:0 sc1
    buffer_load_dword v217, v242, s[40:43], 0 offen offset:256 sc1
    buffer_load_dword v218, v242, s[40:43], 0 offen offset:512 sc1
    buffer_load_dword v219, v242, s[40:43], 0 offen offset:768 sc1
    buffer_load_dword v220, v242, s[40:43], 0 offen offset:1024 sc1
    buffer_load_dword v221, v242, s[40:43], 0 offen offset:1280 sc1
    s_waitcnt lgkmcnt(3)
    v_mfma_f32_32x32x16_bf16 v[144:159], v[16:19], v[176:179], 0
    ds_read_b128 v[204:207], v2 offset:7168
    buffer_load_dword v222, v242, s[40:43], 0 offen offset:1536 sc1
    buffer_load_dword v223, v242, s[40:43], 0 offen offset:1792 sc1
    v_mfma_f32_32x32x16_bf16 v[144:159], v[20:23], v[180:183], v[144:159]
    ds_read_b128 v[176:179], v2 offset:8192
    buffer_load_dword v224, v242, s[40:43], 0 offen offset:2048 sc1
    buffer_load_dword v225, v242, s[40:43], 0 offen offset:2304 sc1
    v_mfma_f32_32x32x16_bf16 v[144:159], v[24:27], v[184:187], v[144:159]
    ds_read_b128 v[180:183], v2 offset:9216
    buffer_load_dword v226, v242, s[40:43], 0 offen offset:2560 sc1
    buffer_load_dword v227, v242, s[40:43], 0 offen offset:2816 sc1
    v_mfma_f32_32x32x16_bf16 v[144:159], v[28:31], v[188:191], v[144:159]
    ds_read_b128 v[184:187], v2 offset:10240
    buffer_load_dword v228, v242, s[40:43], 0 offen offset:3072 sc1
    buffer_load_dword v229, v242, s[40:43], 0 offen offset:3328 sc1
    s_waitcnt lgkmcnt(3)
    v_mfma_f32_32x32x16_bf16 v[144:159], v[32:35], v[192:195], v[144:159]
    ds_read_b128 v[188:191], v2 offset:11264
    buffer_load_dwordx4 v240, s[40:43], s54 offen offset:2048 sc1 lds
    v_mfma_f32_32x32x16_bf16 v[144:159], v[36:39], v[196:199], v[144:159]
    ds_read_b128 v[192:195], v2 offset:12288
    buffer_load_dwordx4 v240, s[40:43], s54 offen offset:3072 sc1 lds
    v_mfma_f32_32x32x16_bf16 v[144:159], v[40:43], v[200:203], v[144:159]
    ds_read_b128 v[196:199], v2 offset:13312
    v_mfma_f32_32x32x16_bf16 v[144:159], v[44:47], v[204:207], v[144:159]
    ds_read_b128 v[200:203], v2 offset:14336
    s_add_u32 m0, s60, 32768
    s_mov_b32 s54, 2129920
    buffer_load_dwordx4 v240, s[40:43], s54 offen sc1 lds
    s_waitcnt lgkmcnt(3)
    v_mfma_f32_32x32x16_bf16 v[144:159], v[48:51], v[176:179], v[144:159]
    ds_read_b128 v[204:207], v2 offset:15360
    buffer_load_dwordx4 v240, s[40:43], s54 offen offset:1024 sc1 lds
    v_mfma_f32_32x32x16_bf16 v[144:159], v[52:55], v[180:183], v[144:159]
    ds_read_b128 v[176:179], v2 offset:16384
    v_mfma_f32_32x32x16_bf16 v[144:159], v[56:59], v[184:187], v[144:159]
    ds_read_b128 v[180:183], v2 offset:17408
    buffer_load_dwordx4 v240, s[40:43], s54 offen offset:2048 sc1 lds
    v_mfma_f32_32x32x16_bf16 v[144:159], v[60:63], v[188:191], v[144:159]
    ds_read_b128 v[184:187], v2 offset:18432
    s_waitcnt vmcnt(5)
    v_add_f32 v216, v216, v223
    v_add_f32 v217, v217, v224
    v_add_f32 v218, v218, v225
    v_add_f32 v219, v219, v226
    s_waitcnt lgkmcnt(3)
    v_mfma_f32_32x32x16_bf16 v[144:159], v[64:67], v[192:195], v[144:159]
    ds_read_b128 v[188:191], v2 offset:19456
    v_add_f32 v220, v220, v227
    v_add_f32 v221, v221, v228
    v_add_f32 v222, v222, v229
    v_add_f32 v216, v216, v219
    v_add_f32 v217, v217, v220
    v_mfma_f32_32x32x16_bf16 v[144:159], v[68:71], v[196:199], v[144:159]
    ds_read_b128 v[192:195], v2 offset:20480
    s_add_u32 m0, s60, 61440
    s_mov_b32 s54, 2154496
    buffer_load_dwordx4 v240, s[40:43], s54 offen sc1 lds
    v_add_f32 v218, v218, v221
    v_add_f32 v216, v216, v222
    v_mfma_f32_32x32x16_bf16 v[144:159], v[72:75], v[200:203], v[144:159]
    ds_read_b128 v[196:199], v2 offset:21504
    v_add_f32 v217, v217, v218
    v_add_f32 v216, v216, v217
    v_mov_b32 v217, v216
    s_lshl_b32 s56, s48, 9
    v_add_u32 v218, s56, v243
    v_mfma_f32_32x32x16_bf16 v[144:159], v[76:79], v[204:207], v[144:159]
    ds_read_b128 v[200:203], v2 offset:22528
    buffer_load_dwordx4 v240, s[40:43], s54 offen offset:1024 sc1 lds
    v_permlane32_swap_b32 v216, v217
    v_mul_f32 v219, 0xbb124925, v216
    s_waitcnt lgkmcnt(3)
    v_mfma_f32_32x32x16_bf16 v[144:159], v[80:83], v[176:179], v[144:159]
    ds_read_b128 v[204:207], v2 offset:23552
    v_mul_f32 v217, 0x3b124925, v217
    v_cvt_pk_bf16_f32 v220, v219, v219
    v_fma_f32 v217, -v219, v219, v217
    v_lshlrev_b32 v220, 16, v220
    v_max_f32 v217, 0, v217
    v_sub_f32 v220, v219, v220
    v_mfma_f32_32x32x16_bf16 v[144:159], v[84:87], v[180:183], v[144:159]
    ds_read_b128 v[176:179], v2 offset:24576
    buffer_load_dwordx4 v240, s[40:43], s54 offen offset:2048 sc1 lds
    v_add_f32 v217, 0x3727c5ac, v217
    v_cvt_pk_bf16_f32 v220, v219, v220
    v_rsq_f32 v216, v217
    v_mfma_f32_32x32x16_bf16 v[144:159], v[88:91], v[184:187], v[144:159]
    ds_read_b128 v[180:183], v2 offset:25600
    v_sqrt_f32 v223, v217
    v_mul_f32 v221, 0xc0135761, v216
    v_mul_f32 v216, v216, v216
    v_mul_f32 v216, 0x3d372713, v216
    v_mfma_f32_32x32x16_bf16 v[144:159], v[92:95], v[188:191], v[144:159]
    ds_read_b128 v[184:187], v2 offset:26624
    buffer_load_dwordx4 v240, s[40:43], s54 offen offset:3072 sc1 lds
    v_mul_f32 v222, v221, v216
    ds_write_b128 v218, v[220:223]
    s_waitcnt lgkmcnt(4)
    v_mfma_f32_32x32x16_bf16 v[144:159], v[96:99], v[192:195], v[144:159]
    ds_read_b128 v[188:191], v2 offset:27648
    s_waitcnt vmcnt(4)
    s_waitcnt lgkmcnt(1)
    s_barrier
    v_mfma_f32_32x32x16_bf16 v[144:159], v[100:103], v[196:199], v[144:159]
    ds_read_b128 v[208:211], v243 offset:0
    ds_read_b128 v[192:195], v2 offset:28672
    v_mfma_f32_32x32x16_bf16 v[144:159], v[104:107], v[200:203], v[144:159]
    ds_read_b32 v132, v243 offset:0
    ds_read_b128 v[196:199], v2 offset:29696
    s_add_u32 m0, s60, 65536
    s_mov_b32 s54, 2158592
    buffer_load_dwordx4 v240, s[40:43], s54 offen sc1 lds
    v_mfma_f32_32x32x16_bf16 v[144:159], v[108:111], v[204:207], v[144:159]
    ds_read_b128 v[200:203], v2 offset:30720
    s_waitcnt lgkmcnt(5)
    v_mfma_f32_32x32x16_bf16 v[144:159], v[112:115], v[176:179], v[144:159]
    ds_read_b128 v[204:207], v2 offset:31744
    buffer_load_dwordx4 v240, s[40:43], s54 offen offset:1024 sc1 lds
    v_mfma_f32_32x32x16_bf16 v[144:159], v[116:119], v[180:183], v[144:159]
    ds_read_b128 v[176:179], v2 offset:32768
    v_mfma_f32_32x32x16_bf16 v[144:159], v[120:123], v[184:187], v[144:159]
    ds_read_b128 v[180:183], v2 offset:33792
    buffer_load_dwordx4 v240, s[40:43], s54 offen offset:2048 sc1 lds
    v_mfma_f32_32x32x16_bf16 v[144:159], v[124:127], v[188:191], v[144:159]
    ds_read_b128 v[184:187], v2 offset:34816
    s_waitcnt lgkmcnt(6)
    v_mfma_f32_32x32x16_bf16 v[144:159], v[128:131], v[132:135], v[144:159]
    s_waitcnt lgkmcnt(3)
    v_mfma_f32_32x32x16_bf16 v[160:175], v[16:19], v[192:195], 0
    ds_read_b128 v[188:191], v2 offset:35840
    s_add_u32 m0, s60, 90112
    s_mov_b32 s54, 2183168
    buffer_load_dwordx4 v240, s[40:43], s54 offen sc1 lds
    v_mfma_f32_32x32x16_bf16 v[160:175], v[20:23], v[196:199], v[160:175]
    ds_read_b128 v[192:195], v2 offset:36864
    buffer_load_dwordx4 v240, s[40:43], s54 offen offset:1024 sc1 lds
    s_nop 2
    v_mul_f32 v216, v144, v144
    v_mul_f32 v217, v145, v145
    v_mul_f32 v218, v146, v146
    v_mul_f32 v219, v147, v147
    v_fma_f32 v216, v216, v210, v209
    v_fma_f32 v217, v217, v210, v209
    s_branch L_pggs2
.p2align 12
L_pgg2:
    s_branch L_pggret
L_pggs2:
    v_mfma_f32_32x32x16_bf16 v[160:175], v[24:27], v[200:203], v[160:175]
    ds_read_b128 v[196:199], v2 offset:37888
    v_fma_f32 v218, v218, v210, v209
    v_fma_f32 v219, v219, v210, v209
    v_mul_f32 v216, v144, v216
    v_mul_f32 v217, v145, v217
    v_mul_f32 v218, v146, v218
    v_mul_f32 v219, v147, v219
    v_exp_f32 v216, v216
    v_mfma_f32_32x32x16_bf16 v[160:175], v[28:31], v[204:207], v[160:175]
    ds_read_b128 v[200:203], v2 offset:38912
    buffer_load_dwordx4 v240, s[40:43], s54 offen offset:2048 sc1 lds
    v_exp_f32 v217, v217
    v_exp_f32 v218, v218
    s_waitcnt lgkmcnt(3)
    v_mfma_f32_32x32x16_bf16 v[160:175], v[32:35], v[176:179], v[160:175]
    ds_read_b128 v[204:207], v2 offset:39936
    v_exp_f32 v219, v219
    v_fma_f32 v216, v216, v211, v211
    v_fma_f32 v217, v217, v211, v211
    v_fma_f32 v218, v218, v211, v211
    v_fma_f32 v219, v219, v211, v211
    v_rcp_f32 v216, v216
    v_mfma_f32_32x32x16_bf16 v[160:175], v[36:39], v[180:183], v[160:175]
    ds_read_b128 v[176:179], v2 offset:40960
    buffer_load_dwordx4 v240, s[40:43], s54 offen offset:3072 sc1 lds
    v_rcp_f32 v217, v217
    v_rcp_f32 v218, v218
    v_rcp_f32 v219, v219
    v_mfma_f32_32x32x16_bf16 v[160:175], v[40:43], v[184:187], v[160:175]
    ds_read_b128 v[180:183], v2 offset:41984
    s_add_u32 m0, s60, 94208
    s_mov_b32 s54, 2187264
    buffer_load_dwordx4 v240, s[40:43], s54 offen sc1 lds
    v_mul_f32 v216, v144, v216
    v_mul_f32 v217, v145, v217
    v_mul_f32 v218, v146, v218
    v_mfma_f32_32x32x16_bf16 v[160:175], v[44:47], v[188:191], v[160:175]
    ds_read_b128 v[184:187], v2 offset:43008
    v_mul_f32 v219, v147, v219
    v_cvt_pk_bf16_f32 v224, v216, v217
    v_cvt_pk_bf16_f32 v225, v218, v219
    v_mul_f32 v220, v148, v148
    v_mul_f32 v221, v149, v149
    v_mul_f32 v222, v150, v150
    v_mul_f32 v223, v151, v151
    v_fma_f32 v220, v220, v210, v209
    s_waitcnt lgkmcnt(3)
    v_mfma_f32_32x32x16_bf16 v[160:175], v[48:51], v[192:195], v[160:175]
    ds_read_b128 v[188:191], v2 offset:44032
    buffer_load_dwordx4 v240, s[40:43], s54 offen offset:1024 sc1 lds
    v_fma_f32 v221, v221, v210, v209
    v_fma_f32 v222, v222, v210, v209
    v_fma_f32 v223, v223, v210, v209
    v_mul_f32 v220, v148, v220
    v_mul_f32 v221, v149, v221
    v_mfma_f32_32x32x16_bf16 v[160:175], v[52:55], v[196:199], v[160:175]
    ds_read_b128 v[192:195], v2 offset:45056
    v_mul_f32 v222, v150, v222
    v_mul_f32 v223, v151, v223
    v_exp_f32 v220, v220
    v_exp_f32 v221, v221
    v_exp_f32 v222, v222
    v_mfma_f32_32x32x16_bf16 v[160:175], v[56:59], v[200:203], v[160:175]
    ds_read_b128 v[196:199], v2 offset:46080
    buffer_load_dwordx4 v240, s[40:43], s54 offen offset:2048 sc1 lds
    v_exp_f32 v223, v223
    v_fma_f32 v220, v220, v211, v211
    v_fma_f32 v221, v221, v211, v211
    v_fma_f32 v222, v222, v211, v211
    v_fma_f32 v223, v223, v211, v211
    v_mfma_f32_32x32x16_bf16 v[160:175], v[60:63], v[204:207], v[160:175]
    ds_read_b128 v[200:203], v2 offset:47104
    s_lshl_b32 s54, s53, 12
    s_add_u32 s54, s54, s81
    s_add_u32 m0, s81, 149536
    s_nop 0
    buffer_load_dwordx4 v2, s[44:47], s54 offen lds
    v_rcp_f32 v220, v220
    s_waitcnt lgkmcnt(3)
    v_mfma_f32_32x32x16_bf16 v[160:175], v[64:67], v[176:179], v[160:175]
    ds_read_b128 v[204:207], v2 offset:48128
    v_rcp_f32 v221, v221
    v_rcp_f32 v222, v222
    v_rcp_f32 v223, v223
    v_mul_f32 v220, v148, v220
    v_mfma_f32_32x32x16_bf16 v[160:175], v[68:71], v[180:183], v[160:175]
    ds_read_b128 v[176:179], v2 offset:49152
    s_add_u32 s54, s54, 2
    s_add_u32 m0, s81, 153696
    s_nop 0
    buffer_load_dwordx4 v2, s[44:47], s54 offen lds
    v_mul_f32 v221, v149, v221
    v_mul_f32 v222, v150, v222
    v_mul_f32 v223, v151, v223
    v_cvt_pk_bf16_f32 v226, v220, v221
    v_mfma_f32_32x32x16_bf16 v[160:175], v[72:75], v[184:187], v[160:175]
    ds_read_b128 v[180:183], v2 offset:50176
    v_cvt_pk_bf16_f32 v227, v222, v223
    v_mul_f32 v216, v152, v152
    v_mul_f32 v217, v153, v153
    v_mul_f32 v218, v154, v154
    v_mul_f32 v219, v155, v155
    v_fma_f32 v216, v216, v210, v209
    v_fma_f32 v217, v217, v210, v209
    v_fma_f32 v218, v218, v210, v209
    v_mfma_f32_32x32x16_bf16 v[160:175], v[76:79], v[188:191], v[160:175]
    ds_read_b128 v[184:187], v2 offset:51200
    s_add_u32 m0, s60, 118784
    s_add_u32 m0, s60, 118784
    s_add_u32 s54, s90, 0
    buffer_load_dwordx4 v6, s[32:35], s54 offen offset:0 lds
    v_fma_f32 v219, v219, v210, v209
    v_mul_f32 v216, v152, v216
    s_waitcnt lgkmcnt(3)
    v_mfma_f32_32x32x16_bf16 v[160:175], v[80:83], v[192:195], v[160:175]
    ds_read_b128 v[188:191], v2 offset:52224
    v_mul_f32 v217, v153, v217
    v_mul_f32 v218, v154, v218
    v_mul_f32 v219, v155, v219
    v_exp_f32 v216, v216
    v_exp_f32 v217, v217
    v_mfma_f32_32x32x16_bf16 v[160:175], v[84:87], v[196:199], v[160:175]
    ds_read_b128 v[192:195], v2 offset:53248
    s_add_u32 s54, s90, 6144
    buffer_load_dwordx4 v6, s[32:35], s54 offen offset:1024 lds
    v_exp_f32 v218, v218
    v_exp_f32 v219, v219
    v_fma_f32 v216, v216, v211, v211
    v_mfma_f32_32x32x16_bf16 v[160:175], v[88:91], v[200:203], v[160:175]
    ds_read_b128 v[196:199], v2 offset:54272
    s_add_u32 s54, s90, 12288
    buffer_load_dwordx4 v6, s[32:35], s54 offen offset:2048 lds
    v_fma_f32 v217, v217, v211, v211
    v_fma_f32 v218, v218, v211, v211
    v_fma_f32 v219, v219, v211, v211
    v_rcp_f32 v216, v216
    v_mfma_f32_32x32x16_bf16 v[160:175], v[92:95], v[204:207], v[160:175]
    ds_read_b128 v[200:203], v2 offset:55296
    v_rcp_f32 v217, v217
    v_rcp_f32 v218, v218
    v_rcp_f32 v219, v219
    v_mul_f32 v216, v152, v216
    s_waitcnt lgkmcnt(3)
    v_mfma_f32_32x32x16_bf16 v[160:175], v[96:99], v[176:179], v[160:175]
    ds_read_b128 v[204:207], v2 offset:56320
    s_add_u32 s54, s90, 18432
    buffer_load_dwordx4 v6, s[32:35], s54 offen offset:3072 lds
    v_mul_f32 v217, v153, v217
    v_mul_f32 v218, v154, v218
    s_waitcnt vmcnt(13)
    s_barrier
    v_mfma_f32_32x32x16_bf16 v[160:175], v[100:103], v[180:183], v[160:175]
    ds_read_b128 v[212:215], v243 offset:512
    ds_read_b128 v[176:179], v241 offset:0
    v_mul_f32 v219, v155, v219
    v_cvt_pk_bf16_f32 v228, v216, v217
    v_cvt_pk_bf16_f32 v229, v218, v219
    v_mul_f32 v220, v156, v156
    v_mul_f32 v221, v157, v157
    v_mul_f32 v222, v158, v158
    v_mul_f32 v223, v159, v159
    v_fma_f32 v220, v220, v210, v209
    v_mfma_f32_32x32x16_bf16 v[160:175], v[104:107], v[184:187], v[160:175]
    ds_read_b32 v132, v243 offset:512
    ds_read_b128 v[180:183], v241 offset:1024
    s_add_u32 m0, s60, 122880
    s_add_u32 s54, s90, 28672
    buffer_load_dwordx4 v6, s[32:35], s54 offen offset:0 lds
    v_fma_f32 v221, v221, v210, v209
    v_fma_f32 v222, v222, v210, v209
    v_mfma_f32_32x32x16_bf16 v[160:175], v[108:111], v[188:191], v[160:175]
    ds_read_b128 v[184:187], v241 offset:2048
    s_add_u32 s54, s90, 34816
    buffer_load_dwordx4 v6, s[32:35], s54 offen offset:1024 lds
    v_fma_f32 v223, v223, v210, v209
    v_mul_f32 v220, v156, v220
    v_mul_f32 v221, v157, v221
    v_mul_f32 v222, v158, v222
    s_waitcnt lgkmcnt(5)
    v_mfma_f32_32x32x16_bf16 v[160:175], v[112:115], v[192:195], v[160:175]
    ds_read_b128 v[188:191], v241 offset:3072
    v_mul_f32 v223, v159, v223
    v_exp_f32 v220, v220
    v_exp_f32 v221, v221
    v_exp_f32 v222, v222
    v_mfma_f32_32x32x16_bf16 v[160:175], v[116:119], v[196:199], v[160:175]
    ds_read_b128 v[192:195], v241 offset:4096
    s_add_u32 s54, s90, 40960
    buffer_load_dwordx4 v6, s[32:35], s54 offen offset:2048 lds
    v_exp_f32 v223, v223
    v_fma_f32 v220, v220, v211, v211
    v_fma_f32 v221, v221, v211, v211
    v_fma_f32 v222, v222, v211, v211
    v_mfma_f32_32x32x16_bf16 v[160:175], v[120:123], v[200:203], v[160:175]
    ds_read_b128 v[196:199], v241 offset:5120
    v_fma_f32 v223, v223, v211, v211
    v_rcp_f32 v220, v220
    v_rcp_f32 v221, v221
    v_rcp_f32 v222, v222
    v_rcp_f32 v223, v223
    v_mfma_f32_32x32x16_bf16 v[160:175], v[124:127], v[204:207], v[160:175]
    ds_read_b128 v[200:203], v241 offset:6144
    s_add_u32 m0, s60, 0
    s_add_u32 s54, s90, 50176
    buffer_load_dwordx4 v6, s[32:35], s54 offen offset:0 lds
    v_mul_f32 v220, v156, v220
    v_mul_f32 v221, v157, v221
    s_waitcnt lgkmcnt(6)
    v_mfma_f32_32x32x16_bf16 v[160:175], v[128:131], v[132:135], v[160:175]
    v_mul_f32 v222, v158, v222
    v_mul_f32 v223, v159, v223
    v_cvt_pk_bf16_f32 v230, v220, v221
    v_cvt_pk_bf16_f32 v231, v222, v223
    buffer_store_dwordx4 v[224:227], v244, s[40:43], s24 offen sc1
    buffer_store_dwordx4 v[228:231], v244, s[40:43], s24 offen offset:1024 sc1
    s_waitcnt lgkmcnt(3)
    v_mfma_f32_32x32x16_bf16 v[144:159], v[16:19], v[176:179], 0
    ds_read_b128 v[204:207], v241 offset:7168
    s_add_u32 m0, s60, 1024
    s_add_u32 s54, s91, 0
    buffer_load_dwordx4 v6, s[32:35], s54 offen offset:0 lds
    v_mfma_f32_32x32x16_bf16 v[144:159], v[20:23], v[180:183], v[144:159]
    ds_read_b128 v[176:179], v241 offset:8192
    s_add_u32 s54, s91, 6144
    buffer_load_dwordx4 v6, s[32:35], s54 offen offset:1024 lds
    v_mul_f32 v216, v160, v160
    v_mul_f32 v217, v161, v161
    v_mul_f32 v218, v162, v162
    v_mul_f32 v219, v163, v163
    v_fma_f32 v216, v216, v214, v213
    v_mfma_f32_32x32x16_bf16 v[144:159], v[24:27], v[184:187], v[144:159]
    v_fma_f32 v217, v217, v214, v213
    v_fma_f32 v218, v218, v214, v213
    v_fma_f32 v219, v219, v214, v213
    v_mul_f32 v216, v160, v216
    v_mul_f32 v217, v161, v217
    v_mul_f32 v218, v162, v218
    v_mul_f32 v219, v163, v219
    s_waitcnt vmcnt(5)
    ds_read_b64_tr_b16 a[0:1], v10 offset:57344
    ds_read_b128 v[180:183], v241 offset:9216
    v_mfma_f32_32x32x16_bf16 v[144:159], v[28:31], v[188:191], v[144:159]
    ds_read_b64_tr_b16 a[4:5], v12 offset:57344
    ds_read_b128 v[184:187], v241 offset:10240
    s_add_u32 s54, s91, 12288
    buffer_load_dwordx4 v6, s[32:35], s54 offen offset:2048 lds
    v_exp_f32 v216, v216
    s_waitcnt lgkmcnt(5)
    v_mfma_f32_32x32x16_bf16 v[144:159], v[32:35], v[192:195], v[144:159]
    ds_read_b64_tr_b16 a[2:3], v10 offset:58368
    ds_read_b128 v[188:191], v241 offset:11264
    v_exp_f32 v217, v217
    v_exp_f32 v218, v218
    v_exp_f32 v219, v219
    v_fma_f32 v216, v216, v215, v215
    v_fma_f32 v217, v217, v215, v215
    v_mfma_f32_32x32x16_bf16 v[144:159], v[36:39], v[196:199], v[144:159]
    ds_read_b64_tr_b16 a[6:7], v12 offset:58368
    ds_read_b128 v[192:195], v241 offset:12288
    s_add_u32 s54, s91, 18432
    buffer_load_dwordx4 v6, s[32:35], s54 offen offset:3072 lds
    v_fma_f32 v218, v218, v215, v215
    v_fma_f32 v219, v219, v215, v215
    v_rcp_f32 v216, v216
    v_mfma_f32_32x32x16_bf16 v[144:159], v[40:43], v[200:203], v[144:159]
    ds_read_b64_tr_b16 a[8:9], v10 offset:59392
    ds_read_b128 v[196:199], v241 offset:13312
    v_rcp_f32 v217, v217
    v_rcp_f32 v218, v218
    v_rcp_f32 v219, v219
    v_mul_f32 v216, v160, v216
    v_mul_f32 v217, v161, v217
    v_mfma_f32_32x32x16_bf16 v[144:159], v[44:47], v[204:207], v[144:159]
    ds_read_b64_tr_b16 a[12:13], v12 offset:59392
    ds_read_b128 v[200:203], v241 offset:14336
    buffer_load_dword v248, v247, s[40:43], 0 offen offset:16 sc1
    v_mul_f32 v218, v162, v218
    v_mul_f32 v219, v163, v219
    v_cvt_pk_bf16_f32 v224, v216, v217
    v_cvt_pk_bf16_f32 v225, v218, v219
    s_waitcnt lgkmcnt(6)
    v_mfma_f32_32x32x16_bf16 v[144:159], v[48:51], v[176:179], v[144:159]
    ds_read_b64_tr_b16 a[10:11], v10 offset:60416
    ds_read_b128 v[204:207], v241 offset:15360
    v_mul_f32 v220, v164, v164
    v_mul_f32 v221, v165, v165
    v_mul_f32 v222, v166, v166
    v_mul_f32 v223, v167, v167
    v_fma_f32 v220, v220, v214, v213
    v_fma_f32 v221, v221, v214, v213
    v_fma_f32 v222, v222, v214, v213
    v_fma_f32 v223, v223, v214, v213
    v_mfma_f32_32x32x16_bf16 v[144:159], v[52:55], v[180:183], v[144:159]
    ds_read_b64_tr_b16 a[14:15], v12 offset:60416
    ds_read_b128 v[176:179], v241 offset:16384
    s_add_u32 m0, s60, 5120
    s_add_u32 s54, s91, 28672
    buffer_load_dwordx4 v6, s[32:35], s54 offen offset:0 lds
    v_mul_f32 v220, v164, v220
    v_mul_f32 v221, v165, v221
    v_mul_f32 v222, v166, v222
    v_mfma_f32_32x32x16_bf16 v[144:159], v[56:59], v[184:187], v[144:159]
    ds_read_b64_tr_b16 a[16:17], v10 offset:61440
    ds_read_b128 v[180:183], v241 offset:17408
    v_mul_f32 v223, v167, v223
    v_exp_f32 v220, v220
    v_exp_f32 v221, v221
    v_exp_f32 v222, v222
    v_mfma_f32_32x32x16_bf16 v[144:159], v[60:63], v[188:191], v[144:159]
    ds_read_b64_tr_b16 a[20:21], v12 offset:61440
    ds_read_b128 v[184:187], v241 offset:18432
    s_add_u32 s54, s91, 34816
    buffer_load_dwordx4 v6, s[32:35], s54 offen offset:1024 lds
    v_exp_f32 v223, v223
    v_fma_f32 v220, v220, v215, v215
    s_waitcnt lgkmcnt(6)
    v_mfma_f32_32x32x16_bf16 v[144:159], v[64:67], v[192:195], v[144:159]
    ds_read_b64_tr_b16 a[18:19], v10 offset:62464
    ds_read_b128 v[188:191], v241 offset:19456
    v_fma_f32 v221, v221, v215, v215
    v_fma_f32 v222, v222, v215, v215
    v_fma_f32 v223, v223, v215, v215
    v_rcp_f32 v220, v220
    v_rcp_f32 v221, v221
    v_rcp_f32 v222, v222
    v_mfma_f32_32x32x16_bf16 v[144:159], v[68:71], v[196:199], v[144:159]
    ds_read_b64_tr_b16 a[22:23], v12 offset:62464
    ds_read_b128 v[192:195], v241 offset:20480
    s_add_u32 m0, s60, 28672
    s_add_u32 s54, s91, 43008
    buffer_load_dwordx4 v6, s[32:35], s54 offen offset:0 lds
    v_rcp_f32 v223, v223
    v_mfma_f32_32x32x16_bf16 v[144:159], v[72:75], v[200:203], v[144:159]
    ds_read_b64_tr_b16 a[24:25], v10 offset:63488
    ds_read_b128 v[196:199], v241 offset:21504
    v_mul_f32 v220, v164, v220
    v_mul_f32 v221, v165, v221
    v_mul_f32 v222, v166, v222
    v_mul_f32 v223, v167, v223
    v_cvt_pk_bf16_f32 v226, v220, v221
    v_cvt_pk_bf16_f32 v227, v222, v223
    v_mul_f32 v216, v168, v168
    v_mul_f32 v217, v169, v169
    v_mfma_f32_32x32x16_bf16 v[144:159], v[76:79], v[204:207], v[144:159]
    ds_read_b64_tr_b16 a[28:29], v12 offset:63488
    ds_read_b128 v[200:203], v241 offset:22528
    s_add_u32 s54, s91, 49152
    buffer_load_dwordx4 v6, s[32:35], s54 offen offset:1024 lds
    v_mul_f32 v218, v170, v170
    v_mul_f32 v219, v171, v171
    v_fma_f32 v216, v216, v214, v213
    s_waitcnt lgkmcnt(6)
    v_mfma_f32_32x32x16_bf16 v[144:159], v[80:83], v[176:179], v[144:159]
    ds_read_b128 v[204:207], v241 offset:23552
    v_fma_f32 v217, v217, v214, v213
    v_fma_f32 v218, v218, v214, v213
    v_fma_f32 v219, v219, v214, v213
    v_mul_f32 v216, v168, v216
    v_mul_f32 v217, v169, v217
    v_mul_f32 v218, v170, v218
    v_mul_f32 v219, v171, v219
    v_exp_f32 v216, v216
    v_mfma_f32_32x32x16_bf16 v[144:159], v[84:87], v[180:183], v[144:159]
    ds_read_b128 v[176:179], v241 offset:24576
    s_add_u32 m0, s60, 30720
    s_add_u32 s54, s92, 0
    buffer_load_dwordx4 v6, s[32:35], s54 offen offset:0 lds
    v_exp_f32 v217, v217
    v_exp_f32 v218, v218
    v_mfma_f32_32x32x16_bf16 v[144:159], v[88:91], v[184:187], v[144:159]
    ds_read_b128 v[180:183], v241 offset:25600
    v_exp_f32 v219, v219
    v_fma_f32 v216, v216, v215, v215
    v_fma_f32 v217, v217, v215, v215
    v_fma_f32 v218, v218, v215, v215
    v_fma_f32 v219, v219, v215, v215
    v_rcp_f32 v216, v216
    v_mfma_f32_32x32x16_bf16 v[144:159], v[92:95], v[188:191], v[144:159]
    ds_read_b128 v[184:187], v241 offset:26624
    s_add_u32 s54, s92, 6144
    buffer_load_dwordx4 v6, s[32:35], s54 offen offset:1024 lds
    v_rcp_f32 v217, v217
    v_rcp_f32 v218, v218
    s_waitcnt lgkmcnt(3)
    v_mfma_f32_32x32x16_bf16 v[144:159], v[96:99], v[192:195], v[144:159]
    ds_read_b128 v[188:191], v241 offset:27648
    v_rcp_f32 v219, v219
    s_mov_b64 exec, 15
    buffer_store_dword v13, v11, s[40:43], s3 offen
    s_mov_b64 exec, -1
    s_barrier
    v_mfma_f32_32x32x16_bf16 v[144:159], v[100:103], v[196:199], v[144:159]
    ds_read_b128 v[208:211], v243 offset:1024
    ds_read_b128 v[192:195], v241 offset:28672
    s_add_u32 s54, s92, 12288
    buffer_load_dwordx4 v6, s[32:35], s54 offen offset:2048 lds
    v_mul_f32 v216, v168, v216
    v_mul_f32 v217, v169, v217
    v_mul_f32 v218, v170, v218
    v_mul_f32 v219, v171, v219
    v_mfma_f32_32x32x16_bf16 v[144:159], v[104:107], v[200:203], v[144:159]
    ds_read_b32 v132, v243 offset:1024
    ds_read_b128 v[196:199], v241 offset:29696
    v_cvt_pk_bf16_f32 v228, v216, v217
    v_cvt_pk_bf16_f32 v229, v218, v219
    v_mul_f32 v220, v172, v172
    v_mul_f32 v221, v173, v173
    v_mul_f32 v222, v174, v174
    v_mul_f32 v223, v175, v175
    v_fma_f32 v220, v220, v214, v213
    v_fma_f32 v221, v221, v214, v213
    v_mfma_f32_32x32x16_bf16 v[144:159], v[108:111], v[204:207], v[144:159]
    ds_read_b128 v[200:203], v241 offset:30720
    s_add_u32 s54, s92, 18432
    buffer_load_dwordx4 v6, s[32:35], s54 offen offset:3072 lds
    v_fma_f32 v222, v222, v214, v213
    v_fma_f32 v223, v223, v214, v213
    v_mul_f32 v220, v172, v220
    v_mul_f32 v221, v173, v221
    s_waitcnt lgkmcnt(5)
    v_mfma_f32_32x32x16_bf16 v[144:159], v[112:115], v[176:179], v[144:159]
    ds_read_b128 v[204:207], v241 offset:31744
    v_mul_f32 v222, v174, v222
    v_mul_f32 v223, v175, v223
    v_exp_f32 v220, v220
    v_exp_f32 v221, v221
    v_exp_f32 v222, v222
    v_mfma_f32_32x32x16_bf16 v[144:159], v[116:119], v[180:183], v[144:159]
    ds_read_b128 v[176:179], v241 offset:32768
    s_add_u32 m0, s60, 34816
    s_add_u32 s54, s92, 28672
    buffer_load_dwordx4 v6, s[32:35], s54 offen offset:0 lds
    v_exp_f32 v223, v223
    v_fma_f32 v220, v220, v215, v215
    v_fma_f32 v221, v221, v215, v215
    v_fma_f32 v222, v222, v215, v215
    v_mfma_f32_32x32x16_bf16 v[144:159], v[120:123], v[184:187], v[144:159]
    ds_read_b128 v[180:183], v241 offset:33792
    v_fma_f32 v223, v223, v215, v215
    v_rcp_f32 v220, v220
    v_rcp_f32 v221, v221
    v_rcp_f32 v222, v222
    v_rcp_f32 v223, v223
    v_mfma_f32_32x32x16_bf16 v[144:159], v[124:127], v[188:191], v[144:159]
    ds_read_b128 v[184:187], v241 offset:34816
    s_add_u32 m0, s60, 118784
    s_add_u32 s54, s92, 35840
    buffer_load_dwordx4 v6, s[32:35], s54 offen offset:0 lds
    v_mul_f32 v220, v172, v220
    s_waitcnt lgkmcnt(6)
    v_mfma_f32_32x32x16_bf16 v[144:159], v[128:131], v[132:135], v[144:159]
    v_mul_f32 v221, v173, v221
    v_mul_f32 v222, v174, v222
    v_mul_f32 v223, v175, v223
    v_cvt_pk_bf16_f32 v230, v220, v221
    v_cvt_pk_bf16_f32 v231, v222, v223
    buffer_store_dwordx4 v[224:227], v244, s[40:43], s25 offen nt
    buffer_store_dwordx4 v[228:231], v244, s[40:43], s25 offen offset:1024 nt
    s_waitcnt vmcnt(13)
    v_cmp_ne_u32 vcc, s65, v248
    s_cbranch_vccz L_ok16
    s_mov_b32 s55, 0
L_spin17:
    buffer_load_dword v248, v247, s[40:43], 0 offen offset:16 sc1
    s_waitcnt vmcnt(0)
    v_cmp_ne_u32 vcc, s65, v248
    s_cbranch_vccz L_spun18
    s_add_u32 s55, s55, 1
    s_cmp_lt_u32 s55, 1048576
    s_cbranch_scc1 L_spin17
L_spun18:
L_ok16:
    s_add_u32 s54, s70, 4718592
    s_add_u32 m0, s81, 157824
    s_nop 0
    buffer_load_dwordx4 v2, s[40:43], s54 offen sc1 lds
    s_add_u32 m0, s60, 118784
    s_waitcnt lgkmcnt(3)
    v_mfma_f32_32x32x16_bf16 v[160:175], v[16:19], v[192:195], 0
    ds_read_b128 v[188:191], v241 offset:35840
    s_add_u32 s54, s92, 41984
    buffer_load_dwordx4 v6, s[32:35], s54 offen offset:1024 lds
    v_mfma_f32_32x32x16_bf16 v[160:175], v[20:23], v[196:199], v[160:175]
    ds_read_b128 v[192:195], v241 offset:36864
    v_mul_f32 v216, v144, v144
    v_mul_f32 v217, v145, v145
    v_mul_f32 v218, v146, v146
    v_mul_f32 v219, v147, v147
    v_fma_f32 v216, v216, v210, v209
    v_fma_f32 v217, v217, v210, v209
    v_fma_f32 v218, v218, v210, v209
    v_fma_f32 v219, v219, v210, v209
    v_mul_f32 v216, v144, v216
    v_mfma_f32_32x32x16_bf16 v[160:175], v[24:27], v[200:203], v[160:175]
    s_add_u32 s54, s92, 48128
    buffer_load_dwordx4 v6, s[32:35], s54 offen offset:2048 lds
    v_mul_f32 v217, v145, v217
    v_mul_f32 v218, v146, v218
    v_mul_f32 v219, v147, v219
    s_waitcnt vmcnt(14)
    ds_read_b64_tr_b16 a[26:27], v3 offset:0
    ds_read_b128 v[196:199], v241 offset:37888
    v_mfma_f32_32x32x16_bf16 v[160:175], v[28:31], v[204:207], v[160:175]
    ds_read_b64_tr_b16 a[30:31], v4 offset:0
    ds_read_b128 v[200:203], v241 offset:38912
    v_exp_f32 v216, v216
    v_exp_f32 v217, v217
    v_exp_f32 v218, v218
    s_waitcnt lgkmcnt(5)
    v_mfma_f32_32x32x16_bf16 v[160:175], v[32:35], v[176:179], v[160:175]
    ds_read_b64_tr_b16 a[32:33], v3 offset:1024
    ds_read_b128 v[204:207], v241 offset:39936
    s_add_u32 m0, s60, 121856
    s_add_u32 s54, s93, 0
    buffer_load_dwordx4 v6, s[32:35], s54 offen offset:0 lds
    v_exp_f32 v219, v219
    v_fma_f32 v216, v216, v211, v211
    v_fma_f32 v217, v217, v211, v211
    v_mfma_f32_32x32x16_bf16 v[160:175], v[36:39], v[180:183], v[160:175]
    ds_read_b64_tr_b16 a[36:37], v4 offset:1024
    ds_read_b128 v[176:179], v241 offset:40960
    v_fma_f32 v218, v218, v211, v211
    v_fma_f32 v219, v219, v211, v211
    v_rcp_f32 v216, v216
    v_rcp_f32 v217, v217
    v_rcp_f32 v218, v218
    v_mfma_f32_32x32x16_bf16 v[160:175], v[40:43], v[184:187], v[160:175]
    ds_read_b64_tr_b16 a[34:35], v3 offset:2048
    ds_read_b128 v[180:183], v241 offset:41984
    s_add_u32 s54, s93, 6144
    buffer_load_dwordx4 v6, s[32:35], s54 offen offset:1024 lds
    v_rcp_f32 v219, v219
    v_mul_f32 v216, v144, v216
    v_mul_f32 v217, v145, v217
    v_mfma_f32_32x32x16_bf16 v[160:175], v[44:47], v[188:191], v[160:175]
    ds_read_b64_tr_b16 a[38:39], v4 offset:2048
    ds_read_b128 v[184:187], v241 offset:43008
    v_mul_f32 v218, v146, v218
    v_mul_f32 v219, v147, v219
    v_cvt_pk_bf16_f32 v224, v216, v217
    v_cvt_pk_bf16_f32 v225, v218, v219
    v_mul_f32 v220, v148, v148
    v_mul_f32 v221, v149, v149
    v_mul_f32 v222, v150, v150
    s_waitcnt lgkmcnt(6)
    v_mfma_f32_32x32x16_bf16 v[160:175], v[48:51], v[192:195], v[160:175]
    ds_read_b64_tr_b16 a[40:41], v3 offset:3072
    ds_read_b128 v[188:191], v241 offset:44032
    s_add_u32 s54, s93, 12288
    buffer_load_dwordx4 v6, s[32:35], s54 offen offset:2048 lds
    v_mul_f32 v223, v151, v151
    v_fma_f32 v220, v220, v210, v209
    v_fma_f32 v221, v221, v210, v209
    v_fma_f32 v222, v222, v210, v209
    v_mfma_f32_32x32x16_bf16 v[160:175], v[52:55], v[196:199], v[160:175]
    ds_read_b64_tr_b16 a[44:45], v4 offset:3072
    ds_read_b128 v[192:195], v241 offset:45056
    v_fma_f32 v223, v223, v210, v209
    v_mul_f32 v220, v148, v220
    v_mul_f32 v221, v149, v221
    v_mul_f32 v222, v150, v222
    v_mul_f32 v223, v151, v223
    v_exp_f32 v220, v220
    v_mfma_f32_32x32x16_bf16 v[160:175], v[56:59], v[200:203], v[160:175]
    ds_read_b64_tr_b16 a[42:43], v3 offset:4096
    ds_read_b128 v[196:199], v241 offset:46080
    v_exp_f32 v221, v221
    v_exp_f32 v222, v222
    v_exp_f32 v223, v223
    v_fma_f32 v220, v220, v211, v211
    v_fma_f32 v221, v221, v211, v211
    v_mfma_f32_32x32x16_bf16 v[160:175], v[60:63], v[204:207], v[160:175]
    ds_read_b64_tr_b16 a[46:47], v4 offset:4096
    ds_read_b128 v[200:203], v241 offset:47104
    s_add_u32 s54, s93, 18432
    buffer_load_dwordx4 v6, s[32:35], s54 offen offset:3072 lds
    v_fma_f32 v222, v222, v211, v211
    v_fma_f32 v223, v223, v211, v211
    v_rcp_f32 v220, v220
    s_waitcnt lgkmcnt(6)
    v_mfma_f32_32x32x16_bf16 v[160:175], v[64:67], v[176:179], v[160:175]
    ds_read_b64_tr_b16 a[48:49], v3 offset:5120
    ds_read_b128 v[204:207], v241 offset:48128
    v_rcp_f32 v221, v221
    v_rcp_f32 v222, v222
    v_rcp_f32 v223, v223
    v_mul_f32 v220, v148, v220
    v_mfma_f32_32x32x16_bf16 v[160:175], v[68:71], v[180:183], v[160:175]
    ds_read_b64_tr_b16 a[52:53], v4 offset:5120
    ds_read_b128 v[176:179], v241 offset:49152
    s_add_u32 m0, s60, 61440
    s_add_u32 s54, s93, 28672
    buffer_load_dwordx4 v6, s[32:35], s54 offen offset:0 lds
    v_mul_f32 v221, v149, v221
    v_mul_f32 v222, v150, v222
    v_mul_f32 v223, v151, v223
    v_mfma_f32_32x32x16_bf16 v[160:175], v[72:75], v[184:187], v[160:175]
    ds_read_b64_tr_b16 a[50:51], v3 offset:6144
    ds_read_b128 v[180:183], v241 offset:50176
    v_cvt_pk_bf16_f32 v226, v220, v221
    v_cvt_pk_bf16_f32 v227, v222, v223
    v_mul_f32 v216, v152, v152
    v_mul_f32 v217, v153, v153
    v_mul_f32 v218, v154, v154
    v_mul_f32 v219, v155, v155
    v_fma_f32 v216, v216, v210, v209
    v_fma_f32 v217, v217, v210, v209
    v_mfma_f32_32x32x16_bf16 v[160:175], v[76:79], v[188:191], v[160:175]
    ds_read_b64_tr_b16 a[54:55], v4 offset:6144
    ds_read_b128 v[184:187], v241 offset:51200
    s_add_u32 s54, s93, 34816
    buffer_load_dwordx4 v6, s[32:35], s54 offen offset:1024 lds
    v_fma_f32 v218, v218, v210, v209
    v_fma_f32 v219, v219, v210, v209
    v_mul_f32 v216, v152, v216
    s_waitcnt lgkmcnt(6)
    v_mfma_f32_32x32x16_bf16 v[160:175], v[80:83], v[192:195], v[160:175]
    ds_read_b128 v[188:191], v241 offset:52224
    v_mul_f32 v217, v153, v217
    v_mul_f32 v218, v154, v218
    v_mul_f32 v219, v155, v219
    v_exp_f32 v216, v216
    v_exp_f32 v217, v217
    v_exp_f32 v218, v218
    v_mfma_f32_32x32x16_bf16 v[160:175], v[84:87], v[196:199], v[160:175]
    ds_read_b128 v[192:195], v241 offset:53248
    s_add_u32 s54, s93, 40960
    buffer_load_dwordx4 v6, s[32:35], s54 offen offset:2048 lds
    v_exp_f32 v219, v219
    v_fma_f32 v216, v216, v211, v211
    v_fma_f32 v217, v217, v211, v211
    v_fma_f32 v218, v218, v211, v211
    v_mfma_f32_32x32x16_bf16 v[160:175], v[88:91], v[200:203], v[160:175]
    ds_read_b128 v[196:199], v241 offset:54272
    v_fma_f32 v219, v219, v211, v211
    v_rcp_f32 v216, v216
    v_rcp_f32 v217, v217
    v_rcp_f32 v218, v218
    v_rcp_f32 v219, v219
    v_mfma_f32_32x32x16_bf16 v[160:175], v[92:95], v[204:207], v[160:175]
    ds_read_b128 v[200:203], v241 offset:55296
    v_mul_f32 v216, v152, v216
    v_mul_f32 v217, v153, v217
    v_mul_f32 v218, v154, v218
    s_branch L_pggs3
.p2align 12
L_pgg3:
    s_branch L_pggret
L_pggs3:
    v_mul_f32 v219, v155, v219
    v_cvt_pk_bf16_f32 v228, v216, v217
    v_cvt_pk_bf16_f32 v229, v218, v219
    v_mul_f32 v220, v156, v156
    v_mul_f32 v221, v157, v157
    s_waitcnt lgkmcnt(3)
    v_mfma_f32_32x32x16_bf16 v[160:175], v[96:99], v[176:179], v[160:175]
    ds_read_b128 v[204:207], v241 offset:56320
    s_add_u32 s54, s93, 47104
    buffer_load_dwordx4 v6, s[32:35], s54 offen offset:3072 lds
    v_mul_f32 v222, v158, v158
    v_mul_f32 v223, v159, v159
    v_fma_f32 v220, v220, v210, v209
    s_waitcnt vmcnt(10)
    s_barrier
    v_mfma_f32_32x32x16_bf16 v[160:175], v[100:103], v[180:183], v[160:175]
    ds_read_b128 v[48:51], v246 offset:3584
    ds_read2_b32 v[16:17], v232 offset0:0 offset1:1
    ds_read2_b32 v[18:19], v232 offset0:2 offset1:3
    ds_read_b128 v[212:215], v243 offset:1536
    v_fma_f32 v221, v221, v210, v209
    v_fma_f32 v222, v222, v210, v209
    v_fma_f32 v223, v223, v210, v209
    v_mul_f32 v220, v156, v220
    v_mul_f32 v221, v157, v221
    v_mul_f32 v222, v158, v222
    v_mfma_f32_32x32x16_bf16 v[160:175], v[104:107], v[184:187], v[160:175]
    ds_read_b128 v[52:55], v246 offset:3072
    ds_read2_b32 v[20:21], v232 offset0:128 offset1:129
    ds_read2_b32 v[22:23], v232 offset0:130 offset1:131
    ds_read_b32 v132, v243 offset:1536
    s_add_u32 m0, s60, 65536
    s_add_u32 s54, s94, 0
    buffer_load_dwordx4 v6, s[32:35], s54 offen offset:0 lds
    v_mul_f32 v223, v159, v223
    v_mfma_f32_32x32x16_bf16 v[160:175], v[108:111], v[188:191], v[160:175]
    ds_read_b128 v[56:59], v246 offset:2560
    ds_read2_b32 v[24:25], v233 offset0:0 offset1:1
    ds_read2_b32 v[26:27], v233 offset0:2 offset1:3
    v_exp_f32 v220, v220
    v_exp_f32 v221, v221
    v_exp_f32 v222, v222
    s_waitcnt lgkmcnt(11)
    v_mfma_f32_32x32x16_bf16 v[160:175], v[112:115], v[192:195], v[160:175]
    ds_read_b128 v[60:63], v246 offset:2048
    ds_read2_b32 v[28:29], v233 offset0:128 offset1:129
    ds_read2_b32 v[30:31], v233 offset0:130 offset1:131
    s_add_u32 s54, s94, 6144
    buffer_load_dwordx4 v6, s[32:35], s54 offen offset:1024 lds
    v_exp_f32 v223, v223
    v_fma_f32 v220, v220, v211, v211
    v_mfma_f32_32x32x16_bf16 v[160:175], v[116:119], v[196:199], v[160:175]
    ds_read_b128 v[64:67], v246 offset:1536
    ds_read2_b32 v[32:33], v234 offset0:0 offset1:1
    ds_read2_b32 v[34:35], v234 offset0:2 offset1:3
    v_fma_f32 v221, v221, v211, v211
    v_fma_f32 v222, v222, v211, v211
    v_fma_f32 v223, v223, v211, v211
    v_rcp_f32 v220, v220
    v_rcp_f32 v221, v221
    v_mfma_f32_32x32x16_bf16 v[160:175], v[120:123], v[200:203], v[160:175]
    ds_read_b128 v[68:71], v246 offset:1024
    ds_read2_b32 v[36:37], v234 offset0:128 offset1:129
    ds_read2_b32 v[38:39], v234 offset0:130 offset1:131
    s_add_u32 s54, s94, 12288
    buffer_load_dwordx4 v6, s[32:35], s54 offen offset:2048 lds
    v_rcp_f32 v222, v222
    v_mfma_f32_32x32x16_bf16 v[160:175], v[124:127], v[204:207], v[160:175]
    ds_read_b128 v[72:75], v246 offset:512
    ds_read2_b32 v[40:41], v235 offset0:0 offset1:1
    ds_read2_b32 v[42:43], v235 offset0:2 offset1:3
    v_rcp_f32 v223, v223
    v_mul_f32 v220, v156, v220
    v_mul_f32 v221, v157, v221
    v_mul_f32 v222, v158, v222
    v_mul_f32 v223, v159, v223
    s_waitcnt lgkmcnt(15)
    v_mfma_f32_32x32x16_bf16 v[160:175], v[128:131], v[132:135], v[160:175]
    ds_read_b128 v[76:79], v246 offset:0
    ds_read2_b32 v[44:45], v235 offset0:128 offset1:129
    ds_read2_b32 v[46:47], v235 offset0:130 offset1:131
    v_cvt_pk_bf16_f32 v230, v220, v221
    v_cvt_pk_bf16_f32 v231, v222, v223
    buffer_store_dwordx4 v[224:227], v244, s[40:43], s26 offen sc1
    buffer_store_dwordx4 v[228:231], v244, s[40:43], s26 offen offset:1024 sc1
    s_lshl_b32 s101, s48, 6
    s_add_u32 s101, s101, s3
    s_load_dwordx16 s[4:19], s[40:41], s101
    s_nop 1
    v_pk_mul_f32 v[216:217], v[160:161], v[160:161]
    s_add_u32 m0, s60, 0
    s_add_u32 s54, s94, 21504
    buffer_load_dwordx4 v6, s[32:35], s54 offen offset:0 lds
    v_pk_mul_f32 v[218:219], v[162:163], v[162:163]
    v_pk_mul_f32 v[220:221], v[164:165], v[164:165]
    v_pk_mul_f32 v[222:223], v[166:167], v[166:167]
    v_pk_fma_f32 v[216:217], v[216:217], v[214:215], v[212:213] op_sel:[0,0,1] op_sel_hi:[1,0,1]
    v_pk_fma_f32 v[218:219], v[218:219], v[214:215], v[212:213] op_sel:[0,0,1] op_sel_hi:[1,0,1]
    v_pk_fma_f32 v[220:221], v[220:221], v[214:215], v[212:213] op_sel:[0,0,1] op_sel_hi:[1,0,1]
    v_pk_fma_f32 v[222:223], v[222:223], v[214:215], v[212:213] op_sel:[0,0,1] op_sel_hi:[1,0,1]
    v_pk_mul_f32 v[216:217], v[160:161], v[216:217]
    v_pk_mul_f32 v[218:219], v[162:163], v[218:219]
    v_pk_mul_f32 v[220:221], v[164:165], v[220:221]
    s_add_u32 s54, s94, 27648
    buffer_load_dwordx4 v6, s[32:35], s54 offen offset:1024 lds
    v_pk_mul_f32 v[222:223], v[166:167], v[222:223]
    v_exp_f32 v216, v216
    v_exp_f32 v217, v217
    v_exp_f32 v218, v218
    v_exp_f32 v219, v219
    v_exp_f32 v220, v220
    v_exp_f32 v221, v221
    v_exp_f32 v222, v222
    v_exp_f32 v223, v223
    v_pk_fma_f32 v[216:217], v[216:217], v[214:215], v[214:215] op_sel:[0,1,1] op_sel_hi:[1,1,1]
    s_add_u32 s54, s94, 33792
    buffer_load_dwordx4 v6, s[32:35], s54 offen offset:2048 lds
    v_pk_fma_f32 v[218:219], v[218:219], v[214:215], v[214:215] op_sel:[0,1,1] op_sel_hi:[1,1,1]
    v_pk_fma_f32 v[220:221], v[220:221], v[214:215], v[214:215] op_sel:[0,1,1] op_sel_hi:[1,1,1]
    v_pk_fma_f32 v[222:223], v[222:223], v[214:215], v[214:215] op_sel:[0,1,1] op_sel_hi:[1,1,1]
    v_rcp_f32 v216, v216
    v_rcp_f32 v217, v217
    v_rcp_f32 v218, v218
    v_rcp_f32 v219, v219
    v_rcp_f32 v220, v220
    v_rcp_f32 v221, v221
    v_rcp_f32 v222, v222
    s_add_u32 s54, s94, 39936
    buffer_load_dwordx4 v6, s[32:35], s54 offen offset:3072 lds
    v_rcp_f32 v223, v223
    v_pk_mul_f32 v[216:217], v[160:161], v[216:217]
    v_pk_mul_f32 v[218:219], v[162:163], v[218:219]
    v_pk_mul_f32 v[220:221], v[164:165], v[220:221]
    v_pk_mul_f32 v[222:223], v[166:167], v[222:223]
    v_cvt_pk_bf16_f32 v224, v216, v217
    v_cvt_pk_bf16_f32 v225, v218, v219
    v_cvt_pk_bf16_f32 v226, v220, v221
    v_cvt_pk_bf16_f32 v227, v222, v223
    s_mov_b32 s55, 0
L_cl19:
    s_waitcnt lgkmcnt(0)
    s_and_b64 s[20:21], s[4:5], s[6:7]
    s_or_b64 s[22:23], s[4:5], s[6:7]
    s_and_b64 s[20:21], s[20:21], s[8:9]
    s_or_b64 s[22:23], s[22:23], s[8:9]
    s_and_b64 s[20:21], s[20:21], s[10:11]
    s_or_b64 s[22:23], s[22:23], s[10:11]
    s_and_b64 s[20:21], s[20:21], s[12:13]
    s_or_b64 s[22:23], s[22:23], s[12:13]
    s_and_b64 s[20:21], s[20:21], s[14:15]
    s_or_b64 s[22:23], s[22:23], s[14:15]
    s_and_b64 s[20:21], s[20:21], s[16:17]
    s_or_b64 s[22:23], s[22:23], s[16:17]
    s_and_b32 s20, s20, s21
    s_or_b32 s21, s22, s23
    s_cmp_eq_u64 s[20:21], s[64:65]
    s_cbranch_scc1 L_ce20
    s_add_u32 s55, s55, 1
    s_cmp_eq_u32 s55, 4
    s_cbranch_scc1 L_cv22
    s_add_u32 s101, s101, 256
    s_load_dwordx16 s[4:19], s[40:41], s101
    s_branch L_cl19
L_cv22:
    v_and_b32 v9, 15, v1
    v_min_u32 v9, 13, v9
    v_and_b32 v250, 48, v1
    v_add_lshl_u32 v9, v9, v250, 2
    v_add_u32 v9, s3, v9
    v_subrev_u32 v9, 16, v9
    s_mov_b32 s55, 0
L_spin23:
    buffer_load_dword v250, v9, s[40:43], 0 offen offset:16 sc1
    s_waitcnt vmcnt(0)
    v_cmp_ne_u32 vcc, s65, v250
    s_cbranch_vccz L_spun24
    s_add_u32 s55, s55, 1
    s_cmp_lt_u32 s55, 1048576
    s_cbranch_scc1 L_spin23
L_spun24:
L_ce20:
    s_barrier
    buffer_store_dwordx4 v[224:227], v244, s[40:43], s27 offen offset:0 nt
    v_pk_mul_f32 v[216:217], v[168:169], v[168:169]
    s_add_u32 m0, s60, 4096
    s_add_u32 s54, s94, 50176
    buffer_load_dwordx4 v6, s[32:35], s54 offen offset:0 lds
    v_pk_mul_f32 v[218:219], v[170:171], v[170:171]
    v_pk_mul_f32 v[220:221], v[172:173], v[172:173]
    v_pk_mul_f32 v[222:223], v[174:175], v[174:175]
    v_pk_fma_f32 v[216:217], v[216:217], v[214:215], v[212:213] op_sel:[0,0,1] op_sel_hi:[1,0,1]
    v_pk_fma_f32 v[218:219], v[218:219], v[214:215], v[212:213] op_sel:[0,0,1] op_sel_hi:[1,0,1]
    v_pk_fma_f32 v[220:221], v[220:221], v[214:215], v[212:213] op_sel:[0,0,1] op_sel_hi:[1,0,1]
    v_pk_fma_f32 v[222:223], v[222:223], v[214:215], v[212:213] op_sel:[0,0,1] op_sel_hi:[1,0,1]
    v_pk_mul_f32 v[216:217], v[168:169], v[216:217]
    v_pk_mul_f32 v[218:219], v[170:171], v[218:219]
    v_pk_mul_f32 v[220:221], v[172:173], v[220:221]
    v_pk_mul_f32 v[222:223], v[174:175], v[222:223]
    v_exp_f32 v216, v216
    v_exp_f32 v217, v217
    v_exp_f32 v218, v218
    v_exp_f32 v219, v219
    v_exp_f32 v220, v220
    v_exp_f32 v221, v221
    v_exp_f32 v222, v222
    v_exp_f32 v223, v223
    v_pk_fma_f32 v[216:217], v[216:217], v[214:215], v[214:215] op_sel:[0,1,1] op_sel_hi:[1,1,1]
    v_pk_fma_f32 v[218:219], v[218:219], v[214:215], v[214:215] op_sel:[0,1,1] op_sel_hi:[1,1,1]
    v_pk_fma_f32 v[220:221], v[220:221], v[214:215], v[214:215] op_sel:[0,1,1] op_sel_hi:[1,1,1]
    v_pk_fma_f32 v[222:223], v[222:223], v[214:215], v[214:215] op_sel:[0,1,1] op_sel_hi:[1,1,1]
    v_rcp_f32 v216, v216
    v_rcp_f32 v217, v217
    v_rcp_f32 v218, v218
    v_rcp_f32 v219, v219
    v_rcp_f32 v220, v220
    v_rcp_f32 v221, v221
    v_rcp_f32 v222, v222
    v_rcp_f32 v223, v223
    v_pk_mul_f32 v[216:217], v[168:169], v[216:217]
    v_pk_mul_f32 v[218:219], v[170:171], v[218:219]
    v_pk_mul_f32 v[220:221], v[172:173], v[220:221]
    v_pk_mul_f32 v[222:223], v[174:175], v[222:223]
    v_cvt_pk_bf16_f32 v228, v216, v217
    v_cvt_pk_bf16_f32 v229, v218, v219
    v_cvt_pk_bf16_f32 v230, v220, v221
    v_cvt_pk_bf16_f32 v231, v222, v223
    buffer_store_dwordx4 v[228:231], v244, s[40:43], s27 offen offset:1024 nt
    v_mfma_f32_16x16x32_bf16 v[176:179], v[236:239], v[48:51], 0
    s_add_u32 m0, s60, 5120
    s_add_u32 s54, s95, 0
    buffer_load_dwordx4 v6, s[32:35], s54 offen offset:0 lds
    ds_read_b64_tr_b16 a[56:57], v3 offset:28672
    v_mfma_f32_16x16x32_bf16 v[180:183], v[236:239], v[52:55], 0
    ds_read_b64_tr_b16 a[60:61], v4 offset:28672
    v_mfma_f32_16x16x32_bf16 v[184:187], v[236:239], v[56:59], 0
    ds_read_b64_tr_b16 a[58:59], v3 offset:29696
    v_mfma_f32_16x16x32_bf16 v[188:191], v[236:239], v[60:63], 0
    ds_read_b64_tr_b16 a[62:63], v4 offset:29696
    v_mfma_f32_16x16x32_bf16 v[192:195], v[236:239], v[64:67], 0
    ds_read_b64_tr_b16 a[64:65], v3 offset:30720
    s_add_u32 s54, s95, 6144
    buffer_load_dwordx4 v6, s[32:35], s54 offen offset:1024 lds
    v_mfma_f32_16x16x32_bf16 v[196:199], v[236:239], v[68:71], 0
    ds_read_b64_tr_b16 a[68:69], v4 offset:30720
    v_mfma_f32_16x16x32_bf16 v[200:203], v[236:239], v[72:75], 0
    ds_read_b64_tr_b16 a[66:67], v3 offset:31744
    s_and_b32 s58, s49, 1
    v_mfma_f32_16x16x32_bf16 v[204:207], v[236:239], v[76:79], 0
    ds_read_b64_tr_b16 a[70:71], v4 offset:31744
    s_sub_u32 s56, s26, s24
    v_mfma_f32_16x16x32_bf16 v[176:179], v[16:19], v[48:51], v[176:179]
    ds_read_b64_tr_b16 a[72:73], v3 offset:32768
    s_mul_i32 s56, s56, s58
    s_add_u32 s56, s56, s24
    v_mfma_f32_16x16x32_bf16 v[180:183], v[16:19], v[52:55], v[180:183]
    ds_read_b64_tr_b16 a[76:77], v4 offset:32768
    s_add_u32 m0, s60, 90112
    s_add_u32 s54, s95, 14336
    buffer_load_dwordx4 v6, s[32:35], s54 offen offset:0 lds
    v_mfma_f32_16x16x32_bf16 v[184:187], v[16:19], v[56:59], v[184:187]
    ds_read_b64_tr_b16 a[74:75], v3 offset:33792
    v_mfma_f32_16x16x32_bf16 v[188:191], v[16:19], v[60:63], v[188:191]
    ds_read_b64_tr_b16 a[78:79], v4 offset:33792
    v_mfma_f32_16x16x32_bf16 v[192:195], v[16:19], v[64:67], v[192:195]
    ds_read_b64_tr_b16 a[80:81], v3 offset:34816
    s_sub_u32 s57, s27, s25
    v_mfma_f32_16x16x32_bf16 v[196:199], v[16:19], v[68:71], v[196:199]
    ds_read_b64_tr_b16 a[84:85], v4 offset:34816
    s_mul_i32 s57, s57, s58
    v_mfma_f32_16x16x32_bf16 v[200:203], v[16:19], v[72:75], v[200:203]
    ds_read_b128 v[112:115], v246 offset:3648
    s_add_u32 s54, s95, 20480
    buffer_load_dwordx4 v6, s[32:35], s54 offen offset:1024 lds
    v_mfma_f32_16x16x32_bf16 v[204:207], v[16:19], v[76:79], v[204:207]
    ds_read2_b32 v[80:81], v232 offset0:16 offset1:17
    v_mfma_f32_16x16x32_bf16 v[180:183], v[20:23], v[48:51], v[180:183]
    ds_read2_b32 v[82:83], v232 offset0:18 offset1:19
    s_add_u32 s57, s57, s25
    v_mfma_f32_16x16x32_bf16 v[184:187], v[20:23], v[52:55], v[184:187]
    ds_read_b128 v[116:119], v246 offset:3136
    s_lshr_b32 s58, s48, 1
    v_mfma_f32_16x16x32_bf16 v[188:191], v[20:23], v[56:59], v[188:191]
    ds_read2_b32 v[84:85], v232 offset0:144 offset1:145
    s_sub_u32 s59, s57, s56
    s_mul_i32 s59, s59, s58
    v_mfma_f32_16x16x32_bf16 v[192:195], v[20:23], v[60:63], v[192:195]
    s_add_u32 s54, s95, 26624
    buffer_load_dwordx4 v6, s[32:35], s54 offen offset:2048 lds
    v_mfma_f32_16x16x32_bf16 v[196:199], v[20:23], v[64:67], v[196:199]
    ds_read2_b32 v[86:87], v232 offset0:146 offset1:147
    v_mfma_f32_16x16x32_bf16 v[200:203], v[20:23], v[68:71], v[200:203]
    ds_read_b128 v[120:123], v246 offset:2624
    s_add_u32 s56, s56, s59
    v_mfma_f32_16x16x32_bf16 v[204:207], v[20:23], v[72:75], v[204:207]
    ds_read2_b32 v[88:89], v233 offset0:16 offset1:17
    s_sub_u32 s57, s57, s59
    s_mul_i32 s59, s71, 28672
    v_mfma_f32_16x16x32_bf16 v[184:187], v[24:27], v[48:51], v[184:187]
    ds_read2_b32 v[90:91], v233 offset0:18 offset1:19
    s_add_u32 s56, s56, s59
    s_waitcnt vmcnt(5)
    s_mov_b64 exec, 15
    buffer_store_dword v13, v11, s[40:43], s97 offen
    s_mov_b64 exec, -1
    v_mfma_f32_16x16x32_bf16 v[188:191], v[24:27], v[52:55], v[188:191]
    ds_read_b128 v[124:127], v246 offset:2112
    s_add_u32 s54, s95, 32768
    buffer_load_dwordx4 v6, s[32:35], s54 offen offset:3072 lds
    v_mfma_f32_16x16x32_bf16 v[192:195], v[24:27], v[56:59], v[192:195]
    ds_read2_b32 v[92:93], v233 offset0:144 offset1:145
    v_mfma_f32_16x16x32_bf16 v[196:199], v[24:27], v[60:63], v[196:199]
    ds_read2_b32 v[94:95], v233 offset0:146 offset1:147
    s_add_u32 s57, s57, s59
    v_mfma_f32_16x16x32_bf16 v[200:203], v[24:27], v[64:67], v[200:203]
    ds_read_b128 v[128:131], v246 offset:1600
    v_add_u32 v240, s56, v2
    v_mfma_f32_16x16x32_bf16 v[204:207], v[24:27], v[68:71], v[204:207]
    ds_read2_b32 v[96:97], v234 offset0:16 offset1:17
    v_add_u32 v241, s57, v2
    s_bfe_u32 s82, s98, 196608
    v_mfma_f32_16x16x32_bf16 v[188:191], v[28:31], v[48:51], v[188:191]
    ds_read2_b32 v[98:99], v234 offset0:18 offset1:19
    s_add_u32 m0, s60, 94208
    s_add_u32 s54, s95, 43008
    buffer_load_dwordx4 v6, s[32:35], s54 offen offset:0 lds
    v_mfma_f32_16x16x32_bf16 v[192:195], v[28:31], v[52:55], v[192:195]
    ds_read_b128 v[132:135], v246 offset:1088
    v_mfma_f32_16x16x32_bf16 v[196:199], v[28:31], v[56:59], v[196:199]
    ds_read2_b32 v[100:101], v234 offset0:144 offset1:145
    v_mfma_f32_16x16x32_bf16 v[200:203], v[28:31], v[60:63], v[200:203]
    ds_read2_b32 v[102:103], v234 offset0:146 offset1:147
    s_lshl_b32 s82, s82, 12
    v_mfma_f32_16x16x32_bf16 v[204:207], v[28:31], v[64:67], v[204:207]
    ds_read_b128 v[136:139], v246 offset:576
    s_bfe_u32 s83, s98, 196612
    v_mfma_f32_16x16x32_bf16 v[192:195], v[32:35], v[48:51], v[192:195]
    ds_read2_b32 v[104:105], v235 offset0:16 offset1:17
    s_add_u32 s54, s95, 49152
    buffer_load_dwordx4 v6, s[32:35], s54 offen offset:1024 lds
    v_mfma_f32_16x16x32_bf16 v[196:199], v[32:35], v[52:55], v[196:199]
    ds_read2_b32 v[106:107], v235 offset0:18 offset1:19
    v_mfma_f32_16x16x32_bf16 v[200:203], v[32:35], v[56:59], v[200:203]
    ds_read_b128 v[140:143], v246 offset:64
    s_lshl_b32 s83, s83, 12
    v_mfma_f32_16x16x32_bf16 v[204:207], v[32:35], v[60:63], v[204:207]
    ds_read2_b32 v[108:109], v235 offset0:144 offset1:145
    s_bfe_u32 s84, s98, 196616
    v_mfma_f32_16x16x32_bf16 v[196:199], v[36:39], v[48:51], v[196:199]
    ds_read2_b32 v[110:111], v235 offset0:146 offset1:147
    s_lshl_b32 s84, s84, 12
    s_bfe_u32 s85, s98, 196620
    v_mfma_f32_16x16x32_bf16 v[200:203], v[36:39], v[52:55], v[200:203]
    s_add_u32 m0, s60, 96256
    s_add_u32 s54, s96, 0
    buffer_load_dwordx4 v6, s[32:35], s54 offen offset:0 lds
    v_mfma_f32_16x16x32_bf16 v[204:207], v[36:39], v[56:59], v[204:207]
    v_mfma_f32_16x16x32_bf16 v[200:203], v[40:43], v[48:51], v[200:203]
    s_lshl_b32 s85, s85, 12
    s_bfe_u32 s86, s98, 196624
    v_mfma_f32_16x16x32_bf16 v[204:207], v[40:43], v[52:55], v[204:207]
    s_lshl_b32 s86, s86, 12
    s_bfe_u32 s87, s98, 196628
    s_lshl_b32 s87, s87, 12
    v_mfma_f32_16x16x32_bf16 v[204:207], v[44:47], v[48:51], v[204:207]
    s_bfe_u32 s88, s98, 196632
    s_lshl_b32 s88, s88, 12
    s_waitcnt lgkmcnt(0)
    v_mfma_f32_16x16x32_bf16 v[176:179], v[80:83], v[112:115], v[176:179]
    s_add_u32 m0, s60, 28672
    s_add_u32 s54, s96, 7168
    buffer_load_dwordx4 v6, s[32:35], s54 offen offset:0 lds
    ds_read_b64_tr_b16 a[82:83], v10 offset:57344
    v_mfma_f32_16x16x32_bf16 v[180:183], v[80:83], v[116:119], v[180:183]
    ds_read_b64_tr_b16 a[86:87], v12 offset:57344
    v_mfma_f32_16x16x32_bf16 v[184:187], v[80:83], v[120:123], v[184:187]
    ds_read_b64_tr_b16 a[88:89], v10 offset:58368
    v_mfma_f32_16x16x32_bf16 v[188:191], v[80:83], v[124:127], v[188:191]
    ds_read_b64_tr_b16 a[92:93], v12 offset:58368
    v_mfma_f32_16x16x32_bf16 v[192:195], v[80:83], v[128:131], v[192:195]
    ds_read_b64_tr_b16 a[90:91], v10 offset:59392
    s_add_u32 s54, s96, 13312
    buffer_load_dwordx4 v6, s[32:35], s54 offen offset:1024 lds
    v_mfma_f32_16x16x32_bf16 v[196:199], v[80:83], v[132:135], v[196:199]
    ds_read_b64_tr_b16 a[94:95], v12 offset:59392
    v_mfma_f32_16x16x32_bf16 v[200:203], v[80:83], v[136:139], v[200:203]
    ds_read_b64_tr_b16 a[96:97], v10 offset:60416
    v_mfma_f32_16x16x32_bf16 v[204:207], v[80:83], v[140:143], v[204:207]
    v_mfma_f32_16x16x32_bf16 v[180:183], v[84:87], v[112:115], v[180:183]
    ds_read_b64_tr_b16 a[100:101], v12 offset:60416
    v_mfma_f32_16x16x32_bf16 v[184:187], v[84:87], v[116:119], v[184:187]
    ds_read_b64_tr_b16 a[98:99], v10 offset:61440
    s_add_u32 s54, s96, 19456
    buffer_load_dwordx4 v6, s[32:35], s54 offen offset:2048 lds
    v_mfma_f32_16x16x32_bf16 v[188:191], v[84:87], v[120:123], v[188:191]
    ds_read_b64_tr_b16 a[102:103], v12 offset:61440
    v_mfma_f32_16x16x32_bf16 v[192:195], v[84:87], v[124:127], v[192:195]
    ds_read_b64_tr_b16 a[104:105], v10 offset:62464
    s_lshl_b32 s101, s48, 6
    s_add_u32 s101, s101, s97
    s_load_dwordx16 s[4:19], s[40:41], s101
    v_mfma_f32_16x16x32_bf16 v[196:199], v[84:87], v[128:131], v[196:199]
    ds_read_b64_tr_b16 a[108:109], v12 offset:62464
    v_mfma_f32_16x16x32_bf16 v[200:203], v[84:87], v[132:135], v[200:203]
    ds_read_b64_tr_b16 a[106:107], v10 offset:63488
    v_mfma_f32_16x16x32_bf16 v[204:207], v[84:87], v[136:139], v[204:207]
    ds_read_b64_tr_b16 a[110:111], v12 offset:63488
    s_add_u32 s54, s96, 25600
    buffer_load_dwordx4 v6, s[32:35], s54 offen offset:3072 lds
    v_mfma_f32_16x16x32_bf16 v[184:187], v[88:91], v[112:115], v[184:187]
    v_mfma_f32_16x16x32_bf16 v[188:191], v[88:91], v[116:119], v[188:191]
    ds_read_b64_tr_b16 a[112:113], v10 offset:0
    v_mfma_f32_16x16x32_bf16 v[192:195], v[88:91], v[120:123], v[192:195]
    ds_read_b64_tr_b16 a[116:117], v12 offset:0
    v_mfma_f32_16x16x32_bf16 v[196:199], v[88:91], v[124:127], v[196:199]
    ds_read_b64_tr_b16 a[114:115], v10 offset:1024
    s_add_u32 s56, s60, 61440
    v_mfma_f32_16x16x32_bf16 v[200:203], v[88:91], v[128:131], v[200:203]
    ds_read_b64_tr_b16 a[118:119], v12 offset:1024
    s_add_u32 m0, s60, 32768
    s_add_u32 s54, s96, 35840
    buffer_load_dwordx4 v6, s[32:35], s54 offen offset:0 lds
    v_mfma_f32_16x16x32_bf16 v[204:207], v[88:91], v[132:135], v[204:207]
    ds_read_b64_tr_b16 a[120:121], v10 offset:2048
    v_mfma_f32_16x16x32_bf16 v[188:191], v[92:95], v[112:115], v[188:191]
    ds_read_b64_tr_b16 a[124:125], v12 offset:2048
    v_mfma_f32_16x16x32_bf16 v[192:195], v[92:95], v[116:119], v[192:195]
    ds_read_b64_tr_b16 a[122:123], v10 offset:3072
    v_mfma_f32_16x16x32_bf16 v[196:199], v[92:95], v[120:123], v[196:199]
    v_add_u32 v230, s56, v2
    v_mfma_f32_16x16x32_bf16 v[200:203], v[92:95], v[124:127], v[200:203]
    ds_read_b64_tr_b16 a[126:127], v12 offset:3072
    s_add_u32 s54, s96, 41984
    buffer_load_dwordx4 v6, s[32:35], s54 offen offset:1024 lds
    v_mfma_f32_16x16x32_bf16 v[204:207], v[92:95], v[128:131], v[204:207]
    ds_read_b64_tr_b16 a[128:129], v10 offset:4096
    v_mfma_f32_16x16x32_bf16 v[192:195], v[96:99], v[112:115], v[192:195]
    ds_read_b64_tr_b16 a[132:133], v12 offset:4096
    v_mfma_f32_16x16x32_bf16 v[196:199], v[96:99], v[116:119], v[196:199]
    ds_read_b64_tr_b16 a[130:131], v10 offset:5120
    v_mfma_f32_16x16x32_bf16 v[200:203], v[96:99], v[120:123], v[200:203]
    ds_read_b64_tr_b16 a[134:135], v12 offset:5120
    v_mfma_f32_16x16x32_bf16 v[204:207], v[96:99], v[124:127], v[204:207]
    ds_read_b64_tr_b16 a[136:137], v10 offset:6144
    s_add_u32 s54, s96, 48128
    buffer_load_dwordx4 v6, s[32:35], s54 offen offset:2048 lds
    v_mfma_f32_16x16x32_bf16 v[196:199], v[100:103], v[112:115], v[196:199]
    ds_read_b64_tr_b16 a[140:141], v12 offset:6144
    v_mfma_f32_16x16x32_bf16 v[200:203], v[100:103], v[116:119], v[200:203]
    s_lshl_b32 s56, s48, 11
    v_mfma_f32_16x16x32_bf16 v[204:207], v[100:103], v[120:123], v[204:207]
    s_add_u32 s56, s56, 118784
    v_mfma_f32_16x16x32_bf16 v[200:203], v[104:107], v[112:115], v[200:203]
    v_add_u32 v231, s56, v2
    s_add_u32 s57, s48, 1
    v_mfma_f32_16x16x32_bf16 v[204:207], v[104:107], v[116:119], v[204:207]
    s_lshr_b32 s57, s57, 2
    s_mul_i32 s57, s57, 64512
    v_mfma_f32_16x16x32_bf16 v[204:207], v[108:111], v[112:115], v[204:207]
    s_sub_u32 s56, s56, s57
    v_add_u32 v247, s56, v2
    s_waitcnt lgkmcnt(0)
    s_mov_b32 s55, 0
L_cl25:
    s_waitcnt lgkmcnt(0)
    s_and_b64 s[20:21], s[4:5], s[6:7]
    s_or_b64 s[22:23], s[4:5], s[6:7]
    s_and_b64 s[20:21], s[20:21], s[8:9]
    s_or_b64 s[22:23], s[22:23], s[8:9]
    s_and_b64 s[20:21], s[20:21], s[10:11]
    s_or_b64 s[22:23], s[22:23], s[10:11]
    s_and_b64 s[20:21], s[20:21], s[12:13]
    s_or_b64 s[22:23], s[22:23], s[12:13]
    s_and_b64 s[20:21], s[20:21], s[14:15]
    s_or_b64 s[22:23], s[22:23], s[14:15]
    s_and_b64 s[20:21], s[20:21], s[16:17]
    s_or_b64 s[22:23], s[22:23], s[16:17]
    s_and_b32 s20, s20, s21
    s_or_b32 s21, s22, s23
    s_cmp_eq_u64 s[20:21], s[64:65]
    s_cbranch_scc1 L_ce26
    s_add_u32 s55, s55, 1
    s_cmp_eq_u32 s55, 4
    s_cbranch_scc1 L_cv28
    s_add_u32 s101, s101, 256
    s_load_dwordx16 s[4:19], s[40:41], s101
    s_branch L_cl25
L_cv28:
    v_and_b32 v9, 15, v1
    v_min_u32 v9, 13, v9
    v_and_b32 v250, 48, v1
    v_add_lshl_u32 v9, v9, v250, 2
    v_add_u32 v9, s97, v9
    v_subrev_u32 v9, 16, v9
    s_mov_b32 s55, 0
L_spin29:
    buffer_load_dword v250, v9, s[40:43], 0 offen offset:16 sc1
    s_waitcnt vmcnt(0)
    v_cmp_ne_u32 vcc, s65, v250
    s_cbranch_vccz L_spun30
    s_add_u32 s55, s55, 1
    s_cmp_lt_u32 s55, 1048576
    s_cbranch_scc1 L_spin29
L_spun30:
L_ce26:
    s_barrier
    buffer_load_dwordx4 v[80:83], v241, s[40:43], s82 offen offset:0 sc1
    buffer_load_dwordx4 v[84:87], v241, s[40:43], s82 offen offset:1024 sc1
    ds_write_b128 v230, v[176:179] offset:57344
    buffer_load_dwordx4 v[88:91], v241, s[40:43], s82 offen offset:2048 sc1
    ds_write_b128 v230, v[180:183] offset:58368
    ds_write_b128 v230, v[184:187] offset:59392
    buffer_load_dwordx4 v[92:95], v241, s[40:43], s82 offen offset:3072 sc1
    ds_write_b128 v230, v[188:191] offset:60416
    ds_write_b128 v230, v[192:195] offset:61440
    buffer_load_dwordx4 v[96:99], v241, s[40:43], s83 offen offset:0 sc1
    ds_write_b128 v230, v[196:199] offset:62464
    ds_write_b128 v230, v[200:203] offset:63488
    buffer_load_dwordx4 v[100:103], v241, s[40:43], s83 offen offset:1024 sc1
    ds_write_b128 v230, v[204:207] offset:0
    s_waitcnt lgkmcnt(0)
    s_barrier
    buffer_load_dwordx4 v[104:107], v241, s[40:43], s83 offen offset:2048 sc1
    ds_read_b128 v[176:179], v231 offset:0
    ds_read_b128 v[180:183], v247 offset:1024
    buffer_load_dwordx4 v[108:111], v241, s[40:43], s83 offen offset:3072 sc1
    ds_read_b128 v[184:187], v231 offset:7168
    ds_read_b128 v[188:191], v247 offset:8192
    buffer_load_dwordx4 v[112:115], v241, s[40:43], s84 offen offset:0 sc1
    ds_read_b128 v[192:195], v231 offset:14336
    ds_read_b128 v[196:199], v247 offset:15360
    buffer_load_dwordx4 v[116:119], v241, s[40:43], s84 offen offset:1024 sc1
    ds_read_b128 v[200:203], v231 offset:21504
    ds_read_b128 v[204:207], v247 offset:22528
    s_waitcnt lgkmcnt(0)
    v_pk_add_f32 v[176:177], v[176:177], v[184:185]
    v_pk_add_f32 v[178:179], v[178:179], v[186:187]
    v_pk_add_f32 v[180:181], v[180:181], v[188:189]
    v_pk_add_f32 v[182:183], v[182:183], v[190:191]
    v_pk_add_f32 v[192:193], v[192:193], v[200:201]
    v_pk_add_f32 v[194:195], v[194:195], v[202:203]
    v_pk_add_f32 v[196:197], v[196:197], v[204:205]
    v_pk_add_f32 v[198:199], v[198:199], v[206:207]
    v_pk_add_f32 v[176:177], v[176:177], v[192:193]
    v_pk_add_f32 v[178:179], v[178:179], v[194:195]
    v_pk_add_f32 v[180:181], v[180:181], v[196:197]
    v_pk_add_f32 v[182:183], v[182:183], v[198:199]
    v_cvt_pk_bf16_f32 v184, v176, v177
    v_cvt_pk_bf16_f32 v185, v178, v179
    v_cvt_pk_bf16_f32 v186, v180, v181
    v_cvt_pk_bf16_f32 v187, v182, v183
    s_mov_b32 s56, 6815744
    v_permlane16_swap_b32 v184, v186
    v_permlane16_swap_b32 v185, v187
    buffer_store_dwordx4 v[184:187], v252, s[40:43], s56 offen sc1
    buffer_load_dwordx4 v[120:123], v241, s[40:43], s84 offen offset:2048 sc1
    buffer_load_dwordx4 v[124:127], v241, s[40:43], s84 offen offset:3072 sc1
    buffer_load_dwordx4 v[128:131], v241, s[40:43], s85 offen offset:0 sc1
    buffer_load_dwordx4 v[132:135], v241, s[40:43], s85 offen offset:1024 sc1
    s_waitcnt vmcnt(14)
    v_mfma_f32_32x32x16_bf16 v[48:63], a[0:3], v[80:83], 0
    buffer_load_dwordx4 v[136:139], v241, s[40:43], s85 offen offset:2048 sc1
    ds_read_b64_tr_b16 a[138:139], v3 offset:0
    v_mfma_f32_32x32x16_bf16 v[64:79], a[4:7], v[80:83], 0
    ds_read_b64_tr_b16 a[142:143], v4 offset:0
    ds_read_b64_tr_b16 a[144:145], v3 offset:1024
    s_waitcnt vmcnt(14)
    v_mfma_f32_32x32x16_bf16 v[48:63], a[8:11], v[84:87], v[48:63]
    ds_read_b64_tr_b16 a[148:149], v4 offset:1024
    ds_read_b64_tr_b16 a[146:147], v3 offset:2048
    buffer_load_dwordx4 v[140:143], v241, s[40:43], s85 offen offset:3072 sc1
    v_mfma_f32_32x32x16_bf16 v[64:79], a[12:15], v[84:87], v[64:79]
    ds_read_b64_tr_b16 a[150:151], v4 offset:2048
    s_waitcnt vmcnt(14)
    v_mfma_f32_32x32x16_bf16 v[48:63], a[16:19], v[88:91], v[48:63]
    ds_read_b64_tr_b16 a[152:153], v3 offset:3072
    ds_read_b64_tr_b16 a[156:157], v4 offset:3072
    buffer_load_dwordx4 v[144:147], v241, s[40:43], s86 offen offset:0 sc1
    v_mfma_f32_32x32x16_bf16 v[64:79], a[20:23], v[88:91], v[64:79]
    ds_read_b64_tr_b16 a[154:155], v3 offset:4096
    ds_read_b64_tr_b16 a[158:159], v4 offset:4096
    s_waitcnt vmcnt(14)
    v_mfma_f32_32x32x16_bf16 v[48:63], a[24:27], v[92:95], v[48:63]
    ds_read_b64_tr_b16 a[160:161], v3 offset:5120
    ds_read_b64_tr_b16 a[164:165], v4 offset:5120
    buffer_load_dwordx4 v[148:151], v241, s[40:43], s86 offen offset:1024 sc1
    v_mfma_f32_32x32x16_bf16 v[64:79], a[28:31], v[92:95], v[64:79]
    ds_read_b64_tr_b16 a[162:163], v3 offset:6144
    s_waitcnt vmcnt(14)
    v_mfma_f32_32x32x16_bf16 v[48:63], a[32:35], v[96:99], v[48:63]
    buffer_load_dwordx4 v[152:155], v241, s[40:43], s86 offen offset:2048 sc1
    ds_read_b64_tr_b16 a[166:167], v4 offset:6144
    v_mfma_f32_32x32x16_bf16 v[64:79], a[36:39], v[96:99], v[64:79]
    ds_read_b64_tr_b16 a[168:169], v10 offset:28672
    ds_read_b64_tr_b16 a[172:173], v12 offset:28672
    s_waitcnt vmcnt(14)
    v_mfma_f32_32x32x16_bf16 v[48:63], a[40:43], v[100:103], v[48:63]
    ds_read_b64_tr_b16 a[170:171], v10 offset:29696
    ds_read_b64_tr_b16 a[174:175], v12 offset:29696
    buffer_load_dwordx4 v[156:159], v241, s[40:43], s86 offen offset:3072 sc1
    v_mfma_f32_32x32x16_bf16 v[64:79], a[44:47], v[100:103], v[64:79]
    ds_read_b64_tr_b16 a[176:177], v10 offset:30720
    s_waitcnt vmcnt(14)
    v_mfma_f32_32x32x16_bf16 v[48:63], a[48:51], v[104:107], v[48:63]
    ds_read_b64_tr_b16 a[180:181], v12 offset:30720
    ds_read_b64_tr_b16 a[178:179], v10 offset:31744
    buffer_load_dwordx4 v[160:163], v241, s[40:43], s87 offen offset:0 sc1
    v_mfma_f32_32x32x16_bf16 v[64:79], a[52:55], v[104:107], v[64:79]
    ds_read_b64_tr_b16 a[182:183], v12 offset:31744
    ds_read_b64_tr_b16 a[184:185], v10 offset:32768
    s_waitcnt vmcnt(14)
    v_mfma_f32_32x32x16_bf16 v[48:63], a[56:59], v[108:111], v[48:63]
    ds_read_b64_tr_b16 a[188:189], v12 offset:32768
    s_branch L_pggs4
.p2align 12
L_pgg4:
    s_branch L_pggret
L_pggs4:
    buffer_load_dwordx4 v[164:167], v241, s[40:43], s87 offen offset:1024 sc1
    v_mfma_f32_32x32x16_bf16 v[64:79], a[60:63], v[108:111], v[64:79]
    ds_read_b64_tr_b16 a[186:187], v10 offset:33792
    ds_read_b64_tr_b16 a[190:191], v12 offset:33792
    s_waitcnt vmcnt(14)
    v_mfma_f32_32x32x16_bf16 v[48:63], a[64:67], v[112:115], v[48:63]
    ds_read_b64_tr_b16 a[192:193], v10 offset:34816
    ds_read_b64_tr_b16 a[196:197], v12 offset:34816
    buffer_load_dwordx4 v[168:171], v241, s[40:43], s87 offen offset:2048 sc1
    v_mfma_f32_32x32x16_bf16 v[64:79], a[68:71], v[112:115], v[64:79]
    ds_read_b64_tr_b16 a[194:195], v3 offset:28672
    s_waitcnt vmcnt(14)
    v_mfma_f32_32x32x16_bf16 v[48:63], a[72:75], v[116:119], v[48:63]
    ds_read_b64_tr_b16 a[198:199], v4 offset:28672
    buffer_load_dwordx4 v[172:175], v241, s[40:43], s87 offen offset:3072 sc1
    v_mfma_f32_32x32x16_bf16 v[64:79], a[76:79], v[116:119], v[64:79]
    ds_read_b64_tr_b16 a[200:201], v3 offset:29696
    ds_read_b64_tr_b16 a[204:205], v4 offset:29696
    s_waitcnt vmcnt(13)
    v_mfma_f32_32x32x16_bf16 v[48:63], a[80:83], v[120:123], v[48:63]
    buffer_load_dwordx4 v[80:83], v241, s[40:43], s88 offen offset:0 sc1
    ds_read_b64_tr_b16 a[202:203], v3 offset:30720
    ds_read_b64_tr_b16 a[206:207], v4 offset:30720
    s_mov_b64 exec, 1
    buffer_store_dword v13, v8, s[40:43], s100 offen offset:16 sc1
    s_mov_b64 exec, -1
    v_mfma_f32_32x32x16_bf16 v[64:79], a[84:87], v[120:123], v[64:79]
    ds_read_b64_tr_b16 a[208:209], v3 offset:31744
    ds_read_b64_tr_b16 a[212:213], v4 offset:31744
    s_waitcnt vmcnt(14)
    v_mfma_f32_32x32x16_bf16 v[48:63], a[88:91], v[124:127], v[48:63]
    ds_read_b64_tr_b16 a[210:211], v3 offset:32768
    buffer_load_dwordx4 v[84:87], v241, s[40:43], s88 offen offset:1024 sc1
    v_mfma_f32_32x32x16_bf16 v[64:79], a[92:95], v[124:127], v[64:79]
    ds_read_b64_tr_b16 a[214:215], v4 offset:32768
    ds_read_b64_tr_b16 a[216:217], v3 offset:33792
    s_waitcnt vmcnt(14)
    v_mfma_f32_32x32x16_bf16 v[48:63], a[96:99], v[128:131], v[48:63]
    ds_read_b64_tr_b16 a[220:221], v4 offset:33792
    ds_read_b64_tr_b16 a[218:219], v3 offset:34816
    buffer_load_dwordx4 v[88:91], v241, s[40:43], s88 offen offset:2048 sc1
    v_mfma_f32_32x32x16_bf16 v[64:79], a[100:103], v[128:131], v[64:79]
    ds_read_b64_tr_b16 a[222:223], v4 offset:34816
    s_waitcnt vmcnt(14)
    v_mfma_f32_32x32x16_bf16 v[48:63], a[104:107], v[132:135], v[48:63]
    buffer_load_dwordx4 v[92:95], v241, s[40:43], s88 offen offset:3072 sc1
    v_mfma_f32_32x32x16_bf16 v[64:79], a[108:111], v[132:135], v[64:79]
    v_lshrrev_b32 v242, 3, v1
    v_and_b32 v243, 2, v242
    v_lshlrev_b32 v243, 1, v243
    v_and_b32 v244, 7, v1
    s_waitcnt vmcnt(14)
    v_mfma_f32_32x32x16_bf16 v[48:63], a[112:115], v[136:139], v[48:63]
    buffer_load_dwordx4 v[96:99], v240, s[40:43], s82 offen offset:0 sc1
    v_xor_b32 v243, v243, v244
    v_mul_u32_u24 v242, 4224, v242
    v_lshl_add_u32 v242, v243, 4, v242
    v_mfma_f32_32x32x16_bf16 v[64:79], a[116:119], v[136:139], v[64:79]
    s_lshl_b32 s56, s50, 6
    s_lshl_b32 s57, s48, 4
    s_add_u32 s56, s57, s56
    s_waitcnt vmcnt(14)
    v_mfma_f32_32x32x16_bf16 v[48:63], a[120:123], v[140:143], v[48:63]
    buffer_load_dwordx4 v[100:103], v240, s[40:43], s82 offen offset:1024 sc1
    s_mul_i32 s57, s56, 4224
    s_lshl_b32 s58, s49, 7
    s_add_u32 s57, s57, s58
    v_mfma_f32_32x32x16_bf16 v[64:79], a[124:127], v[140:143], v[64:79]
    v_add_u32 v242, s57, v242
    v_lshrrev_b32 v243, 2, v1
    v_mul_u32_u24 v229, 896, v243
    s_waitcnt vmcnt(14)
    v_mfma_f32_32x32x16_bf16 v[48:63], a[128:131], v[144:147], v[48:63]
    buffer_load_dwordx4 v[104:107], v240, s[40:43], s82 offen offset:2048 sc1
    v_mul_u32_u24 v231, 80, v243
    v_add_u32 v243, s56, v243
    v_add_u32 v244, 1344, v243
    v_mul_u32_u24 v244, 9363, v244
    v_mfma_f32_32x32x16_bf16 v[64:79], a[132:135], v[144:147], v[64:79]
    v_lshrrev_b32 v244, 16, v244
    v_min_u32 v243, v243, v244
    v_lshlrev_b32 v243, 7, v243
    s_waitcnt vmcnt(14)
    s_waitcnt lgkmcnt(15)
    v_mfma_f32_32x32x16_bf16 v[48:63], a[136:139], v[148:151], v[48:63]
    buffer_load_dwordx4 v[108:111], v240, s[40:43], s82 offen offset:3072 sc1
    v_and_b32 v244, 3, v1
    v_lshl_add_u32 v243, v244, 2, v243
    v_lshl_add_u32 v229, v244, 4, v229
    v_mfma_f32_32x32x16_bf16 v[64:79], a[140:143], v[148:151], v[64:79]
    v_lshl_add_u32 v231, v244, 4, v231
    s_lshl_b32 s59, s48, 11
    s_and_b32 s56, s48, 1
    s_waitcnt vmcnt(14)
    v_mfma_f32_32x32x16_bf16 v[48:63], a[144:147], v[152:155], v[48:63]
    buffer_load_dwordx4 v[112:115], v240, s[40:43], s83 offen offset:0 sc1
    s_lshr_b32 s57, s48, 1
    s_xor_b32 s58, s56, s57
    s_lshl_b32 s58, s58, 6
    v_mfma_f32_32x32x16_bf16 v[64:79], a[148:151], v[152:155], v[64:79]
    v_xor_b32 v228, s58, v3
    s_lshl_b32 s58, s56, 12
    s_add_u32 s58, s58, 149504
    s_sub_u32 s58, s58, s60
    s_waitcnt vmcnt(14)
    v_mfma_f32_32x32x16_bf16 v[48:63], a[152:155], v[156:159], v[48:63]
    buffer_load_dwordx4 v[116:119], v240, s[40:43], s83 offen offset:1024 sc1
    v_add_u32 v228, s58, v228
    s_lshl_b32 s58, s49, 1
    s_add_u32 s57, s57, s58
    v_mfma_f32_32x32x16_bf16 v[64:79], a[156:159], v[156:159], v[64:79]
    s_mul_i32 s57, s57, 28672
    s_lshl_b32 s56, s56, 6
    s_add_u32 s57, s57, s56
    s_waitcnt vmcnt(14)
    v_mfma_f32_32x32x16_bf16 v[48:63], a[160:163], v[160:163], v[48:63]
    buffer_load_dwordx4 v[120:123], v240, s[40:43], s83 offen offset:2048 sc1
    s_lshl_b32 s56, s50, 7
    s_add_u32 s57, s57, s56
    v_add_u32 v229, s57, v229
    v_mfma_f32_32x32x16_bf16 v[64:79], a[164:167], v[160:163], v[64:79]
    s_add_u32 s56, s60, 90112
    v_add_u32 v231, s56, v231
    v_and_b32 v230, 31, v1
    s_waitcnt vmcnt(14)
    s_waitcnt lgkmcnt(14)
    v_mfma_f32_32x32x16_bf16 v[48:63], a[168:171], v[164:167], v[48:63]
    buffer_load_dwordx4 v[124:127], v240, s[40:43], s83 offen offset:3072 sc1
    v_mul_u32_u24 v230, 80, v230
    v_lshrrev_b32 v244, 5, v1
    v_lshl_add_u32 v230, v244, 3, v230
    v_add_u32 v230, s56, v230
    v_mfma_f32_32x32x16_bf16 v[64:79], a[172:175], v[164:167], v[64:79]
    s_xor_b32 s56, s48, 0
    s_mul_i32 s56, s56, 12288
    v_add_u32 v224, s56, v2
    s_waitcnt vmcnt(14)
    v_mfma_f32_32x32x16_bf16 v[48:63], a[176:179], v[168:171], v[48:63]
    buffer_load_dwordx4 v[128:131], v240, s[40:43], s84 offen offset:0 sc1
    s_xor_b32 s56, s48, 1
    s_mul_i32 s56, s56, 12288
    v_add_u32 v225, s56, v2
    v_mfma_f32_32x32x16_bf16 v[64:79], a[180:183], v[168:171], v[64:79]
    s_xor_b32 s56, s48, 2
    s_mul_i32 s56, s56, 12288
    v_add_u32 v226, s56, v2
    s_waitcnt vmcnt(14)
    v_mfma_f32_32x32x16_bf16 v[48:63], a[184:187], v[172:175], v[48:63]
    buffer_load_dwordx4 v[132:135], v240, s[40:43], s84 offen offset:1024 sc1
    s_xor_b32 s56, s48, 3
    s_mul_i32 s56, s56, 12288
    v_add_u32 v227, s56, v2
    v_mfma_f32_32x32x16_bf16 v[64:79], a[188:191], v[172:175], v[64:79]
    v_accvgpr_read_b32 v16, a240
    v_accvgpr_read_b32 v17, a241
    v_accvgpr_read_b32 v18, a242
    v_accvgpr_read_b32 v19, a243
    s_waitcnt vmcnt(14)
    s_waitcnt lgkmcnt(0)
    v_mfma_f32_32x32x16_bf16 v[48:63], a[192:195], v[80:83], v[48:63]
    buffer_load_dwordx4 v[136:139], v240, s[40:43], s84 offen offset:2048 sc1
    v_accvgpr_read_b32 v20, a244
    v_accvgpr_read_b32 v21, a245
    v_accvgpr_read_b32 v22, a246
    v_mfma_f32_32x32x16_bf16 v[64:79], a[196:199], v[80:83], v[64:79]
    v_accvgpr_read_b32 v23, a247
    v_accvgpr_read_b32 v24, a248
    v_accvgpr_read_b32 v25, a249
    s_waitcnt vmcnt(13)
    v_mfma_f32_32x32x16_bf16 v[48:63], a[200:203], v[84:87], v[48:63]
    buffer_load_dwordx4 v[140:143], v240, s[40:43], s84 offen offset:3072 sc1
    v_accvgpr_read_b32 v26, a250
    v_accvgpr_read_b32 v27, a251
    v_accvgpr_read_b32 v28, a252
    v_mfma_f32_32x32x16_bf16 v[64:79], a[204:207], v[84:87], v[64:79]
    v_accvgpr_read_b32 v29, a253
    v_accvgpr_read_b32 v30, a254
    v_accvgpr_read_b32 v31, a255
    s_waitcnt vmcnt(13)
    v_mfma_f32_32x32x16_bf16 v[48:63], a[208:211], v[88:91], v[48:63]
    buffer_load_dwordx4 v[144:147], v240, s[40:43], s85 offen offset:0 sc1
    v_mfma_f32_32x32x16_bf16 v[64:79], a[212:215], v[88:91], v[64:79]
    s_waitcnt vmcnt(13)
    v_mfma_f32_32x32x16_bf16 v[48:63], a[216:219], v[92:95], v[48:63]
    buffer_load_dwordx4 v[148:151], v240, s[40:43], s85 offen offset:1024 sc1
    s_barrier
    v_mfma_f32_32x32x16_bf16 v[64:79], a[220:223], v[92:95], v[64:79]
    s_waitcnt vmcnt(13)
    v_mfma_f32_32x32x16_bf16 v[32:47], a[4:7], v[96:99], 0
    buffer_load_dwordx4 v[152:155], v240, s[40:43], s85 offen offset:2048 sc1
    s_waitcnt vmcnt(13)
    v_mfma_f32_32x32x16_bf16 v[32:47], a[12:15], v[100:103], v[32:47]
    buffer_load_dwordx4 v[156:159], v240, s[40:43], s85 offen offset:3072 sc1
    s_waitcnt vmcnt(13)
    v_mfma_f32_32x32x16_bf16 v[32:47], a[20:23], v[104:107], v[32:47]
    buffer_load_dwordx4 v[160:163], v240, s[40:43], s86 offen offset:0 sc1
    s_waitcnt vmcnt(13)
    v_mfma_f32_32x32x16_bf16 v[32:47], a[28:31], v[108:111], v[32:47]
    ds_write_b128 v226, v[48:51] offset:4096
    buffer_load_dwordx4 v[164:167], v240, s[40:43], s86 offen offset:1024 sc1
    s_waitcnt vmcnt(13)
    v_mfma_f32_32x32x16_bf16 v[32:47], a[36:39], v[112:115], v[32:47]
    buffer_load_dwordx4 v[168:171], v240, s[40:43], s86 offen offset:2048 sc1
    v_mfma_f32_32x32x16_bf16 v[16:31], a[0:3], v[96:99], v[16:31]
    ds_write_b128 v226, v[52:55] offset:5120
    s_waitcnt vmcnt(13)
    v_mfma_f32_32x32x16_bf16 v[32:47], a[44:47], v[116:119], v[32:47]
    buffer_load_dwordx4 v[172:175], v240, s[40:43], s86 offen offset:3072 sc1
    v_mfma_f32_32x32x16_bf16 v[16:31], a[8:11], v[100:103], v[16:31]
    ds_write_b128 v226, v[56:59] offset:6144
    s_waitcnt vmcnt(13)
    v_mfma_f32_32x32x16_bf16 v[32:47], a[52:55], v[120:123], v[32:47]
    buffer_load_dwordx4 v[80:83], v240, s[40:43], s87 offen offset:0 sc1
    v_mfma_f32_32x32x16_bf16 v[16:31], a[16:19], v[104:107], v[16:31]
    ds_write_b128 v226, v[60:63] offset:7168
    s_waitcnt vmcnt(13)
    v_mfma_f32_32x32x16_bf16 v[32:47], a[60:63], v[124:127], v[32:47]
    buffer_load_dwordx4 v[84:87], v240, s[40:43], s87 offen offset:1024 sc1
    buffer_load_dword v244, v243, s[40:43], s100 offen offset:16 sc1
    v_mfma_f32_32x32x16_bf16 v[16:31], a[24:27], v[108:111], v[16:31]
    ds_write_b128 v227, v[64:67] offset:8192
    s_waitcnt vmcnt(14)
    v_mfma_f32_32x32x16_bf16 v[32:47], a[68:71], v[128:131], v[32:47]
    buffer_load_dwordx4 v[88:91], v240, s[40:43], s87 offen offset:2048 sc1
    v_mfma_f32_32x32x16_bf16 v[16:31], a[32:35], v[112:115], v[16:31]
    ds_write_b128 v227, v[68:71] offset:9216
    s_waitcnt vmcnt(14)
    v_mfma_f32_32x32x16_bf16 v[32:47], a[76:79], v[132:135], v[32:47]
    buffer_load_dwordx4 v[92:95], v240, s[40:43], s87 offen offset:3072 sc1
    v_mfma_f32_32x32x16_bf16 v[16:31], a[40:43], v[116:119], v[16:31]
    ds_write_b128 v227, v[72:75] offset:10240
    s_waitcnt vmcnt(14)
    v_mfma_f32_32x32x16_bf16 v[32:47], a[84:87], v[136:139], v[32:47]
    buffer_load_dwordx4 v[96:99], v240, s[40:43], s88 offen offset:0 sc1
    v_mfma_f32_32x32x16_bf16 v[16:31], a[48:51], v[120:123], v[16:31]
    ds_write_b128 v227, v[76:79] offset:11264
    s_waitcnt vmcnt(14)
    v_mfma_f32_32x32x16_bf16 v[32:47], a[92:95], v[140:143], v[32:47]
    buffer_load_dwordx4 v[100:103], v240, s[40:43], s88 offen offset:1024 sc1
    v_mfma_f32_32x32x16_bf16 v[16:31], a[56:59], v[124:127], v[16:31]
    s_waitcnt vmcnt(14)
    v_mfma_f32_32x32x16_bf16 v[32:47], a[100:103], v[144:147], v[32:47]
    buffer_load_dwordx4 v[104:107], v240, s[40:43], s88 offen offset:2048 sc1
    v_mfma_f32_32x32x16_bf16 v[16:31], a[64:67], v[128:131], v[16:31]
    s_waitcnt vmcnt(14)
    v_mfma_f32_32x32x16_bf16 v[32:47], a[108:111], v[148:151], v[32:47]
    buffer_load_dwordx4 v[108:111], v240, s[40:43], s88 offen offset:3072 sc1
    s_waitcnt lgkmcnt(0)
    s_barrier
    v_mfma_f32_32x32x16_bf16 v[16:31], a[72:75], v[132:135], v[16:31]
    ds_read_b128 v[176:179], v224 offset:4096
    s_waitcnt vmcnt(14)
    v_mfma_f32_32x32x16_bf16 v[32:47], a[116:119], v[152:155], v[32:47]
    ds_read_b128 v[180:183], v224 offset:5120
    v_mfma_f32_32x32x16_bf16 v[16:31], a[80:83], v[136:139], v[16:31]
    ds_read_b128 v[184:187], v224 offset:6144
    s_waitcnt vmcnt(13)
    v_mfma_f32_32x32x16_bf16 v[32:47], a[124:127], v[156:159], v[32:47]
    ds_read_b128 v[188:191], v224 offset:7168
    v_mfma_f32_32x32x16_bf16 v[16:31], a[88:91], v[140:143], v[16:31]
    ds_read_b128 v[192:195], v224 offset:8192
    s_waitcnt vmcnt(12)
    v_mfma_f32_32x32x16_bf16 v[32:47], a[132:135], v[160:163], v[32:47]
    ds_read_b128 v[196:199], v224 offset:9216
    v_mfma_f32_32x32x16_bf16 v[16:31], a[96:99], v[144:147], v[16:31]
    ds_read_b128 v[200:203], v224 offset:10240
    s_waitcnt vmcnt(11)
    v_mfma_f32_32x32x16_bf16 v[32:47], a[140:143], v[164:167], v[32:47]
    ds_read_b128 v[204:207], v224 offset:11264
    v_mfma_f32_32x32x16_bf16 v[16:31], a[104:107], v[148:151], v[16:31]
    s_waitcnt vmcnt(10)
    v_mfma_f32_32x32x16_bf16 v[32:47], a[148:151], v[168:171], v[32:47]
    v_mfma_f32_32x32x16_bf16 v[16:31], a[112:115], v[152:155], v[16:31]
    s_waitcnt vmcnt(9)
    v_mfma_f32_32x32x16_bf16 v[32:47], a[156:159], v[172:175], v[32:47]
    s_waitcnt lgkmcnt(0)
    v_add_f32 v208, v176, v192
    v_add_f32 v209, v177, v193
    v_add_f32 v210, v178, v194
    v_mfma_f32_32x32x16_bf16 v[16:31], a[120:123], v[156:159], v[16:31]
    v_add_f32 v211, v179, v195
    v_add_f32 v212, v180, v196
    v_add_f32 v213, v181, v197
    s_waitcnt vmcnt(8)
    v_mfma_f32_32x32x16_bf16 v[32:47], a[164:167], v[80:83], v[32:47]
    s_waitcnt vmcnt(6)
    v_cmp_ne_u32 vcc, s65, v244
    s_cbranch_vccz L_ok31
    s_mov_b32 s55, 0
L_spin32:
    buffer_load_dword v244, v243, s[40:43], s100 offen offset:16 sc1
    s_waitcnt vmcnt(0)
    v_cmp_ne_u32 vcc, s65, v244
    s_cbranch_vccz L_spun33
    s_sleep 6
    s_add_u32 s55, s55, 1
    s_cmp_lt_u32 s55, 1048576
    s_cbranch_scc1 L_spin32
L_spun33:
L_ok31:
    s_add_u32 m0, s59, 149504
    s_mov_b32 s54, 6815744
    buffer_load_dwordx4 v242, s[40:43], s54 offen sc1 lds
    s_mov_b32 s54, 6848512
    buffer_load_dwordx4 v242, s[40:43], s54 offen offset:1024 sc1 lds
    v_add_f32 v214, v182, v198
    v_add_f32 v215, v183, v199
    v_add_f32 v216, v184, v200
    v_mfma_f32_32x32x16_bf16 v[16:31], a[128:131], v[160:163], v[16:31]
    v_add_f32 v217, v185, v201
    v_add_f32 v218, v186, v202
    v_add_f32 v219, v187, v203
    v_add_f32 v220, v188, v204
    v_mfma_f32_32x32x16_bf16 v[32:47], a[172:175], v[84:87], v[32:47]
    v_add_f32 v221, v189, v205
    v_add_f32 v222, v190, v206
    v_add_f32 v223, v191, v207
    v_mfma_f32_32x32x16_bf16 v[16:31], a[136:139], v[164:167], v[16:31]
    v_accvgpr_read_b32 v176, a224
    v_accvgpr_read_b32 v177, a225
    v_accvgpr_read_b32 v178, a226
    s_waitcnt vmcnt(7)
    v_mfma_f32_32x32x16_bf16 v[32:47], a[180:183], v[88:91], v[32:47]
    v_accvgpr_read_b32 v179, a227
    v_accvgpr_read_b32 v180, a228
    v_accvgpr_read_b32 v181, a229
    v_accvgpr_read_b32 v182, a230
    v_mfma_f32_32x32x16_bf16 v[16:31], a[144:147], v[168:171], v[16:31]
    v_accvgpr_read_b32 v183, a231
    v_accvgpr_read_b32 v184, a232
    v_accvgpr_read_b32 v185, a233
    s_waitcnt vmcnt(6)
    v_mfma_f32_32x32x16_bf16 v[32:47], a[188:191], v[92:95], v[32:47]
    v_accvgpr_read_b32 v186, a234
    v_accvgpr_read_b32 v187, a235
    v_accvgpr_read_b32 v188, a236
    v_mfma_f32_32x32x16_bf16 v[16:31], a[152:155], v[172:175], v[16:31]
    v_accvgpr_read_b32 v189, a237
    v_accvgpr_read_b32 v190, a238
    v_accvgpr_read_b32 v191, a239
    s_waitcnt vmcnt(5)
    v_mfma_f32_32x32x16_bf16 v[32:47], a[196:199], v[96:99], v[32:47]
    v_mfma_f32_32x32x16_bf16 v[16:31], a[160:163], v[80:83], v[16:31]
    s_waitcnt vmcnt(4)
    v_mfma_f32_32x32x16_bf16 v[32:47], a[204:207], v[100:103], v[32:47]
    v_mfma_f32_32x32x16_bf16 v[16:31], a[168:171], v[84:87], v[16:31]
    s_waitcnt vmcnt(3)
    v_mfma_f32_32x32x16_bf16 v[32:47], a[212:215], v[104:107], v[32:47]
    v_mfma_f32_32x32x16_bf16 v[16:31], a[176:179], v[88:91], v[16:31]
    s_waitcnt vmcnt(2)
    v_mfma_f32_32x32x16_bf16 v[32:47], a[220:223], v[108:111], v[32:47]
    v_mfma_f32_32x32x16_bf16 v[16:31], a[184:187], v[92:95], v[16:31]
    v_mfma_f32_32x32x16_bf16 v[16:31], a[192:195], v[96:99], v[16:31]
    v_mfma_f32_32x32x16_bf16 v[16:31], a[200:203], v[100:103], v[16:31]
    s_nop 8
    ds_write_b128 v225, v[32:35] offset:0
    ds_write_b128 v225, v[36:39] offset:1024
    v_mfma_f32_32x32x16_bf16 v[16:31], a[208:211], v[104:107], v[16:31]
    ds_write_b128 v225, v[40:43] offset:2048
    v_mfma_f32_32x32x16_bf16 v[16:31], a[216:219], v[108:111], v[16:31]
    ds_write_b128 v225, v[44:47] offset:3072
    s_waitcnt lgkmcnt(0)
    s_waitcnt vmcnt(0)
    s_barrier
    ds_read_b64_tr_b16 v[80:81], v228 offset:0
    ds_read_b64_tr_b16 v[82:83], v228 offset:1024
    ds_read_b64_tr_b16 v[84:85], v228 offset:2048
    ds_read_b64_tr_b16 v[86:87], v228 offset:3072
    ds_read_b128 v[192:195], v224 offset:0
    ds_read_b128 v[196:199], v224 offset:1024
    ds_read_b128 v[200:203], v224 offset:2048
    ds_read_b128 v[204:207], v224 offset:3072
    v_pk_add_f32 v[16:17], v[16:17], v[208:209]
    v_pk_add_f32 v[18:19], v[18:19], v[210:211]
    v_pk_add_f32 v[20:21], v[20:21], v[212:213]
    v_pk_add_f32 v[22:23], v[22:23], v[214:215]
    v_pk_add_f32 v[24:25], v[24:25], v[216:217]
    v_pk_add_f32 v[26:27], v[26:27], v[218:219]
    v_pk_add_f32 v[28:29], v[28:29], v[220:221]
    v_pk_add_f32 v[30:31], v[30:31], v[222:223]
    s_waitcnt lgkmcnt(4)
    v_lshlrev_b32 v96, 16, v80
    v_and_b32 v97, 0xffff0000, v80
    v_lshlrev_b32 v98, 16, v81
    v_and_b32 v99, 0xffff0000, v81
    v_lshlrev_b32 v100, 16, v82
    v_and_b32 v101, 0xffff0000, v82
    v_lshlrev_b32 v102, 16, v83
    v_and_b32 v103, 0xffff0000, v83
    v_lshlrev_b32 v104, 16, v84
    v_and_b32 v105, 0xffff0000, v84
    v_lshlrev_b32 v106, 16, v85
    v_and_b32 v107, 0xffff0000, v85
    v_lshlrev_b32 v108, 16, v86
    v_and_b32 v109, 0xffff0000, v86
    v_lshlrev_b32 v110, 16, v87
    v_and_b32 v111, 0xffff0000, v87
    v_pk_fma_f32 v[16:17], v[176:177], v[96:97], v[16:17]
    v_pk_fma_f32 v[18:19], v[178:179], v[98:99], v[18:19]
    v_pk_fma_f32 v[20:21], v[180:181], v[100:101], v[20:21]
    v_pk_fma_f32 v[22:23], v[182:183], v[102:103], v[22:23]
    v_pk_fma_f32 v[24:25], v[184:185], v[104:105], v[24:25]
    v_pk_fma_f32 v[26:27], v[186:187], v[106:107], v[26:27]
    v_pk_fma_f32 v[28:29], v[188:189], v[108:109], v[28:29]
    v_pk_fma_f32 v[30:31], v[190:191], v[110:111], v[30:31]
    s_waitcnt lgkmcnt(0)
    v_pk_add_f32 v[16:17], v[16:17], v[192:193]
    v_pk_add_f32 v[18:19], v[18:19], v[194:195]
    v_pk_add_f32 v[20:21], v[20:21], v[196:197]
    v_pk_add_f32 v[22:23], v[22:23], v[198:199]
    v_pk_add_f32 v[24:25], v[24:25], v[200:201]
    v_pk_add_f32 v[26:27], v[26:27], v[202:203]
    v_pk_add_f32 v[28:29], v[28:29], v[204:205]
    v_pk_add_f32 v[30:31], v[30:31], v[206:207]
    v_cvt_pk_bf16_f32 v112, v16, v17
    v_cvt_pk_bf16_f32 v113, v18, v19
    v_cvt_pk_bf16_f32 v114, v20, v21
    v_cvt_pk_bf16_f32 v115, v22, v23
    v_cvt_pk_bf16_f32 v116, v24, v25
    v_cvt_pk_bf16_f32 v117, v26, v27
    v_cvt_pk_bf16_f32 v118, v28, v29
    v_cvt_pk_bf16_f32 v119, v30, v31
    ds_write_b64 v230, v[112:113] offset:0
    ds_write_b64 v230, v[114:115] offset:16
    ds_write_b64 v230, v[116:117] offset:32
    ds_write_b64 v230, v[118:119] offset:48
    ds_read_b128 v[120:123], v231 offset:0
    ds_read_b128 v[124:127], v231 offset:1280
    s_mov_b32 s56, 14336
    s_waitcnt lgkmcnt(1)
    buffer_store_dwordx4 v[120:123], v229, s[36:39], 0 offen nt
    s_waitcnt lgkmcnt(0)
    buffer_store_dwordx4 v[124:127], v229, s[36:39], s56 offen nt
    s_endpgm
.p2align 12
L_conv:
    v_lshrrev_b32 v2, 6, v0
    v_and_b32 v1, 63, v0
    v_readfirstlane_b32 s48, v2
    s_load_dwordx2 s[8:9], s[0:1], 8
    s_mov_b32 s10, 1835008
    s_mov_b32 s11, 0x20000
    s_load_dwordx2 s[12:13], s[0:1], 16
    s_mov_b32 s14, 1835008
    s_mov_b32 s15, 0x20000
    s_load_dwordx2 s[16:17], s[0:1], 24
    s_mov_b32 s18, 3584
    s_mov_b32 s19, 0x20000
    s_load_dwordx2 s[40:41], s[0:1], 104
    s_mov_b32 s42, 17825792
    s_mov_b32 s43, 0x20000
    s_load_dwordx2 s[44:45], s[0:1], 32
    s_mov_b32 s46, 1835008
    s_mov_b32 s47, 0x20000
    s_load_dwordx2 s[36:37], s[0:1], 40
    s_mov_b32 s38, 896
    s_mov_b32 s39, 0x20000
    s_load_dwordx2 s[28:29], s[0:1], 72
    s_mov_b32 s30, 1605632
    s_mov_b32 s31, 0x20000
    s_and_b32 s49, s2, 7
    s_lshl_b32 s49, s49, 2
    s_add_u32 s49, s49, s57
    s_sub_u32 s49, s49, 28
    v_mov_b32 v3, 0
    v_lshrrev_b32 v4, 3, v1
    v_and_b32 v5, 7, v1
    v_and_b32 v218, 2, v4
    v_xor_b32 v5, v5, v218
    v_mul_u32_u24 v216, 896, v4
    v_lshl_add_u32 v216, v5, 4, v216
    v_xor_b32 v218, 64, v216
    s_and_b32 s57, s48, 1
    s_lshl_b32 s57, s57, 6
    v_xor_b32 v216, s57, v216
    s_lshl_b32 s56, s49, 2
    s_add_u32 s56, s56, s48
    s_mul_i32 s56, s56, 14336
    v_add_u32 v216, s56, v216
    v_add_u32 v217, 6144, v216
    s_mul_i32 s56, s49, 57344
    s_sub_u32 s56, s56, 3584
    v_add_u32 v218, s56, v218
    s_lshl_b32 s61, s48, 11
    v_and_b32 v28, 15, v1
    v_lshrrev_b32 v29, 4, v1
    s_lshl_b32 s59, s48, 7
    v_lshl_add_u32 v219, v28, 3, s59
    s_mul_i32 s56, s48, 56
    v_min_u32 v49, 55, v1
    v_add_lshl_u32 v49, v49, s56, 7
    s_mul_i32 s56, s48, 49
    v_min_u32 v51, 48, v1
    v_add_lshl_u32 v51, v51, s56, 7
    s_mul_i32 s56, s48, 14
    v_min_u32 v50, 13, v1
    v_add_lshl_u32 v50, v50, s56, 7
    s_waitcnt lgkmcnt(0)
    s_load_dwordx2 s[32:33], s[0:1], 80
    s_mov_b32 s34, 1605632
    s_mov_b32 s35, 0x20000
    s_mov_b64 exec, 0x7fffffff
    s_mov_b32 exec_lo, -1
    s_add_u32 s58, s48, 0
    s_min_u32 s58, s58, 6
    s_add_u32 s54, s58, 3
    s_lshl_b32 s54, s54, 7
    v_add_u32 v4, s54, v218
    s_mul_i32 m0, s58, 16896
    s_nop 0
    buffer_load_dwordx4 v4, s[8:11], 0 offen lds
    s_add_u32 s58, s48, 4
    s_min_u32 s58, s58, 6
    s_add_u32 s54, s58, -4
    s_lshl_b32 s54, s54, 7
    v_add_u32 v4, s54, v218
    s_mul_i32 m0, s58, 16896
    s_nop 0
    buffer_load_dwordx4 v4, s[8:11], 0 offen lds
    s_mov_b64 exec, -1
    buffer_load_dwordx2 v[104:105], v219, s[16:19], 0 offen offset:1536
    s_mov_b32 s54, 384
    s_add_u32 m0, s61, 512
    s_nop 0
    buffer_load_dwordx4 v216, s[8:11], s54 offen lds
    buffer_load_dwordx4 v217, s[8:11], s54 offen offset:1024 lds
    s_add_u32 m0, s61, 8704
    s_nop 0
    buffer_load_dwordx4 v216, s[12:15], s54 offen lds
    buffer_load_dwordx4 v217, s[12:15], s54 offen offset:1024 lds
    s_getpc_b64 s[82:83]
L_pc:
    s_sub_u32 s82, s82, L_pc-parallel_sum__ssm_conv_h3__mixer_s_mlp__prompt_kernel
    s_subb_u32 s83, s83, 0
    s_mov_b32 s74, L_codeend-parallel_sum__ssm_conv_h3__mixer_s_mlp__prompt_kernel
    s_and_b32 s56, s49, 3
    s_lshl_b32 s56, s56, 7
    v_lshl_add_u32 v62, v0, 9, s56
    v_min_u32 v62, s74, v62
    v_mov_b32 v63, s83
    v_add_co_u32 v62, vcc, s82, v62
    s_nop 1
    v_addc_co_u32 v63, vcc, 0, v63, vcc
    global_load_dword v60, v[62:63], off
    s_mov_b32 s100, 32768
    s_mov_b32 s65, 2064384
    buffer_load_dword v54, v3, s[40:43], s65 offen sc1
    buffer_load_dwordx2 v[106:107], v219, s[16:19], 0 offen offset:2048
    buffer_load_dwordx2 v[108:109], v219, s[16:19], 0 offen offset:2560
    buffer_load_dwordx2 v[110:111], v219, s[16:19], 0 offen offset:3072
    buffer_load_dwordx2 v[112:113], v219, s[16:19], 0 offen offset:0
    buffer_load_dwordx2 v[114:115], v219, s[16:19], 0 offen offset:512
    buffer_load_dwordx2 v[116:117], v219, s[16:19], 0 offen offset:1024
    s_mov_b32 s54, 512
    s_add_u32 m0, s61, 17408
    s_nop 0
    buffer_load_dwordx4 v216, s[8:11], s54 offen lds
    buffer_load_dwordx4 v217, s[8:11], s54 offen offset:1024 lds
    s_add_u32 m0, s61, 25600
    s_nop 0
    buffer_load_dwordx4 v216, s[12:15], s54 offen lds
    buffer_load_dwordx4 v217, s[12:15], s54 offen offset:1024 lds
    s_mov_b32 s54, 640
    s_add_u32 m0, s61, 34304
    s_nop 0
    buffer_load_dwordx4 v216, s[8:11], s54 offen lds
    buffer_load_dwordx4 v217, s[8:11], s54 offen offset:1024 lds
    s_add_u32 m0, s61, 42496
    s_nop 0
    buffer_load_dwordx4 v216, s[12:15], s54 offen lds
    buffer_load_dwordx4 v217, s[12:15], s54 offen offset:1024 lds
    v_bfe_u32 v4, v1, 3, 2
    v_xor_b32 v4, s48, v4
    v_and_b32 v5, 3, v1
    v_lshlrev_b32 v5, 3, v5
    v_lshl_add_u32 v223, v4, 5, v5
    v_bfe_u32 v4, v1, 2, 2
    v_lshl_add_u32 v223, v4, 7, v223
    v_lshl_add_u32 v223, v29, 11, v223
    v_xor_b32 v224, 64, v223
    s_mov_b32 s63, 0xffff
    s_mul_i32 s57, s48, 2304
    s_add_u32 s57, s57, 118272
    v_mul_u32_u24 v221, 144, v28
    v_sub_u32 v4, 3, v29
    v_lshl_add_u32 v221, v4, 5, v221
    v_add_u32 v221, s57, v221
    v_lshrrev_b32 v220, 3, v1
    v_and_b32 v4, 7, v1
    v_lshlrev_b32 v4, 4, v4
    v_mul_u32_u24 v222, 144, v220
    v_add3_u32 v222, v222, v4, s57
    v_mul_u32_u24 v220, 4224, v220
    s_mul_i32 s59, s48, 67584
    s_lshl_b32 s56, s49, 7
    s_sub_u32 s56, s59, s56
    s_add_u32 s56, s56, 4722560
    v_add3_u32 v220, v220, v4, s56
    s_add_u32 s53, s49, 224
    s_lshl_b32 s56, s53, 7
    v_mov_b32 v6, s56
    v_lshlrev_b32 v2, 4, v1
    s_mul_i32 s60, s48, 12928
    v_and_b32 v4, 1, v29
    v_lshlrev_b32 v4, 9, v4
    v_lshl_add_u32 v4, v28, 5, v4
    v_lshrrev_b32 v5, 1, v29
    v_lshl_add_u32 v4, v5, 4, v4
    s_mul_i32 s70, s49, 7
    s_add_u32 s70, s70, s48
    s_add_u32 s70, s70, 0
    s_add_u32 s70, s70, 224
    s_lshl_b32 s56, s70, 12
    v_add_u32 v8, s56, v2
    s_mul_i32 s58, s70, 4224
    v_add_u32 v12, s58, v2
    s_add_u32 s58, s58, 6815744
    v_add_u32 v16, s58, v4
    s_lshl_b32 s58, s70, 1
    buffer_load_ushort v24, v3, s[44:47], s56 offen
    buffer_load_ushort v20, v3, s[36:39], s58 offen
    s_mul_i32 s70, s49, 7
    s_add_u32 s70, s70, s48
    s_add_u32 s70, s70, 3
    s_add_u32 s70, s70, 224
    s_lshl_b32 s56, s70, 12
    v_add_u32 v9, s56, v2
    s_mul_i32 s58, s70, 4224
    v_add_u32 v13, s58, v2
    s_add_u32 s58, s58, 6815744
    v_add_u32 v17, s58, v4
    s_lshl_b32 s58, s70, 1
    buffer_load_ushort v25, v3, s[44:47], s56 offen
    buffer_load_ushort v21, v3, s[36:39], s58 offen
    v_add_u32 v4, 1, v28
    v_and_b32 v5, 1, v4
    v_mul_u32_u24 v5, 4160, v5
    v_and_b32 v4, 30, v4
    v_lshl_add_u32 v4, v29, 3, v4
    v_lshl_add_u32 v4, v4, 1, v5
    v_add_u32 v32, s60, v4
    v_lshlrev_b32 v4, 4, v29
    v_lshlrev_b32 v5, 5, v28
    v_sub_u32 v4, v4, v5
    v_add_u32 v4, 8800, v4
    v_add_u32 v40, s60, v4
    v_add_u32 v33, 1024, v32
    v_add_u32 v34, 2048, v32
    v_add_u32 v35, 3072, v32
    v_add_u32 v36, 51712, v32
    v_add_u32 v37, 52736, v32
    v_add_u32 v38, 53760, v32
    v_add_u32 v39, 54784, v32
    v_lshl_add_u32 v4, v29, 3, v28
    v_sub_u32 v4, 15, v4
    v_mov_b32 v52, 0xffff
    v_mov_b32 v53, 0xffff0000
    v_cmp_eq_u32 vcc, 0, v4
    s_nop 1
    v_cndmask_b32 v44, 0, v52, vcc
    v_cmp_eq_u32 vcc, 1, v4
    s_nop 1
    v_cndmask_b32 v44, v44, v53, vcc
    v_cmp_eq_u32 vcc, 2, v4
    s_nop 1
    v_cndmask_b32 v45, 0, v52, vcc
    v_cmp_eq_u32 vcc, 3, v4
    s_nop 1
    v_cndmask_b32 v45, v45, v53, vcc
    v_cmp_eq_u32 vcc, 4, v4
    s_nop 1
    v_cndmask_b32 v46, 0, v52, vcc
    v_cmp_eq_u32 vcc, 5, v4
    s_nop 1
    v_cndmask_b32 v46, v46, v53, vcc
    v_cmp_eq_u32 vcc, 6, v4
    s_nop 1
    v_cndmask_b32 v47, 0, v52, vcc
    v_cmp_eq_u32 vcc, 7, v4
    s_nop 1
    v_cndmask_b32 v47, v47, v53, vcc
    v_mov_b32 v52, 0
    v_mov_b32 v53, 0
    v_lshl_add_u32 v41, v1, 3, s60
    v_bfe_u32 v4, v1, 3, 1
    v_mul_u32_u24 v4, 4160, v4
    v_and_b32 v5, 7, v1
    v_lshl_add_u32 v4, v5, 2, v4
    v_add_u32 v48, s60, v4
    v_lshrrev_b32 v5, 3, v1
    s_lshl_b32 s56, s48, 3
    s_add_u32 s56, s56, 224
    v_add_u32 v7, s56, v5
    v_lshlrev_b32 v7, 7, v7
    s_cmp_eq_u32 s48, 0
    s_cbranch_scc1 L_pgc0
    s_cmp_eq_u32 s48, 1
    s_cbranch_scc1 L_pgc1
    s_cmp_eq_u32 s48, 2
    s_cbranch_scc1 L_pgc2
    s_branch L_pgcret
L_pgcret:
    s_waitcnt lgkmcnt(0)
    s_waitcnt vmcnt(18)
    v_readfirstlane_b32 s65, v54
    s_nop 0
    s_mul_i32 s65, s65, 0x9e3779b1
    s_add_u32 s65, s65, 0x7f4a7c15
    v_mov_b32 v240, s65
    v_mov_b32 v241, s65
    v_mov_b32 v242, s65
    v_mov_b32 v243, s65
    s_barrier
    s_mov_b32 s54, 768
    s_add_u32 m0, s61, 51200
    s_nop 0
    buffer_load_dwordx4 v216, s[8:11], s54 offen lds
    buffer_load_dwordx4 v217, s[8:11], s54 offen offset:1024 lds
    s_add_u32 m0, s61, 59392
    s_nop 0
    buffer_load_dwordx4 v216, s[12:15], s54 offen lds
    buffer_load_dwordx4 v217, s[12:15], s54 offen offset:1024 lds
    ds_read_b64_tr_b16 v[64:65], v224 offset:0
    ds_read_b64_tr_b16 v[66:67], v223 offset:512
    ds_read_b64_tr_b16 v[68:69], v223 offset:1024
    ds_read_b64_tr_b16 v[70:71], v223 offset:1536
    ds_read_b64_tr_b16 v[72:73], v223 offset:2048
    ds_read_b64_tr_b16 v[74:75], v223 offset:8704
    ds_read_b64_tr_b16 v[76:77], v223 offset:9216
    ds_read_b64_tr_b16 v[78:79], v223 offset:9728
    ds_read_b64_tr_b16 v[80:81], v223 offset:10240
    v_alignbit_b32 v176, v105, v105, 16
    v_alignbit_b32 v177, v104, v104, 16
    v_and_b32 v178, 0xffff0000, v105
    v_bfi_b32 v179, s63, v105, v104
    v_and_b32 v180, 0xffff, v104
    s_waitcnt lgkmcnt(0)
    v_dot2_f32_bf16 v184, v64, v178, 0
    v_dot2_f32_bf16 v185, v65, v176, 0
    v_dot2_f32_bf16 v186, v65, v178, 0
    v_dot2_f32_bf16 v187, v66, v176, 0
    v_dot2_f32_bf16 v188, v66, v178, 0
    v_dot2_f32_bf16 v189, v67, v176, 0
    v_dot2_f32_bf16 v190, v67, v178, 0
    v_dot2_f32_bf16 v191, v68, v176, 0
    v_dot2_f32_bf16 v192, v68, v178, 0
    v_dot2_f32_bf16 v193, v69, v176, 0
    v_dot2_f32_bf16 v194, v69, v178, 0
    v_dot2_f32_bf16 v195, v70, v176, 0
    v_dot2_f32_bf16 v196, v70, v178, 0
    v_dot2_f32_bf16 v197, v71, v176, 0
    v_dot2_f32_bf16 v198, v71, v178, 0
    v_dot2_f32_bf16 v199, v72, v176, 0
    v_dot2c_f32_bf16 v184, v65, v179
    v_dot2c_f32_bf16 v185, v66, v177
    v_dot2c_f32_bf16 v186, v66, v179
    v_dot2c_f32_bf16 v187, v67, v177
    v_dot2c_f32_bf16 v188, v67, v179
    v_dot2c_f32_bf16 v189, v68, v177
    v_dot2c_f32_bf16 v190, v68, v179
    v_dot2c_f32_bf16 v191, v69, v177
    v_dot2c_f32_bf16 v192, v69, v179
    v_dot2c_f32_bf16 v193, v70, v177
    v_dot2c_f32_bf16 v194, v70, v179
    v_dot2c_f32_bf16 v195, v71, v177
    v_dot2c_f32_bf16 v196, v71, v179
    v_dot2c_f32_bf16 v197, v72, v177
    v_dot2c_f32_bf16 v198, v72, v179
    v_dot2c_f32_bf16 v199, v73, v177
    s_waitcnt vmcnt(12)
    s_barrier
    s_mov_b32 s54, 0
    s_add_u32 m0, s61, 68096
    s_nop 0
    buffer_load_dwordx4 v216, s[8:11], s54 offen lds
    buffer_load_dwordx4 v217, s[8:11], s54 offen offset:1024 lds
    s_add_u32 m0, s61, 76288
    s_nop 0
    buffer_load_dwordx4 v216, s[12:15], s54 offen lds
    buffer_load_dwordx4 v217, s[12:15], s54 offen offset:1024 lds
    ds_read_b64_tr_b16 v[84:85], v224 offset:16896
    ds_read_b64_tr_b16 v[86:87], v223 offset:17408
    ds_read_b64_tr_b16 v[88:89], v223 offset:17920
    ds_read_b64_tr_b16 v[90:91], v223 offset:18432
    ds_read_b64_tr_b16 v[92:93], v223 offset:18944
    ds_read_b64_tr_b16 v[94:95], v223 offset:25600
    ds_read_b64_tr_b16 v[96:97], v223 offset:26112
    ds_read_b64_tr_b16 v[98:99], v223 offset:26624
    ds_read_b64_tr_b16 v[100:101], v223 offset:27136
    v_dot2c_f32_bf16 v184, v66, v180
    v_dot2c_f32_bf16 v186, v67, v180
    v_dot2c_f32_bf16 v188, v68, v180
    v_dot2c_f32_bf16 v190, v69, v180
    v_dot2c_f32_bf16 v192, v70, v180
    v_dot2c_f32_bf16 v194, v71, v180
    v_dot2c_f32_bf16 v196, v72, v180
    v_dot2c_f32_bf16 v198, v73, v180
    v_lshlrev_b32 v160, 16, v74
    v_and_b32 v161, 0xffff0000, v74
    v_lshlrev_b32 v162, 16, v75
    v_and_b32 v163, 0xffff0000, v75
    v_lshlrev_b32 v164, 16, v76
    v_and_b32 v165, 0xffff0000, v76
    v_lshlrev_b32 v166, 16, v77
    v_and_b32 v167, 0xffff0000, v77
    v_lshlrev_b32 v168, 16, v78
    v_and_b32 v169, 0xffff0000, v78
    v_lshlrev_b32 v170, 16, v79
    v_and_b32 v171, 0xffff0000, v79
    v_lshlrev_b32 v172, 16, v80
    v_and_b32 v173, 0xffff0000, v80
    v_lshlrev_b32 v174, 16, v81
    v_and_b32 v175, 0xffff0000, v81
    v_pk_mul_f32 v[184:185], v[184:185], v[160:161]
    v_pk_mul_f32 v[186:187], v[186:187], v[162:163]
    v_pk_mul_f32 v[188:189], v[188:189], v[164:165]
    v_pk_mul_f32 v[190:191], v[190:191], v[166:167]
    v_pk_mul_f32 v[192:193], v[192:193], v[168:169]
    v_pk_mul_f32 v[194:195], v[194:195], v[170:171]
    v_pk_mul_f32 v[196:197], v[196:197], v[172:173]
    v_pk_mul_f32 v[198:199], v[198:199], v[174:175]
    v_cvt_pk_bf16_f32 v200, v199, v198
    v_cvt_pk_bf16_f32 v201, v197, v196
    v_cvt_pk_bf16_f32 v202, v195, v194
    v_cvt_pk_bf16_f32 v203, v193, v192
    v_cvt_pk_bf16_f32 v204, v191, v190
    v_cvt_pk_bf16_f32 v205, v189, v188
    v_cvt_pk_bf16_f32 v206, v187, v186
    v_cvt_pk_bf16_f32 v207, v185, v184
    ds_write_b128 v221, v[200:203]
    ds_write_b128 v221, v[204:207] offset:16
    ds_read_b128 v[200:203], v222
    ds_read_b128 v[204:207], v222 offset:1152
    v_alignbit_b32 v176, v107, v107, 16
    v_alignbit_b32 v177, v106, v106, 16
    v_and_b32 v178, 0xffff0000, v107
    v_bfi_b32 v179, s63, v107, v106
    v_and_b32 v180, 0xffff, v106
    s_waitcnt lgkmcnt(4)
    v_dot2_f32_bf16 v184, v84, v178, 0
    v_dot2_f32_bf16 v185, v85, v176, 0
    v_dot2_f32_bf16 v186, v85, v178, 0
    v_dot2_f32_bf16 v187, v86, v176, 0
    v_dot2_f32_bf16 v188, v86, v178, 0
    v_dot2_f32_bf16 v189, v87, v176, 0
    v_dot2_f32_bf16 v190, v87, v178, 0
    v_dot2_f32_bf16 v191, v88, v176, 0
    v_dot2_f32_bf16 v192, v88, v178, 0
    v_dot2_f32_bf16 v193, v89, v176, 0
    v_dot2_f32_bf16 v194, v89, v178, 0
    v_dot2_f32_bf16 v195, v90, v176, 0
    v_dot2_f32_bf16 v196, v90, v178, 0
    v_dot2_f32_bf16 v197, v91, v176, 0
    v_dot2_f32_bf16 v198, v91, v178, 0
    v_dot2_f32_bf16 v199, v92, v176, 0
    v_dot2c_f32_bf16 v184, v85, v179
    v_dot2c_f32_bf16 v185, v86, v177
    v_dot2c_f32_bf16 v186, v86, v179
    v_dot2c_f32_bf16 v187, v87, v177
    v_dot2c_f32_bf16 v188, v87, v179
    v_dot2c_f32_bf16 v189, v88, v177
    v_dot2c_f32_bf16 v190, v88, v179
    v_dot2c_f32_bf16 v191, v89, v177
    v_dot2c_f32_bf16 v192, v89, v179
    v_dot2c_f32_bf16 v193, v90, v177
    v_dot2c_f32_bf16 v194, v90, v179
    v_dot2c_f32_bf16 v195, v91, v177
    v_dot2c_f32_bf16 v196, v91, v179
    v_dot2c_f32_bf16 v197, v92, v177
    v_dot2c_f32_bf16 v198, v92, v179
    v_dot2c_f32_bf16 v199, v93, v177
    s_waitcnt lgkmcnt(0)
    s_mov_b32 s56, 811008
    buffer_store_dwordx4 v[200:203], v220, s[40:43], s56 offen sc1
    s_mov_b32 s56, 844800
    buffer_store_dwordx4 v[204:207], v220, s[40:43], s56 offen sc1
    s_waitcnt vmcnt(14)
    s_barrier
    s_mov_b32 s54, 128
    s_add_u32 m0, s61, 84992
    s_nop 0
    buffer_load_dwordx4 v216, s[8:11], s54 offen lds
    buffer_load_dwordx4 v217, s[8:11], s54 offen offset:1024 lds
    s_add_u32 m0, s61, 93184
    s_nop 0
    buffer_load_dwordx4 v216, s[12:15], s54 offen lds
    buffer_load_dwordx4 v217, s[12:15], s54 offen offset:1024 lds
    ds_read_b64_tr_b16 v[64:65], v224 offset:33792
    ds_read_b64_tr_b16 v[66:67], v223 offset:34304
    ds_read_b64_tr_b16 v[68:69], v223 offset:34816
    ds_read_b64_tr_b16 v[70:71], v223 offset:35328
    ds_read_b64_tr_b16 v[72:73], v223 offset:35840
    ds_read_b64_tr_b16 v[74:75], v223 offset:42496
    ds_read_b64_tr_b16 v[76:77], v223 offset:43008
    ds_read_b64_tr_b16 v[78:79], v223 offset:43520
    ds_read_b64_tr_b16 v[80:81], v223 offset:44032
    v_dot2c_f32_bf16 v184, v86, v180
    v_dot2c_f32_bf16 v186, v87, v180
    v_dot2c_f32_bf16 v188, v88, v180
    v_dot2c_f32_bf16 v190, v89, v180
    v_dot2c_f32_bf16 v192, v90, v180
    v_dot2c_f32_bf16 v194, v91, v180
    v_dot2c_f32_bf16 v196, v92, v180
    v_dot2c_f32_bf16 v198, v93, v180
    v_lshlrev_b32 v160, 16, v94
    v_and_b32 v161, 0xffff0000, v94
    v_lshlrev_b32 v162, 16, v95
    v_and_b32 v163, 0xffff0000, v95
    v_lshlrev_b32 v164, 16, v96
    v_and_b32 v165, 0xffff0000, v96
    v_lshlrev_b32 v166, 16, v97
    v_and_b32 v167, 0xffff0000, v97
    v_lshlrev_b32 v168, 16, v98
    v_and_b32 v169, 0xffff0000, v98
    v_lshlrev_b32 v170, 16, v99
    v_and_b32 v171, 0xffff0000, v99
    v_lshlrev_b32 v172, 16, v100
    v_and_b32 v173, 0xffff0000, v100
    v_lshlrev_b32 v174, 16, v101
    v_and_b32 v175, 0xffff0000, v101
    v_pk_mul_f32 v[184:185], v[184:185], v[160:161]
    v_pk_mul_f32 v[186:187], v[186:187], v[162:163]
    v_pk_mul_f32 v[188:189], v[188:189], v[164:165]
    v_pk_mul_f32 v[190:191], v[190:191], v[166:167]
    v_pk_mul_f32 v[192:193], v[192:193], v[168:169]
    v_pk_mul_f32 v[194:195], v[194:195], v[170:171]
    v_pk_mul_f32 v[196:197], v[196:197], v[172:173]
    v_pk_mul_f32 v[198:199], v[198:199], v[174:175]
    v_cvt_pk_bf16_f32 v208, v199, v198
    v_cvt_pk_bf16_f32 v209, v197, v196
    v_cvt_pk_bf16_f32 v210, v195, v194
    v_cvt_pk_bf16_f32 v211, v193, v192
    v_cvt_pk_bf16_f32 v212, v191, v190
    v_cvt_pk_bf16_f32 v213, v189, v188
    v_cvt_pk_bf16_f32 v214, v187, v186
    v_cvt_pk_bf16_f32 v215, v185, v184
    ds_write_b128 v221, v[208:211]
    ds_write_b128 v221, v[212:215] offset:16
    ds_read_b128 v[208:211], v222
    ds_read_b128 v[212:215], v222 offset:1152
    v_alignbit_b32 v176, v109, v109, 16
    v_alignbit_b32 v177, v108, v108, 16
    v_and_b32 v178, 0xffff0000, v109
    v_bfi_b32 v179, s63, v109, v108
    v_and_b32 v180, 0xffff, v108
    s_waitcnt lgkmcnt(4)
    v_dot2_f32_bf16 v184, v64, v178, 0
    v_dot2_f32_bf16 v185, v65, v176, 0
    v_dot2_f32_bf16 v186, v65, v178, 0
    v_dot2_f32_bf16 v187, v66, v176, 0
    v_dot2_f32_bf16 v188, v66, v178, 0
    v_dot2_f32_bf16 v189, v67, v176, 0
    v_dot2_f32_bf16 v190, v67, v178, 0
    v_dot2_f32_bf16 v191, v68, v176, 0
    v_dot2_f32_bf16 v192, v68, v178, 0
    v_dot2_f32_bf16 v193, v69, v176, 0
    v_dot2_f32_bf16 v194, v69, v178, 0
    v_dot2_f32_bf16 v195, v70, v176, 0
    v_dot2_f32_bf16 v196, v70, v178, 0
    v_dot2_f32_bf16 v197, v71, v176, 0
    v_dot2_f32_bf16 v198, v71, v178, 0
    v_dot2_f32_bf16 v199, v72, v176, 0
    v_dot2c_f32_bf16 v184, v65, v179
    v_dot2c_f32_bf16 v185, v66, v177
    v_dot2c_f32_bf16 v186, v66, v179
    v_dot2c_f32_bf16 v187, v67, v177
    v_dot2c_f32_bf16 v188, v67, v179
    v_dot2c_f32_bf16 v189, v68, v177
    v_dot2c_f32_bf16 v190, v68, v179
    v_dot2c_f32_bf16 v191, v69, v177
    v_dot2c_f32_bf16 v192, v69, v179
    v_dot2c_f32_bf16 v193, v70, v177
    v_dot2c_f32_bf16 v194, v70, v179
    v_dot2c_f32_bf16 v195, v71, v177
    v_dot2c_f32_bf16 v196, v71, v179
    v_dot2c_f32_bf16 v197, v72, v177
    v_dot2c_f32_bf16 v198, v72, v179
    v_dot2c_f32_bf16 v199, v73, v177
    s_waitcnt lgkmcnt(0)
    s_mov_b32 s56, 1081344
    buffer_store_dwordx4 v[208:211], v220, s[40:43], s56 offen sc1
    s_mov_b32 s56, 1115136
    buffer_store_dwordx4 v[212:215], v220, s[40:43], s56 offen sc1
    s_waitcnt vmcnt(12)
    s_barrier
    v_add_u32 v223, 50688, v223
    v_add_u32 v224, 50688, v224
    s_mov_b32 s54, 256
    s_add_u32 m0, s61, 101888
    s_nop 0
    buffer_load_dwordx4 v216, s[8:11], s54 offen lds
    buffer_load_dwordx4 v217, s[8:11], s54 offen offset:1024 lds
    s_add_u32 m0, s61, 110080
    s_nop 0
    buffer_load_dwordx4 v216, s[12:15], s54 offen lds
    buffer_load_dwordx4 v217, s[12:15], s54 offen offset:1024 lds
    ds_read_b64_tr_b16 v[84:85], v224 offset:0
    ds_read_b64_tr_b16 v[86:87], v223 offset:512
    ds_read_b64_tr_b16 v[88:89], v223 offset:1024
    ds_read_b64_tr_b16 v[90:91], v223 offset:1536
    ds_read_b64_tr_b16 v[92:93], v223 offset:2048
    ds_read_b64_tr_b16 v[94:95], v223 offset:8704
    ds_read_b64_tr_b16 v[96:97], v223 offset:9216
    ds_read_b64_tr_b16 v[98:99], v223 offset:9728
    ds_read_b64_tr_b16 v[100:101], v223 offset:10240
    v_dot2c_f32_bf16 v184, v66, v180
    v_dot2c_f32_bf16 v186, v67, v180
    v_dot2c_f32_bf16 v188, v68, v180
    v_dot2c_f32_bf16 v190, v69, v180
    v_dot2c_f32_bf16 v192, v70, v180
    v_dot2c_f32_bf16 v194, v71, v180
    v_dot2c_f32_bf16 v196, v72, v180
    v_dot2c_f32_bf16 v198, v73, v180
    v_lshlrev_b32 v160, 16, v74
    v_and_b32 v161, 0xffff0000, v74
    v_lshlrev_b32 v162, 16, v75
    v_and_b32 v163, 0xffff0000, v75
    v_lshlrev_b32 v164, 16, v76
    v_and_b32 v165, 0xffff0000, v76
    v_lshlrev_b32 v166, 16, v77
    v_and_b32 v167, 0xffff0000, v77
    v_lshlrev_b32 v168, 16, v78
    v_and_b32 v169, 0xffff0000, v78
    v_lshlrev_b32 v170, 16, v79
    v_and_b32 v171, 0xffff0000, v79
    v_lshlrev_b32 v172, 16, v80
    v_and_b32 v173, 0xffff0000, v80
    v_lshlrev_b32 v174, 16, v81
    v_and_b32 v175, 0xffff0000, v81
    v_pk_mul_f32 v[184:185], v[184:185], v[160:161]
    v_pk_mul_f32 v[186:187], v[186:187], v[162:163]
    v_pk_mul_f32 v[188:189], v[188:189], v[164:165]
    v_pk_mul_f32 v[190:191], v[190:191], v[166:167]
    v_pk_mul_f32 v[192:193], v[192:193], v[168:169]
    v_pk_mul_f32 v[194:195], v[194:195], v[170:171]
    v_pk_mul_f32 v[196:197], v[196:197], v[172:173]
    v_pk_mul_f32 v[198:199], v[198:199], v[174:175]
    v_cvt_pk_bf16_f32 v200, v199, v198
    v_cvt_pk_bf16_f32 v201, v197, v196
    v_cvt_pk_bf16_f32 v202, v195, v194
    v_cvt_pk_bf16_f32 v203, v193, v192
    v_cvt_pk_bf16_f32 v204, v191, v190
    v_cvt_pk_bf16_f32 v205, v189, v188
    v_cvt_pk_bf16_f32 v206, v187, v186
    v_cvt_pk_bf16_f32 v207, v185, v184
    ds_write_b128 v221, v[200:203]
    ds_write_b128 v221, v[204:207] offset:16
    ds_read_b128 v[200:203], v222
    ds_read_b128 v[204:207], v222 offset:1152
    v_alignbit_b32 v176, v111, v111, 16
    v_alignbit_b32 v177, v110, v110, 16
    v_and_b32 v178, 0xffff0000, v111
    v_bfi_b32 v179, s63, v111, v110
    v_and_b32 v180, 0xffff, v110
    s_waitcnt lgkmcnt(4)
    v_dot2_f32_bf16 v184, v84, v178, 0
    v_dot2_f32_bf16 v185, v85, v176, 0
    v_dot2_f32_bf16 v186, v85, v178, 0
    v_dot2_f32_bf16 v187, v86, v176, 0
    v_dot2_f32_bf16 v188, v86, v178, 0
    v_dot2_f32_bf16 v189, v87, v176, 0
    v_dot2_f32_bf16 v190, v87, v178, 0
    v_dot2_f32_bf16 v191, v88, v176, 0
    v_dot2_f32_bf16 v192, v88, v178, 0
    v_dot2_f32_bf16 v193, v89, v176, 0
    v_dot2_f32_bf16 v194, v89, v178, 0
    v_dot2_f32_bf16 v195, v90, v176, 0
    v_dot2_f32_bf16 v196, v90, v178, 0
    v_dot2_f32_bf16 v197, v91, v176, 0
    v_dot2_f32_bf16 v198, v91, v178, 0
    v_dot2_f32_bf16 v199, v92, v176, 0
    v_dot2c_f32_bf16 v184, v85, v179
    v_dot2c_f32_bf16 v185, v86, v177
    v_dot2c_f32_bf16 v186, v86, v179
    v_dot2c_f32_bf16 v187, v87, v177
    v_dot2c_f32_bf16 v188, v87, v179
    v_dot2c_f32_bf16 v189, v88, v177
    v_dot2c_f32_bf16 v190, v88, v179
    v_dot2c_f32_bf16 v191, v89, v177
    v_dot2c_f32_bf16 v192, v89, v179
    v_dot2c_f32_bf16 v193, v90, v177
    v_dot2c_f32_bf16 v194, v90, v179
    v_dot2c_f32_bf16 v195, v91, v177
    v_dot2c_f32_bf16 v196, v91, v179
    v_dot2c_f32_bf16 v197, v92, v177
    v_dot2c_f32_bf16 v198, v92, v179
    v_dot2c_f32_bf16 v199, v93, v177
    s_waitcnt lgkmcnt(0)
    s_mov_b32 s56, 1351680
    buffer_store_dwordx4 v[200:203], v220, s[40:43], s56 offen sc1
    s_mov_b32 s56, 1385472
    s_branch L_pgcs0
.p2align 12
L_pgc0:
    s_branch L_pgcret
L_pgcs0:
    buffer_store_dwordx4 v[204:207], v220, s[40:43], s56 offen sc1
    s_waitcnt vmcnt(14)
    s_barrier
    ds_read_b64_tr_b16 v[64:65], v224 offset:16896
    ds_read_b64_tr_b16 v[66:67], v223 offset:17408
    ds_read_b64_tr_b16 v[68:69], v223 offset:17920
    ds_read_b64_tr_b16 v[70:71], v223 offset:18432
    ds_read_b64_tr_b16 v[72:73], v223 offset:18944
    ds_read_b64_tr_b16 v[74:75], v223 offset:25600
    ds_read_b64_tr_b16 v[76:77], v223 offset:26112
    ds_read_b64_tr_b16 v[78:79], v223 offset:26624
    ds_read_b64_tr_b16 v[80:81], v223 offset:27136
    v_dot2c_f32_bf16 v184, v86, v180
    v_dot2c_f32_bf16 v186, v87, v180
    v_dot2c_f32_bf16 v188, v88, v180
    v_dot2c_f32_bf16 v190, v89, v180
    v_dot2c_f32_bf16 v192, v90, v180
    v_dot2c_f32_bf16 v194, v91, v180
    v_dot2c_f32_bf16 v196, v92, v180
    v_dot2c_f32_bf16 v198, v93, v180
    v_lshlrev_b32 v160, 16, v94
    v_and_b32 v161, 0xffff0000, v94
    v_lshlrev_b32 v162, 16, v95
    v_and_b32 v163, 0xffff0000, v95
    v_lshlrev_b32 v164, 16, v96
    v_and_b32 v165, 0xffff0000, v96
    v_lshlrev_b32 v166, 16, v97
    v_and_b32 v167, 0xffff0000, v97
    v_lshlrev_b32 v168, 16, v98
    v_and_b32 v169, 0xffff0000, v98
    v_lshlrev_b32 v170, 16, v99
    v_and_b32 v171, 0xffff0000, v99
    v_lshlrev_b32 v172, 16, v100
    v_and_b32 v173, 0xffff0000, v100
    v_lshlrev_b32 v174, 16, v101
    v_and_b32 v175, 0xffff0000, v101
    v_pk_mul_f32 v[184:185], v[184:185], v[160:161]
    v_pk_mul_f32 v[186:187], v[186:187], v[162:163]
    v_pk_mul_f32 v[188:189], v[188:189], v[164:165]
    v_pk_mul_f32 v[190:191], v[190:191], v[166:167]
    v_pk_mul_f32 v[192:193], v[192:193], v[168:169]
    v_pk_mul_f32 v[194:195], v[194:195], v[170:171]
    v_pk_mul_f32 v[196:197], v[196:197], v[172:173]
    v_pk_mul_f32 v[198:199], v[198:199], v[174:175]
    v_cvt_pk_bf16_f32 v208, v199, v198
    v_cvt_pk_bf16_f32 v209, v197, v196
    v_cvt_pk_bf16_f32 v210, v195, v194
    v_cvt_pk_bf16_f32 v211, v193, v192
    v_cvt_pk_bf16_f32 v212, v191, v190
    v_cvt_pk_bf16_f32 v213, v189, v188
    v_cvt_pk_bf16_f32 v214, v187, v186
    v_cvt_pk_bf16_f32 v215, v185, v184
    ds_write_b128 v221, v[208:211]
    ds_write_b128 v221, v[212:215] offset:16
    ds_read_b128 v[208:211], v222
    ds_read_b128 v[212:215], v222 offset:1152
    v_alignbit_b32 v176, v113, v113, 16
    v_alignbit_b32 v177, v112, v112, 16
    v_and_b32 v178, 0xffff0000, v113
    v_bfi_b32 v179, s63, v113, v112
    v_and_b32 v180, 0xffff, v112
    s_waitcnt lgkmcnt(4)
    v_dot2_f32_bf16 v184, v64, v178, 0
    v_dot2_f32_bf16 v185, v65, v176, 0
    v_dot2_f32_bf16 v186, v65, v178, 0
    v_dot2_f32_bf16 v187, v66, v176, 0
    v_dot2_f32_bf16 v188, v66, v178, 0
    v_dot2_f32_bf16 v189, v67, v176, 0
    v_dot2_f32_bf16 v190, v67, v178, 0
    v_dot2_f32_bf16 v191, v68, v176, 0
    v_dot2_f32_bf16 v192, v68, v178, 0
    v_dot2_f32_bf16 v193, v69, v176, 0
    v_dot2_f32_bf16 v194, v69, v178, 0
    v_dot2_f32_bf16 v195, v70, v176, 0
    v_dot2_f32_bf16 v196, v70, v178, 0
    v_dot2_f32_bf16 v197, v71, v176, 0
    v_dot2_f32_bf16 v198, v71, v178, 0
    v_dot2_f32_bf16 v199, v72, v176, 0
    v_dot2c_f32_bf16 v184, v65, v179
    v_dot2c_f32_bf16 v185, v66, v177
    v_dot2c_f32_bf16 v186, v66, v179
    v_dot2c_f32_bf16 v187, v67, v177
    v_dot2c_f32_bf16 v188, v67, v179
    v_dot2c_f32_bf16 v189, v68, v177
    v_dot2c_f32_bf16 v190, v68, v179
    v_dot2c_f32_bf16 v191, v69, v177
    v_dot2c_f32_bf16 v192, v69, v179
    v_dot2c_f32_bf16 v193, v70, v177
    v_dot2c_f32_bf16 v194, v70, v179
    v_dot2c_f32_bf16 v195, v71, v177
    v_dot2c_f32_bf16 v196, v71, v179
    v_dot2c_f32_bf16 v197, v72, v177
    v_dot2c_f32_bf16 v198, v72, v179
    v_dot2c_f32_bf16 v199, v73, v177
    s_waitcnt lgkmcnt(0)
    s_mov_b32 s56, 1622016
    buffer_store_dwordx4 v[208:211], v220, s[40:43], s56 offen sc1
    s_mov_b32 s56, 1655808
    buffer_store_dwordx4 v[212:215], v220, s[40:43], s56 offen sc1
    s_waitcnt vmcnt(10)
    s_barrier
    s_add_u32 m0, s60, 32
    s_nop 0
    buffer_load_dwordx4 v8, s[44:47], 0 offen lds
    buffer_load_dwordx4 v8, s[44:47], 0 offen offset:1024 lds
    buffer_load_dwordx4 v8, s[44:47], 0 offen offset:2048 lds
    buffer_load_dwordx4 v8, s[44:47], 0 offen offset:3072 lds
    ds_read_b64_tr_b16 v[84:85], v224 offset:33792
    ds_read_b64_tr_b16 v[86:87], v223 offset:34304
    ds_read_b64_tr_b16 v[88:89], v223 offset:34816
    ds_read_b64_tr_b16 v[90:91], v223 offset:35328
    ds_read_b64_tr_b16 v[92:93], v223 offset:35840
    ds_read_b64_tr_b16 v[94:95], v223 offset:42496
    ds_read_b64_tr_b16 v[96:97], v223 offset:43008
    ds_read_b64_tr_b16 v[98:99], v223 offset:43520
    ds_read_b64_tr_b16 v[100:101], v223 offset:44032
    v_dot2c_f32_bf16 v184, v66, v180
    v_dot2c_f32_bf16 v186, v67, v180
    v_dot2c_f32_bf16 v188, v68, v180
    v_dot2c_f32_bf16 v190, v69, v180
    v_dot2c_f32_bf16 v192, v70, v180
    v_dot2c_f32_bf16 v194, v71, v180
    v_dot2c_f32_bf16 v196, v72, v180
    v_dot2c_f32_bf16 v198, v73, v180
    v_lshlrev_b32 v160, 16, v74
    v_and_b32 v161, 0xffff0000, v74
    v_lshlrev_b32 v162, 16, v75
    v_and_b32 v163, 0xffff0000, v75
    v_lshlrev_b32 v164, 16, v76
    v_and_b32 v165, 0xffff0000, v76
    v_lshlrev_b32 v166, 16, v77
    v_and_b32 v167, 0xffff0000, v77
    v_lshlrev_b32 v168, 16, v78
    v_and_b32 v169, 0xffff0000, v78
    v_lshlrev_b32 v170, 16, v79
    v_and_b32 v171, 0xffff0000, v79
    v_lshlrev_b32 v172, 16, v80
    v_and_b32 v173, 0xffff0000, v80
    v_lshlrev_b32 v174, 16, v81
    v_and_b32 v175, 0xffff0000, v81
    v_pk_mul_f32 v[184:185], v[184:185], v[160:161]
    v_pk_mul_f32 v[186:187], v[186:187], v[162:163]
    v_pk_mul_f32 v[188:189], v[188:189], v[164:165]
    v_pk_mul_f32 v[190:191], v[190:191], v[166:167]
    v_pk_mul_f32 v[192:193], v[192:193], v[168:169]
    v_pk_mul_f32 v[194:195], v[194:195], v[170:171]
    v_pk_mul_f32 v[196:197], v[196:197], v[172:173]
    v_pk_mul_f32 v[198:199], v[198:199], v[174:175]
    v_cvt_pk_bf16_f32 v200, v199, v198
    v_cvt_pk_bf16_f32 v201, v197, v196
    v_cvt_pk_bf16_f32 v202, v195, v194
    v_cvt_pk_bf16_f32 v203, v193, v192
    v_cvt_pk_bf16_f32 v204, v191, v190
    v_cvt_pk_bf16_f32 v205, v189, v188
    v_cvt_pk_bf16_f32 v206, v187, v186
    v_cvt_pk_bf16_f32 v207, v185, v184
    ds_write_b128 v221, v[200:203]
    ds_write_b128 v221, v[204:207] offset:16
    ds_read_b128 v[200:203], v222
    ds_read_b128 v[204:207], v222 offset:1152
    v_alignbit_b32 v176, v115, v115, 16
    v_alignbit_b32 v177, v114, v114, 16
    v_and_b32 v178, 0xffff0000, v115
    v_bfi_b32 v179, s63, v115, v114
    v_and_b32 v180, 0xffff, v114
    s_waitcnt lgkmcnt(4)
    v_dot2_f32_bf16 v184, v84, v178, 0
    v_dot2_f32_bf16 v185, v85, v176, 0
    v_dot2_f32_bf16 v186, v85, v178, 0
    v_dot2_f32_bf16 v187, v86, v176, 0
    v_dot2_f32_bf16 v188, v86, v178, 0
    v_dot2_f32_bf16 v189, v87, v176, 0
    v_dot2_f32_bf16 v190, v87, v178, 0
    v_dot2_f32_bf16 v191, v88, v176, 0
    v_dot2_f32_bf16 v192, v88, v178, 0
    v_dot2_f32_bf16 v193, v89, v176, 0
    v_dot2_f32_bf16 v194, v89, v178, 0
    v_dot2_f32_bf16 v195, v90, v176, 0
    v_dot2_f32_bf16 v196, v90, v178, 0
    v_dot2_f32_bf16 v197, v91, v176, 0
    v_dot2_f32_bf16 v198, v91, v178, 0
    v_dot2_f32_bf16 v199, v92, v176, 0
    v_dot2c_f32_bf16 v184, v85, v179
    v_dot2c_f32_bf16 v185, v86, v177
    v_dot2c_f32_bf16 v186, v86, v179
    v_dot2c_f32_bf16 v187, v87, v177
    v_dot2c_f32_bf16 v188, v87, v179
    v_dot2c_f32_bf16 v189, v88, v177
    v_dot2c_f32_bf16 v190, v88, v179
    v_dot2c_f32_bf16 v191, v89, v177
    v_dot2c_f32_bf16 v192, v89, v179
    v_dot2c_f32_bf16 v193, v90, v177
    v_dot2c_f32_bf16 v194, v90, v179
    v_dot2c_f32_bf16 v195, v91, v177
    v_dot2c_f32_bf16 v196, v91, v179
    v_dot2c_f32_bf16 v197, v92, v177
    v_dot2c_f32_bf16 v198, v92, v179
    v_dot2c_f32_bf16 v199, v93, v177
    s_waitcnt lgkmcnt(0)
    s_mov_b32 s56, 0
    buffer_store_dwordx4 v[200:203], v220, s[40:43], s56 offen sc1
    s_mov_b32 s56, 33792
    buffer_store_dwordx4 v[204:207], v220, s[40:43], s56 offen sc1
    s_waitcnt vmcnt(10)
    s_waitcnt vmcnt(6)
    s_barrier
    s_cmp_lg_u32 s48, 0
    s_cbranch_scc1 L_nf34
    s_mov_b64 exec, 1
    buffer_store_dwordx4 v[240:243], v6, s[40:43], s100 offen offset:0 sc1
    s_mov_b64 exec, -1
L_nf34:
    v_add_u32 v223, 50688, v223
    v_add_u32 v224, 50688, v224
    s_add_u32 m0, s60, 4192
    s_mov_b32 s54, 2
    buffer_load_dwordx4 v8, s[44:47], s54 offen lds
    buffer_load_dwordx4 v8, s[44:47], s54 offen offset:1024 lds
    buffer_load_dwordx4 v8, s[44:47], s54 offen offset:2048 lds
    buffer_load_dwordx4 v8, s[44:47], s54 offen offset:3072 lds
    ds_read_b64_tr_b16 v[64:65], v224 offset:0
    ds_read_b64_tr_b16 v[66:67], v223 offset:512
    ds_read_b64_tr_b16 v[68:69], v223 offset:1024
    ds_read_b64_tr_b16 v[70:71], v223 offset:1536
    ds_read_b64_tr_b16 v[72:73], v223 offset:2048
    ds_read_b64_tr_b16 v[74:75], v223 offset:8704
    ds_read_b64_tr_b16 v[76:77], v223 offset:9216
    ds_read_b64_tr_b16 v[78:79], v223 offset:9728
    ds_read_b64_tr_b16 v[80:81], v223 offset:10240
    v_dot2c_f32_bf16 v184, v86, v180
    v_dot2c_f32_bf16 v186, v87, v180
    v_dot2c_f32_bf16 v188, v88, v180
    v_dot2c_f32_bf16 v190, v89, v180
    v_dot2c_f32_bf16 v192, v90, v180
    v_dot2c_f32_bf16 v194, v91, v180
    v_dot2c_f32_bf16 v196, v92, v180
    v_dot2c_f32_bf16 v198, v93, v180
    v_lshlrev_b32 v160, 16, v94
    v_and_b32 v161, 0xffff0000, v94
    v_lshlrev_b32 v162, 16, v95
    v_and_b32 v163, 0xffff0000, v95
    v_lshlrev_b32 v164, 16, v96
    v_and_b32 v165, 0xffff0000, v96
    v_lshlrev_b32 v166, 16, v97
    v_and_b32 v167, 0xffff0000, v97
    v_lshlrev_b32 v168, 16, v98
    v_and_b32 v169, 0xffff0000, v98
    v_lshlrev_b32 v170, 16, v99
    v_and_b32 v171, 0xffff0000, v99
    v_lshlrev_b32 v172, 16, v100
    v_and_b32 v173, 0xffff0000, v100
    v_lshlrev_b32 v174, 16, v101
    v_and_b32 v175, 0xffff0000, v101
    v_pk_mul_f32 v[184:185], v[184:185], v[160:161]
    v_pk_mul_f32 v[186:187], v[186:187], v[162:163]
    v_pk_mul_f32 v[188:189], v[188:189], v[164:165]
    v_pk_mul_f32 v[190:191], v[190:191], v[166:167]
    v_pk_mul_f32 v[192:193], v[192:193], v[168:169]
    v_pk_mul_f32 v[194:195], v[194:195], v[170:171]
    v_pk_mul_f32 v[196:197], v[196:197], v[172:173]
    v_pk_mul_f32 v[198:199], v[198:199], v[174:175]
    v_cvt_pk_bf16_f32 v208, v199, v198
    v_cvt_pk_bf16_f32 v209, v197, v196
    v_cvt_pk_bf16_f32 v210, v195, v194
    v_cvt_pk_bf16_f32 v211, v193, v192
    v_cvt_pk_bf16_f32 v212, v191, v190
    v_cvt_pk_bf16_f32 v213, v189, v188
    v_cvt_pk_bf16_f32 v214, v187, v186
    v_cvt_pk_bf16_f32 v215, v185, v184
    ds_write_b128 v221, v[208:211]
    ds_write_b128 v221, v[212:215] offset:16
    ds_read_b128 v[208:211], v222
    ds_read_b128 v[212:215], v222 offset:1152
    v_alignbit_b32 v176, v117, v117, 16
    v_alignbit_b32 v177, v116, v116, 16
    v_and_b32 v178, 0xffff0000, v117
    v_bfi_b32 v179, s63, v117, v116
    v_and_b32 v180, 0xffff, v116
    s_waitcnt lgkmcnt(4)
    v_dot2_f32_bf16 v184, v64, v178, 0
    v_dot2_f32_bf16 v185, v65, v176, 0
    v_dot2_f32_bf16 v186, v65, v178, 0
    v_dot2_f32_bf16 v187, v66, v176, 0
    v_dot2_f32_bf16 v188, v66, v178, 0
    v_dot2_f32_bf16 v189, v67, v176, 0
    v_dot2_f32_bf16 v190, v67, v178, 0
    v_dot2_f32_bf16 v191, v68, v176, 0
    v_dot2_f32_bf16 v192, v68, v178, 0
    v_dot2_f32_bf16 v193, v69, v176, 0
    v_dot2_f32_bf16 v194, v69, v178, 0
    v_dot2_f32_bf16 v195, v70, v176, 0
    v_dot2_f32_bf16 v196, v70, v178, 0
    v_dot2_f32_bf16 v197, v71, v176, 0
    v_dot2_f32_bf16 v198, v71, v178, 0
    v_dot2_f32_bf16 v199, v72, v176, 0
    v_dot2c_f32_bf16 v184, v65, v179
    v_dot2c_f32_bf16 v185, v66, v177
    v_dot2c_f32_bf16 v186, v66, v179
    v_dot2c_f32_bf16 v187, v67, v177
    v_dot2c_f32_bf16 v188, v67, v179
    v_dot2c_f32_bf16 v189, v68, v177
    v_dot2c_f32_bf16 v190, v68, v179
    v_dot2c_f32_bf16 v191, v69, v177
    v_dot2c_f32_bf16 v192, v69, v179
    v_dot2c_f32_bf16 v193, v70, v177
    v_dot2c_f32_bf16 v194, v70, v179
    v_dot2c_f32_bf16 v195, v71, v177
    v_dot2c_f32_bf16 v196, v71, v179
    v_dot2c_f32_bf16 v197, v72, v177
    v_dot2c_f32_bf16 v198, v72, v179
    v_dot2c_f32_bf16 v199, v73, v177
    buffer_load_dword v30, v7, s[40:43], s100 offen offset:0 sc1
    s_waitcnt lgkmcnt(0)
    s_mov_b32 s56, 270336
    buffer_store_dwordx4 v[208:211], v220, s[40:43], s56 offen sc1
    s_mov_b32 s56, 304128
    buffer_store_dwordx4 v[212:215], v220, s[40:43], s56 offen sc1
    v_dot2c_f32_bf16 v184, v66, v180
    v_dot2c_f32_bf16 v186, v67, v180
    v_dot2c_f32_bf16 v188, v68, v180
    v_dot2c_f32_bf16 v190, v69, v180
    v_dot2c_f32_bf16 v192, v70, v180
    v_dot2c_f32_bf16 v194, v71, v180
    v_dot2c_f32_bf16 v196, v72, v180
    v_dot2c_f32_bf16 v198, v73, v180
    v_lshlrev_b32 v160, 16, v74
    v_and_b32 v161, 0xffff0000, v74
    v_lshlrev_b32 v162, 16, v75
    v_and_b32 v163, 0xffff0000, v75
    v_lshlrev_b32 v164, 16, v76
    v_and_b32 v165, 0xffff0000, v76
    v_lshlrev_b32 v166, 16, v77
    v_and_b32 v167, 0xffff0000, v77
    v_lshlrev_b32 v168, 16, v78
    v_and_b32 v169, 0xffff0000, v78
    v_lshlrev_b32 v170, 16, v79
    v_and_b32 v171, 0xffff0000, v79
    v_lshlrev_b32 v172, 16, v80
    v_and_b32 v173, 0xffff0000, v80
    v_lshlrev_b32 v174, 16, v81
    v_and_b32 v175, 0xffff0000, v81
    v_pk_mul_f32 v[184:185], v[184:185], v[160:161]
    v_pk_mul_f32 v[186:187], v[186:187], v[162:163]
    v_pk_mul_f32 v[188:189], v[188:189], v[164:165]
    v_pk_mul_f32 v[190:191], v[190:191], v[166:167]
    v_pk_mul_f32 v[192:193], v[192:193], v[168:169]
    v_pk_mul_f32 v[194:195], v[194:195], v[170:171]
    v_pk_mul_f32 v[196:197], v[196:197], v[172:173]
    v_pk_mul_f32 v[198:199], v[198:199], v[174:175]
    v_cvt_pk_bf16_f32 v200, v199, v198
    v_cvt_pk_bf16_f32 v201, v197, v196
    v_cvt_pk_bf16_f32 v202, v195, v194
    v_cvt_pk_bf16_f32 v203, v193, v192
    v_cvt_pk_bf16_f32 v204, v191, v190
    v_cvt_pk_bf16_f32 v205, v189, v188
    v_cvt_pk_bf16_f32 v206, v187, v186
    v_cvt_pk_bf16_f32 v207, v185, v184
    ds_write_b128 v221, v[200:203]
    ds_write_b128 v221, v[204:207] offset:16
    ds_read_b128 v[200:203], v222
    ds_read_b128 v[204:207], v222 offset:1152
    s_waitcnt lgkmcnt(0)
    s_mov_b32 s56, 540672
    buffer_store_dwordx4 v[200:203], v220, s[40:43], s56 offen sc1
    s_mov_b32 s56, 574464
    buffer_store_dwordx4 v[204:207], v220, s[40:43], s56 offen sc1
    s_waitcnt vmcnt(4)
    v_cmp_ne_u32 vcc, s65, v30
    s_cbranch_vccz L_ok35
    s_mov_b32 s55, 0
L_spin36:
    buffer_load_dword v30, v7, s[40:43], s100 offen offset:0 sc1
    s_waitcnt vmcnt(0)
    v_cmp_ne_u32 vcc, s65, v30
    s_cbranch_vccz L_spun37
    s_sleep 6
    s_add_u32 s55, s55, 1
    s_cmp_lt_u32 s55, 1048576
    s_cbranch_scc1 L_spin36
L_spun37:
L_ok35:
    s_barrier
    s_add_u32 m0, s60, 8320
    s_mov_b32 s54, 4718592
    buffer_load_dwordx4 v12, s[40:43], s54 offen sc1 lds
    buffer_load_dwordx4 v12, s[40:43], s54 offen offset:1024 sc1 lds
    buffer_load_dwordx4 v12, s[40:43], s54 offen offset:2048 sc1 lds
    buffer_load_dwordx4 v12, s[40:43], s54 offen offset:3072 sc1 lds
    s_waitcnt vmcnt(4)
    s_lshl_b32 s56, s48, 2
    s_mov_b64 exec, 1
    buffer_store_dword v240, v6, s[40:43], s56 offen offset:16 sc1
    s_mov_b64 exec, -1
    ds_write_b64 v41, v[52:53] offset:12416
    ds_write_b64 v41, v[52:53] offset:64128
    v_cmp_eq_u32 vcc, 15, v28
    v_lshlrev_b32 v24, 16, v24
    s_nop 0
    v_cndmask_b32 v24, 0, v24, vcc
    v_lshl_or_b32 v20, v20, 16, v20
    v_lshlrev_b32 v25, 16, v25
    v_cndmask_b32 v25, 0, v25, vcc
    v_lshl_or_b32 v21, v21, 16, v21
    ds_write_b32 v48, v24 offset:0
    ds_write_b32 v48, v25 offset:51712
    s_waitcnt lgkmcnt(0)
    s_cmp_eq_u32 s48, 3
    s_cbranch_scc1 L_agent
    s_waitcnt vmcnt(1)
    ds_read_b128 v[128:131], v40 offset:3584
    ds_read2_b32 v[64:65], v32 offset0:0 offset1:1
    ds_read2_b32 v[66:67], v32 offset0:2 offset1:3
    ds_read_b128 v[132:135], v40 offset:3072
    ds_read2_b32 v[68:69], v32 offset0:128 offset1:129
    ds_read2_b32 v[70:71], v32 offset0:130 offset1:131
    ds_read_b128 v[136:139], v40 offset:2560
    ds_read2_b32 v[72:73], v33 offset0:0 offset1:1
    ds_read2_b32 v[74:75], v33 offset0:2 offset1:3
    ds_read_b128 v[140:143], v40 offset:2048
    ds_read2_b32 v[76:77], v33 offset0:128 offset1:129
    ds_read2_b32 v[78:79], v33 offset0:130 offset1:131
    ds_read_b128 v[144:147], v40 offset:1536
    ds_read2_b32 v[80:81], v34 offset0:0 offset1:1
    ds_read2_b32 v[82:83], v34 offset0:2 offset1:3
    ds_read_b128 v[148:151], v40 offset:1024
    ds_read2_b32 v[84:85], v34 offset0:128 offset1:129
    ds_read2_b32 v[86:87], v34 offset0:130 offset1:131
    ds_read_b128 v[152:155], v40 offset:512
    ds_read2_b32 v[88:89], v35 offset0:0 offset1:1
    ds_read2_b32 v[90:91], v35 offset0:2 offset1:3
    ds_read_b128 v[156:159], v40 offset:0
    ds_read2_b32 v[92:93], v35 offset0:128 offset1:129
    ds_read2_b32 v[94:95], v35 offset0:130 offset1:131
    v_and_b32 v56, v20, v44
    v_and_b32 v57, v20, v45
    v_and_b32 v58, v20, v46
    v_and_b32 v59, v20, v47
    s_waitcnt lgkmcnt(0)
    s_nop 0
    v_mfma_f32_16x16x32_bf16 v[192:195], v[56:59], v[128:131], 0
    ds_read_b128 v[160:163], v40 offset:3648
    v_mfma_f32_16x16x32_bf16 v[196:199], v[56:59], v[132:135], 0
    ds_read2_b32 v[96:97], v32 offset0:16 offset1:17
    v_mfma_f32_16x16x32_bf16 v[200:203], v[56:59], v[136:139], 0
    v_mfma_f32_16x16x32_bf16 v[204:207], v[56:59], v[140:143], 0
    ds_read2_b32 v[98:99], v32 offset0:18 offset1:19
    v_mfma_f32_16x16x32_bf16 v[208:211], v[56:59], v[144:147], 0
    v_mfma_f32_16x16x32_bf16 v[212:215], v[56:59], v[148:151], 0
    ds_read_b128 v[164:167], v40 offset:3136
    v_mfma_f32_16x16x32_bf16 v[216:219], v[56:59], v[152:155], 0
    s_add_u32 m0, s60, 51744
    s_nop 0
    buffer_load_dwordx4 v9, s[44:47], 0 offen lds
    ds_read2_b32 v[100:101], v32 offset0:144 offset1:145
    v_mfma_f32_16x16x32_bf16 v[220:223], v[56:59], v[156:159], 0
    v_mfma_f32_16x16x32_bf16 v[192:195], v[64:67], v[128:131], v[192:195]
    ds_read2_b32 v[102:103], v32 offset0:146 offset1:147
    v_mfma_f32_16x16x32_bf16 v[196:199], v[64:67], v[132:135], v[196:199]
    v_mfma_f32_16x16x32_bf16 v[200:203], v[64:67], v[136:139], v[200:203]
    ds_read_b128 v[168:171], v40 offset:2624
    v_mfma_f32_16x16x32_bf16 v[204:207], v[64:67], v[140:143], v[204:207]
    ds_read2_b32 v[104:105], v33 offset0:16 offset1:17
    v_mfma_f32_16x16x32_bf16 v[208:211], v[64:67], v[144:147], v[208:211]
    v_mfma_f32_16x16x32_bf16 v[212:215], v[64:67], v[148:151], v[212:215]
    ds_read2_b32 v[106:107], v33 offset0:18 offset1:19
    v_mfma_f32_16x16x32_bf16 v[216:219], v[64:67], v[152:155], v[216:219]
    v_mfma_f32_16x16x32_bf16 v[220:223], v[64:67], v[156:159], v[220:223]
    ds_read_b128 v[172:175], v40 offset:2112
    v_mfma_f32_16x16x32_bf16 v[196:199], v[68:71], v[128:131], v[196:199]
    ds_read2_b32 v[108:109], v33 offset0:144 offset1:145
    v_mfma_f32_16x16x32_bf16 v[200:203], v[68:71], v[132:135], v[200:203]
    v_mfma_f32_16x16x32_bf16 v[204:207], v[68:71], v[136:139], v[204:207]
    ds_read2_b32 v[110:111], v33 offset0:146 offset1:147
    v_mfma_f32_16x16x32_bf16 v[208:211], v[68:71], v[140:143], v[208:211]
    v_mfma_f32_16x16x32_bf16 v[212:215], v[68:71], v[144:147], v[212:215]
    ds_read_b128 v[176:179], v40 offset:1600
    v_mfma_f32_16x16x32_bf16 v[216:219], v[68:71], v[148:151], v[216:219]
    ds_read2_b32 v[112:113], v34 offset0:16 offset1:17
    v_mfma_f32_16x16x32_bf16 v[220:223], v[68:71], v[152:155], v[220:223]
    v_mfma_f32_16x16x32_bf16 v[200:203], v[72:75], v[128:131], v[200:203]
    ds_read2_b32 v[114:115], v34 offset0:18 offset1:19
    v_mfma_f32_16x16x32_bf16 v[204:207], v[72:75], v[132:135], v[204:207]
    v_mfma_f32_16x16x32_bf16 v[208:211], v[72:75], v[136:139], v[208:211]
    buffer_load_dwordx4 v9, s[44:47], 0 offen offset:1024 lds
    ds_read_b128 v[180:183], v40 offset:1088
    v_mfma_f32_16x16x32_bf16 v[212:215], v[72:75], v[140:143], v[212:215]
    ds_read2_b32 v[116:117], v34 offset0:144 offset1:145
    v_mfma_f32_16x16x32_bf16 v[216:219], v[72:75], v[144:147], v[216:219]
    v_mfma_f32_16x16x32_bf16 v[220:223], v[72:75], v[148:151], v[220:223]
    ds_read2_b32 v[118:119], v34 offset0:146 offset1:147
    v_mfma_f32_16x16x32_bf16 v[204:207], v[76:79], v[128:131], v[204:207]
    v_mfma_f32_16x16x32_bf16 v[208:211], v[76:79], v[132:135], v[208:211]
    ds_read_b128 v[184:187], v40 offset:576
    v_mfma_f32_16x16x32_bf16 v[212:215], v[76:79], v[136:139], v[212:215]
    ds_read2_b32 v[120:121], v35 offset0:16 offset1:17
    v_mfma_f32_16x16x32_bf16 v[216:219], v[76:79], v[140:143], v[216:219]
    v_mfma_f32_16x16x32_bf16 v[220:223], v[76:79], v[144:147], v[220:223]
    ds_read2_b32 v[122:123], v35 offset0:18 offset1:19
    v_mfma_f32_16x16x32_bf16 v[208:211], v[80:83], v[128:131], v[208:211]
    v_mfma_f32_16x16x32_bf16 v[212:215], v[80:83], v[132:135], v[212:215]
    ds_read_b128 v[188:191], v40 offset:64
    v_mfma_f32_16x16x32_bf16 v[216:219], v[80:83], v[136:139], v[216:219]
    ds_read2_b32 v[124:125], v35 offset0:144 offset1:145
    v_mfma_f32_16x16x32_bf16 v[220:223], v[80:83], v[140:143], v[220:223]
    v_mfma_f32_16x16x32_bf16 v[212:215], v[84:87], v[128:131], v[212:215]
    ds_read2_b32 v[126:127], v35 offset0:146 offset1:147
    v_mfma_f32_16x16x32_bf16 v[216:219], v[84:87], v[132:135], v[216:219]
    v_mfma_f32_16x16x32_bf16 v[220:223], v[84:87], v[136:139], v[220:223]
    v_mfma_f32_16x16x32_bf16 v[216:219], v[88:91], v[128:131], v[216:219]
    v_mfma_f32_16x16x32_bf16 v[220:223], v[88:91], v[132:135], v[220:223]
    v_mfma_f32_16x16x32_bf16 v[220:223], v[92:95], v[128:131], v[220:223]
    s_waitcnt lgkmcnt(0)
    v_mfma_f32_16x16x32_bf16 v[192:195], v[96:99], v[160:163], v[192:195]
    ds_read_b128 v[128:131], v40 offset:3712
    v_mfma_f32_16x16x32_bf16 v[196:199], v[96:99], v[164:167], v[196:199]
    ds_read2_b32 v[64:65], v32 offset0:32 offset1:33
    v_mfma_f32_16x16x32_bf16 v[200:203], v[96:99], v[168:171], v[200:203]
    ds_read2_b32 v[66:67], v32 offset0:34 offset1:35
    v_mfma_f32_16x16x32_bf16 v[204:207], v[96:99], v[172:175], v[204:207]
    v_mfma_f32_16x16x32_bf16 v[208:211], v[96:99], v[176:179], v[208:211]
    ds_read_b128 v[132:135], v40 offset:3200
    v_mfma_f32_16x16x32_bf16 v[212:215], v[96:99], v[180:183], v[212:215]
    ds_read2_b32 v[68:69], v32 offset0:160 offset1:161
    v_mfma_f32_16x16x32_bf16 v[216:219], v[96:99], v[184:187], v[216:219]
    buffer_load_dwordx4 v9, s[44:47], 0 offen offset:2048 lds
    ds_read2_b32 v[70:71], v32 offset0:162 offset1:163
    v_mfma_f32_16x16x32_bf16 v[220:223], v[96:99], v[188:191], v[220:223]
    v_mfma_f32_16x16x32_bf16 v[196:199], v[100:103], v[160:163], v[196:199]
    ds_read_b128 v[136:139], v40 offset:2688
    v_mfma_f32_16x16x32_bf16 v[200:203], v[100:103], v[164:167], v[200:203]
    ds_read2_b32 v[72:73], v33 offset0:32 offset1:33
    v_mfma_f32_16x16x32_bf16 v[204:207], v[100:103], v[168:171], v[204:207]
    ds_read2_b32 v[74:75], v33 offset0:34 offset1:35
    v_mfma_f32_16x16x32_bf16 v[208:211], v[100:103], v[172:175], v[208:211]
    v_mfma_f32_16x16x32_bf16 v[212:215], v[100:103], v[176:179], v[212:215]
    ds_read_b128 v[140:143], v40 offset:2176
    v_mfma_f32_16x16x32_bf16 v[216:219], v[100:103], v[180:183], v[216:219]
    ds_read2_b32 v[76:77], v33 offset0:160 offset1:161
    v_mfma_f32_16x16x32_bf16 v[220:223], v[100:103], v[184:187], v[220:223]
    ds_read2_b32 v[78:79], v33 offset0:162 offset1:163
    v_mfma_f32_16x16x32_bf16 v[200:203], v[104:107], v[160:163], v[200:203]
    v_mfma_f32_16x16x32_bf16 v[204:207], v[104:107], v[164:167], v[204:207]
    ds_read_b128 v[144:147], v40 offset:1664
    v_mfma_f32_16x16x32_bf16 v[208:211], v[104:107], v[168:171], v[208:211]
    ds_read2_b32 v[80:81], v34 offset0:32 offset1:33
    v_mfma_f32_16x16x32_bf16 v[212:215], v[104:107], v[172:175], v[212:215]
    ds_read2_b32 v[82:83], v34 offset0:34 offset1:35
    v_mfma_f32_16x16x32_bf16 v[216:219], v[104:107], v[176:179], v[216:219]
    v_mfma_f32_16x16x32_bf16 v[220:223], v[104:107], v[180:183], v[220:223]
    ds_read_b128 v[148:151], v40 offset:1152
    v_mfma_f32_16x16x32_bf16 v[204:207], v[108:111], v[160:163], v[204:207]
    buffer_load_dwordx4 v9, s[44:47], 0 offen offset:3072 lds
    ds_read2_b32 v[84:85], v34 offset0:160 offset1:161
    v_mfma_f32_16x16x32_bf16 v[208:211], v[108:111], v[164:167], v[208:211]
    ds_read2_b32 v[86:87], v34 offset0:162 offset1:163
    v_mfma_f32_16x16x32_bf16 v[212:215], v[108:111], v[168:171], v[212:215]
    v_mfma_f32_16x16x32_bf16 v[216:219], v[108:111], v[172:175], v[216:219]
    ds_read_b128 v[152:155], v40 offset:640
    v_mfma_f32_16x16x32_bf16 v[220:223], v[108:111], v[176:179], v[220:223]
    ds_read2_b32 v[88:89], v35 offset0:32 offset1:33
    v_mfma_f32_16x16x32_bf16 v[208:211], v[112:115], v[160:163], v[208:211]
    ds_read2_b32 v[90:91], v35 offset0:34 offset1:35
    v_mfma_f32_16x16x32_bf16 v[212:215], v[112:115], v[164:167], v[212:215]
    v_mfma_f32_16x16x32_bf16 v[216:219], v[112:115], v[168:171], v[216:219]
    ds_read_b128 v[156:159], v40 offset:128
    v_mfma_f32_16x16x32_bf16 v[220:223], v[112:115], v[172:175], v[220:223]
    ds_read2_b32 v[92:93], v35 offset0:160 offset1:161
    v_mfma_f32_16x16x32_bf16 v[212:215], v[116:119], v[160:163], v[212:215]
    ds_read2_b32 v[94:95], v35 offset0:162 offset1:163
    v_mfma_f32_16x16x32_bf16 v[216:219], v[116:119], v[164:167], v[216:219]
    v_mfma_f32_16x16x32_bf16 v[220:223], v[116:119], v[168:171], v[220:223]
    v_mfma_f32_16x16x32_bf16 v[216:219], v[120:123], v[160:163], v[216:219]
    v_mfma_f32_16x16x32_bf16 v[220:223], v[120:123], v[164:167], v[220:223]
    v_mfma_f32_16x16x32_bf16 v[220:223], v[124:127], v[160:163], v[220:223]
    s_waitcnt lgkmcnt(0)
    v_mfma_f32_16x16x32_bf16 v[192:195], v[64:67], v[128:131], v[192:195]
    ds_read_b128 v[160:163], v40 offset:3776
    v_mfma_f32_16x16x32_bf16 v[196:199], v[64:67], v[132:135], v[196:199]
    ds_read2_b32 v[96:97], v32 offset0:48 offset1:49
    v_mfma_f32_16x16x32_bf16 v[200:203], v[64:67], v[136:139], v[200:203]
    ds_read2_b32 v[98:99], v32 offset0:50 offset1:51
    v_mfma_f32_16x16x32_bf16 v[204:207], v[64:67], v[140:143], v[204:207]
    v_mfma_f32_16x16x32_bf16 v[208:211], v[64:67], v[144:147], v[208:211]
    ds_read_b128 v[164:167], v40 offset:3264
    v_mfma_f32_16x16x32_bf16 v[212:215], v[64:67], v[148:151], v[212:215]
    ds_read2_b32 v[100:101], v32 offset0:176 offset1:177
    v_mfma_f32_16x16x32_bf16 v[216:219], v[64:67], v[152:155], v[216:219]
    s_add_u32 m0, s60, 55904
    s_mov_b32 s54, 2
    buffer_load_dwordx4 v9, s[44:47], s54 offen lds
    ds_read2_b32 v[102:103], v32 offset0:178 offset1:179
    v_mfma_f32_16x16x32_bf16 v[220:223], v[64:67], v[156:159], v[220:223]
    v_mfma_f32_16x16x32_bf16 v[196:199], v[68:71], v[128:131], v[196:199]
    ds_read_b128 v[168:171], v40 offset:2752
    v_mfma_f32_16x16x32_bf16 v[200:203], v[68:71], v[132:135], v[200:203]
    ds_read2_b32 v[104:105], v33 offset0:48 offset1:49
    v_mfma_f32_16x16x32_bf16 v[204:207], v[68:71], v[136:139], v[204:207]
    ds_read2_b32 v[106:107], v33 offset0:50 offset1:51
    v_mfma_f32_16x16x32_bf16 v[208:211], v[68:71], v[140:143], v[208:211]
    s_branch L_pgcs1
.p2align 12
L_pgc1:
    s_branch L_pgcret
L_pgcs1:
    v_mfma_f32_16x16x32_bf16 v[212:215], v[68:71], v[144:147], v[212:215]
    ds_read_b128 v[172:175], v40 offset:2240
    v_mfma_f32_16x16x32_bf16 v[216:219], v[68:71], v[148:151], v[216:219]
    ds_read2_b32 v[108:109], v33 offset0:176 offset1:177
    v_mfma_f32_16x16x32_bf16 v[220:223], v[68:71], v[152:155], v[220:223]
    ds_read2_b32 v[110:111], v33 offset0:178 offset1:179
    v_mfma_f32_16x16x32_bf16 v[200:203], v[72:75], v[128:131], v[200:203]
    v_mfma_f32_16x16x32_bf16 v[204:207], v[72:75], v[132:135], v[204:207]
    ds_read_b128 v[176:179], v40 offset:1728
    v_mfma_f32_16x16x32_bf16 v[208:211], v[72:75], v[136:139], v[208:211]
    ds_read2_b32 v[112:113], v34 offset0:48 offset1:49
    v_mfma_f32_16x16x32_bf16 v[212:215], v[72:75], v[140:143], v[212:215]
    ds_read2_b32 v[114:115], v34 offset0:50 offset1:51
    v_mfma_f32_16x16x32_bf16 v[216:219], v[72:75], v[144:147], v[216:219]
    v_mfma_f32_16x16x32_bf16 v[220:223], v[72:75], v[148:151], v[220:223]
    ds_read_b128 v[180:183], v40 offset:1216
    v_mfma_f32_16x16x32_bf16 v[204:207], v[76:79], v[128:131], v[204:207]
    buffer_load_dwordx4 v9, s[44:47], s54 offen offset:1024 lds
    ds_read2_b32 v[116:117], v34 offset0:176 offset1:177
    v_mfma_f32_16x16x32_bf16 v[208:211], v[76:79], v[132:135], v[208:211]
    ds_read2_b32 v[118:119], v34 offset0:178 offset1:179
    v_mfma_f32_16x16x32_bf16 v[212:215], v[76:79], v[136:139], v[212:215]
    v_mfma_f32_16x16x32_bf16 v[216:219], v[76:79], v[140:143], v[216:219]
    ds_read_b128 v[184:187], v40 offset:704
    v_mfma_f32_16x16x32_bf16 v[220:223], v[76:79], v[144:147], v[220:223]
    ds_read2_b32 v[120:121], v35 offset0:48 offset1:49
    v_mfma_f32_16x16x32_bf16 v[208:211], v[80:83], v[128:131], v[208:211]
    ds_read2_b32 v[122:123], v35 offset0:50 offset1:51
    v_mfma_f32_16x16x32_bf16 v[212:215], v[80:83], v[132:135], v[212:215]
    v_mfma_f32_16x16x32_bf16 v[216:219], v[80:83], v[136:139], v[216:219]
    ds_read_b128 v[188:191], v40 offset:192
    v_mfma_f32_16x16x32_bf16 v[220:223], v[80:83], v[140:143], v[220:223]
    ds_read2_b32 v[124:125], v35 offset0:176 offset1:177
    v_mfma_f32_16x16x32_bf16 v[212:215], v[84:87], v[128:131], v[212:215]
    ds_read2_b32 v[126:127], v35 offset0:178 offset1:179
    v_mfma_f32_16x16x32_bf16 v[216:219], v[84:87], v[132:135], v[216:219]
    v_mfma_f32_16x16x32_bf16 v[220:223], v[84:87], v[136:139], v[220:223]
    v_mfma_f32_16x16x32_bf16 v[216:219], v[88:91], v[128:131], v[216:219]
    v_mfma_f32_16x16x32_bf16 v[220:223], v[88:91], v[132:135], v[220:223]
    v_mfma_f32_16x16x32_bf16 v[220:223], v[92:95], v[128:131], v[220:223]
    s_waitcnt lgkmcnt(0)
    v_mfma_f32_16x16x32_bf16 v[192:195], v[96:99], v[160:163], v[192:195]
    ds_read_b128 v[128:131], v40 offset:3840
    v_mfma_f32_16x16x32_bf16 v[196:199], v[96:99], v[164:167], v[196:199]
    ds_read2_b32 v[64:65], v32 offset0:64 offset1:65
    v_mfma_f32_16x16x32_bf16 v[200:203], v[96:99], v[168:171], v[200:203]
    ds_read2_b32 v[66:67], v32 offset0:66 offset1:67
    v_mfma_f32_16x16x32_bf16 v[204:207], v[96:99], v[172:175], v[204:207]
    v_mfma_f32_16x16x32_bf16 v[208:211], v[96:99], v[176:179], v[208:211]
    ds_read_b128 v[132:135], v40 offset:3328
    v_mfma_f32_16x16x32_bf16 v[212:215], v[96:99], v[180:183], v[212:215]
    ds_read2_b32 v[68:69], v32 offset0:192 offset1:193
    v_mfma_f32_16x16x32_bf16 v[216:219], v[96:99], v[184:187], v[216:219]
    buffer_load_dwordx4 v9, s[44:47], s54 offen offset:2048 lds
    ds_read2_b32 v[70:71], v32 offset0:194 offset1:195
    v_mfma_f32_16x16x32_bf16 v[220:223], v[96:99], v[188:191], v[220:223]
    v_mfma_f32_16x16x32_bf16 v[196:199], v[100:103], v[160:163], v[196:199]
    ds_read_b128 v[136:139], v40 offset:2816
    v_mfma_f32_16x16x32_bf16 v[200:203], v[100:103], v[164:167], v[200:203]
    ds_read2_b32 v[72:73], v33 offset0:64 offset1:65
    v_mfma_f32_16x16x32_bf16 v[204:207], v[100:103], v[168:171], v[204:207]
    ds_read2_b32 v[74:75], v33 offset0:66 offset1:67
    v_mfma_f32_16x16x32_bf16 v[208:211], v[100:103], v[172:175], v[208:211]
    v_mfma_f32_16x16x32_bf16 v[212:215], v[100:103], v[176:179], v[212:215]
    ds_read_b128 v[140:143], v40 offset:2304
    v_mfma_f32_16x16x32_bf16 v[216:219], v[100:103], v[180:183], v[216:219]
    ds_read2_b32 v[76:77], v33 offset0:192 offset1:193
    v_mfma_f32_16x16x32_bf16 v[220:223], v[100:103], v[184:187], v[220:223]
    ds_read2_b32 v[78:79], v33 offset0:194 offset1:195
    v_mfma_f32_16x16x32_bf16 v[200:203], v[104:107], v[160:163], v[200:203]
    v_mfma_f32_16x16x32_bf16 v[204:207], v[104:107], v[164:167], v[204:207]
    ds_read_b128 v[144:147], v40 offset:1792
    v_mfma_f32_16x16x32_bf16 v[208:211], v[104:107], v[168:171], v[208:211]
    ds_read2_b32 v[80:81], v34 offset0:64 offset1:65
    v_mfma_f32_16x16x32_bf16 v[212:215], v[104:107], v[172:175], v[212:215]
    ds_read2_b32 v[82:83], v34 offset0:66 offset1:67
    v_mfma_f32_16x16x32_bf16 v[216:219], v[104:107], v[176:179], v[216:219]
    v_mfma_f32_16x16x32_bf16 v[220:223], v[104:107], v[180:183], v[220:223]
    ds_read_b128 v[148:151], v40 offset:1280
    v_mfma_f32_16x16x32_bf16 v[204:207], v[108:111], v[160:163], v[204:207]
    buffer_load_dwordx4 v9, s[44:47], s54 offen offset:3072 lds
    ds_read2_b32 v[84:85], v34 offset0:192 offset1:193
    v_mfma_f32_16x16x32_bf16 v[208:211], v[108:111], v[164:167], v[208:211]
    ds_read2_b32 v[86:87], v34 offset0:194 offset1:195
    v_mfma_f32_16x16x32_bf16 v[212:215], v[108:111], v[168:171], v[212:215]
    v_mfma_f32_16x16x32_bf16 v[216:219], v[108:111], v[172:175], v[216:219]
    ds_read_b128 v[152:155], v40 offset:768
    v_mfma_f32_16x16x32_bf16 v[220:223], v[108:111], v[176:179], v[220:223]
    ds_read2_b32 v[88:89], v35 offset0:64 offset1:65
    v_mfma_f32_16x16x32_bf16 v[208:211], v[112:115], v[160:163], v[208:211]
    ds_read2_b32 v[90:91], v35 offset0:66 offset1:67
    v_mfma_f32_16x16x32_bf16 v[212:215], v[112:115], v[164:167], v[212:215]
    v_mfma_f32_16x16x32_bf16 v[216:219], v[112:115], v[168:171], v[216:219]
    ds_read_b128 v[156:159], v40 offset:256
    v_mfma_f32_16x16x32_bf16 v[220:223], v[112:115], v[172:175], v[220:223]
    ds_read2_b32 v[92:93], v35 offset0:192 offset1:193
    v_mfma_f32_16x16x32_bf16 v[212:215], v[116:119], v[160:163], v[212:215]
    ds_read2_b32 v[94:95], v35 offset0:194 offset1:195
    v_mfma_f32_16x16x32_bf16 v[216:219], v[116:119], v[164:167], v[216:219]
    v_mfma_f32_16x16x32_bf16 v[220:223], v[116:119], v[168:171], v[220:223]
    v_mfma_f32_16x16x32_bf16 v[216:219], v[120:123], v[160:163], v[216:219]
    v_mfma_f32_16x16x32_bf16 v[220:223], v[120:123], v[164:167], v[220:223]
    v_mfma_f32_16x16x32_bf16 v[220:223], v[124:127], v[160:163], v[220:223]
    s_waitcnt lgkmcnt(0)
    v_mfma_f32_16x16x32_bf16 v[192:195], v[64:67], v[128:131], v[192:195]
    ds_read_b128 v[160:163], v40 offset:3904
    v_mfma_f32_16x16x32_bf16 v[196:199], v[64:67], v[132:135], v[196:199]
    ds_read2_b32 v[96:97], v32 offset0:80 offset1:81
    v_mfma_f32_16x16x32_bf16 v[200:203], v[64:67], v[136:139], v[200:203]
    ds_read2_b32 v[98:99], v32 offset0:82 offset1:83
    v_mfma_f32_16x16x32_bf16 v[204:207], v[64:67], v[140:143], v[204:207]
    v_mfma_f32_16x16x32_bf16 v[208:211], v[64:67], v[144:147], v[208:211]
    ds_read_b128 v[164:167], v40 offset:3392
    v_mfma_f32_16x16x32_bf16 v[212:215], v[64:67], v[148:151], v[212:215]
    ds_read2_b32 v[100:101], v32 offset0:208 offset1:209
    v_mfma_f32_16x16x32_bf16 v[216:219], v[64:67], v[152:155], v[216:219]
    s_add_u32 m0, s60, 60032
    s_mov_b32 s54, 4718592
    buffer_load_dwordx4 v13, s[40:43], s54 offen sc1 lds
    ds_read2_b32 v[102:103], v32 offset0:210 offset1:211
    v_mfma_f32_16x16x32_bf16 v[220:223], v[64:67], v[156:159], v[220:223]
    v_mfma_f32_16x16x32_bf16 v[196:199], v[68:71], v[128:131], v[196:199]
    ds_read_b128 v[168:171], v40 offset:2880
    v_mfma_f32_16x16x32_bf16 v[200:203], v[68:71], v[132:135], v[200:203]
    ds_read2_b32 v[104:105], v33 offset0:80 offset1:81
    v_mfma_f32_16x16x32_bf16 v[204:207], v[68:71], v[136:139], v[204:207]
    ds_read2_b32 v[106:107], v33 offset0:82 offset1:83
    v_mfma_f32_16x16x32_bf16 v[208:211], v[68:71], v[140:143], v[208:211]
    v_mfma_f32_16x16x32_bf16 v[212:215], v[68:71], v[144:147], v[212:215]
    ds_read_b128 v[172:175], v40 offset:2368
    v_mfma_f32_16x16x32_bf16 v[216:219], v[68:71], v[148:151], v[216:219]
    ds_read2_b32 v[108:109], v33 offset0:208 offset1:209
    v_mfma_f32_16x16x32_bf16 v[220:223], v[68:71], v[152:155], v[220:223]
    ds_read2_b32 v[110:111], v33 offset0:210 offset1:211
    v_mfma_f32_16x16x32_bf16 v[200:203], v[72:75], v[128:131], v[200:203]
    v_mfma_f32_16x16x32_bf16 v[204:207], v[72:75], v[132:135], v[204:207]
    ds_read_b128 v[176:179], v40 offset:1856
    v_mfma_f32_16x16x32_bf16 v[208:211], v[72:75], v[136:139], v[208:211]
    ds_read2_b32 v[112:113], v34 offset0:80 offset1:81
    v_mfma_f32_16x16x32_bf16 v[212:215], v[72:75], v[140:143], v[212:215]
    ds_read2_b32 v[114:115], v34 offset0:82 offset1:83
    v_mfma_f32_16x16x32_bf16 v[216:219], v[72:75], v[144:147], v[216:219]
    v_mfma_f32_16x16x32_bf16 v[220:223], v[72:75], v[148:151], v[220:223]
    ds_read_b128 v[180:183], v40 offset:1344
    v_mfma_f32_16x16x32_bf16 v[204:207], v[76:79], v[128:131], v[204:207]
    buffer_load_dwordx4 v13, s[40:43], s54 offen offset:1024 sc1 lds
    ds_read2_b32 v[116:117], v34 offset0:208 offset1:209
    v_mfma_f32_16x16x32_bf16 v[208:211], v[76:79], v[132:135], v[208:211]
    ds_read2_b32 v[118:119], v34 offset0:210 offset1:211
    v_mfma_f32_16x16x32_bf16 v[212:215], v[76:79], v[136:139], v[212:215]
    v_mfma_f32_16x16x32_bf16 v[216:219], v[76:79], v[140:143], v[216:219]
    ds_read_b128 v[184:187], v40 offset:832
    v_mfma_f32_16x16x32_bf16 v[220:223], v[76:79], v[144:147], v[220:223]
    ds_read2_b32 v[120:121], v35 offset0:80 offset1:81
    v_mfma_f32_16x16x32_bf16 v[208:211], v[80:83], v[128:131], v[208:211]
    ds_read2_b32 v[122:123], v35 offset0:82 offset1:83
    v_mfma_f32_16x16x32_bf16 v[212:215], v[80:83], v[132:135], v[212:215]
    v_mfma_f32_16x16x32_bf16 v[216:219], v[80:83], v[136:139], v[216:219]
    ds_read_b128 v[188:191], v40 offset:320
    v_mfma_f32_16x16x32_bf16 v[220:223], v[80:83], v[140:143], v[220:223]
    ds_read2_b32 v[124:125], v35 offset0:208 offset1:209
    v_mfma_f32_16x16x32_bf16 v[212:215], v[84:87], v[128:131], v[212:215]
    ds_read2_b32 v[126:127], v35 offset0:210 offset1:211
    v_mfma_f32_16x16x32_bf16 v[216:219], v[84:87], v[132:135], v[216:219]
    v_mfma_f32_16x16x32_bf16 v[220:223], v[84:87], v[136:139], v[220:223]
    v_mfma_f32_16x16x32_bf16 v[216:219], v[88:91], v[128:131], v[216:219]
    v_mfma_f32_16x16x32_bf16 v[220:223], v[88:91], v[132:135], v[220:223]
    v_mfma_f32_16x16x32_bf16 v[220:223], v[92:95], v[128:131], v[220:223]
    s_waitcnt lgkmcnt(0)
    v_mfma_f32_16x16x32_bf16 v[192:195], v[96:99], v[160:163], v[192:195]
    ds_read_b128 v[128:131], v40 offset:3968
    v_mfma_f32_16x16x32_bf16 v[196:199], v[96:99], v[164:167], v[196:199]
    ds_read2_b32 v[64:65], v32 offset0:96 offset1:97
    v_mfma_f32_16x16x32_bf16 v[200:203], v[96:99], v[168:171], v[200:203]
    ds_read2_b32 v[66:67], v32 offset0:98 offset1:99
    v_mfma_f32_16x16x32_bf16 v[204:207], v[96:99], v[172:175], v[204:207]
    v_mfma_f32_16x16x32_bf16 v[208:211], v[96:99], v[176:179], v[208:211]
    ds_read_b128 v[132:135], v40 offset:3456
    v_mfma_f32_16x16x32_bf16 v[212:215], v[96:99], v[180:183], v[212:215]
    ds_read2_b32 v[68:69], v32 offset0:224 offset1:225
    v_mfma_f32_16x16x32_bf16 v[216:219], v[96:99], v[184:187], v[216:219]
    buffer_load_dwordx4 v13, s[40:43], s54 offen offset:2048 sc1 lds
    ds_read2_b32 v[70:71], v32 offset0:226 offset1:227
    v_mfma_f32_16x16x32_bf16 v[220:223], v[96:99], v[188:191], v[220:223]
    v_mfma_f32_16x16x32_bf16 v[196:199], v[100:103], v[160:163], v[196:199]
    ds_read_b128 v[136:139], v40 offset:2944
    v_mfma_f32_16x16x32_bf16 v[200:203], v[100:103], v[164:167], v[200:203]
    ds_read2_b32 v[72:73], v33 offset0:96 offset1:97
    v_mfma_f32_16x16x32_bf16 v[204:207], v[100:103], v[168:171], v[204:207]
    ds_read2_b32 v[74:75], v33 offset0:98 offset1:99
    v_mfma_f32_16x16x32_bf16 v[208:211], v[100:103], v[172:175], v[208:211]
    v_mfma_f32_16x16x32_bf16 v[212:215], v[100:103], v[176:179], v[212:215]
    ds_read_b128 v[140:143], v40 offset:2432
    v_mfma_f32_16x16x32_bf16 v[216:219], v[100:103], v[180:183], v[216:219]
    ds_read2_b32 v[76:77], v33 offset0:224 offset1:225
    v_mfma_f32_16x16x32_bf16 v[220:223], v[100:103], v[184:187], v[220:223]
    ds_read2_b32 v[78:79], v33 offset0:226 offset1:227
    v_mfma_f32_16x16x32_bf16 v[200:203], v[104:107], v[160:163], v[200:203]
    v_mfma_f32_16x16x32_bf16 v[204:207], v[104:107], v[164:167], v[204:207]
    ds_read_b128 v[144:147], v40 offset:1920
    v_mfma_f32_16x16x32_bf16 v[208:211], v[104:107], v[168:171], v[208:211]
    ds_read2_b32 v[80:81], v34 offset0:96 offset1:97
    v_mfma_f32_16x16x32_bf16 v[212:215], v[104:107], v[172:175], v[212:215]
    ds_read2_b32 v[82:83], v34 offset0:98 offset1:99
    v_mfma_f32_16x16x32_bf16 v[216:219], v[104:107], v[176:179], v[216:219]
    v_mfma_f32_16x16x32_bf16 v[220:223], v[104:107], v[180:183], v[220:223]
    ds_read_b128 v[148:151], v40 offset:1408
    v_mfma_f32_16x16x32_bf16 v[204:207], v[108:111], v[160:163], v[204:207]
    buffer_load_dwordx4 v13, s[40:43], s54 offen offset:3072 sc1 lds
    ds_read2_b32 v[84:85], v34 offset0:224 offset1:225
    v_mfma_f32_16x16x32_bf16 v[208:211], v[108:111], v[164:167], v[208:211]
    ds_read2_b32 v[86:87], v34 offset0:226 offset1:227
    v_mfma_f32_16x16x32_bf16 v[212:215], v[108:111], v[168:171], v[212:215]
    v_mfma_f32_16x16x32_bf16 v[216:219], v[108:111], v[172:175], v[216:219]
    ds_read_b128 v[152:155], v40 offset:896
    v_mfma_f32_16x16x32_bf16 v[220:223], v[108:111], v[176:179], v[220:223]
    ds_read2_b32 v[88:89], v35 offset0:96 offset1:97
    v_mfma_f32_16x16x32_bf16 v[208:211], v[112:115], v[160:163], v[208:211]
    ds_read2_b32 v[90:91], v35 offset0:98 offset1:99
    v_mfma_f32_16x16x32_bf16 v[212:215], v[112:115], v[164:167], v[212:215]
    v_mfma_f32_16x16x32_bf16 v[216:219], v[112:115], v[168:171], v[216:219]
    ds_read_b128 v[156:159], v40 offset:384
    v_mfma_f32_16x16x32_bf16 v[220:223], v[112:115], v[172:175], v[220:223]
    ds_read2_b32 v[92:93], v35 offset0:224 offset1:225
    v_mfma_f32_16x16x32_bf16 v[212:215], v[116:119], v[160:163], v[212:215]
    ds_read2_b32 v[94:95], v35 offset0:226 offset1:227
    v_mfma_f32_16x16x32_bf16 v[216:219], v[116:119], v[164:167], v[216:219]
    v_mfma_f32_16x16x32_bf16 v[220:223], v[116:119], v[168:171], v[220:223]
    v_mfma_f32_16x16x32_bf16 v[216:219], v[120:123], v[160:163], v[216:219]
    v_mfma_f32_16x16x32_bf16 v[220:223], v[120:123], v[164:167], v[220:223]
    v_mfma_f32_16x16x32_bf16 v[220:223], v[124:127], v[160:163], v[220:223]
    s_waitcnt lgkmcnt(0)
    v_mfma_f32_16x16x32_bf16 v[192:195], v[64:67], v[128:131], v[192:195]
    ds_read_b128 v[160:163], v40 offset:4032
    v_mfma_f32_16x16x32_bf16 v[196:199], v[64:67], v[132:135], v[196:199]
    ds_read2_b32 v[96:97], v32 offset0:112 offset1:113
    v_mfma_f32_16x16x32_bf16 v[200:203], v[64:67], v[136:139], v[200:203]
    ds_read2_b32 v[98:99], v32 offset0:114 offset1:115
    v_mfma_f32_16x16x32_bf16 v[204:207], v[64:67], v[140:143], v[204:207]
    v_mfma_f32_16x16x32_bf16 v[208:211], v[64:67], v[144:147], v[208:211]
    ds_read_b128 v[164:167], v40 offset:3520
    v_mfma_f32_16x16x32_bf16 v[212:215], v[64:67], v[148:151], v[212:215]
    ds_read2_b32 v[100:101], v32 offset0:240 offset1:241
    v_mfma_f32_16x16x32_bf16 v[216:219], v[64:67], v[152:155], v[216:219]
    ds_read2_b32 v[102:103], v32 offset0:242 offset1:243
    v_mfma_f32_16x16x32_bf16 v[220:223], v[64:67], v[156:159], v[220:223]
    v_mfma_f32_16x16x32_bf16 v[196:199], v[68:71], v[128:131], v[196:199]
    ds_read_b128 v[168:171], v40 offset:3008
    v_mfma_f32_16x16x32_bf16 v[200:203], v[68:71], v[132:135], v[200:203]
    ds_read2_b32 v[104:105], v33 offset0:112 offset1:113
    v_mfma_f32_16x16x32_bf16 v[204:207], v[68:71], v[136:139], v[204:207]
    ds_read2_b32 v[106:107], v33 offset0:114 offset1:115
    v_mfma_f32_16x16x32_bf16 v[208:211], v[68:71], v[140:143], v[208:211]
    v_mfma_f32_16x16x32_bf16 v[212:215], v[68:71], v[144:147], v[212:215]
    ds_read_b128 v[172:175], v40 offset:2496
    v_mfma_f32_16x16x32_bf16 v[216:219], v[68:71], v[148:151], v[216:219]
    ds_read2_b32 v[108:109], v33 offset0:240 offset1:241
    v_mfma_f32_16x16x32_bf16 v[220:223], v[68:71], v[152:155], v[220:223]
    ds_read2_b32 v[110:111], v33 offset0:242 offset1:243
    v_mfma_f32_16x16x32_bf16 v[200:203], v[72:75], v[128:131], v[200:203]
    v_mfma_f32_16x16x32_bf16 v[204:207], v[72:75], v[132:135], v[204:207]
    ds_read_b128 v[176:179], v40 offset:1984
    v_mfma_f32_16x16x32_bf16 v[208:211], v[72:75], v[136:139], v[208:211]
    ds_read2_b32 v[112:113], v34 offset0:112 offset1:113
    v_mfma_f32_16x16x32_bf16 v[212:215], v[72:75], v[140:143], v[212:215]
    ds_read2_b32 v[114:115], v34 offset0:114 offset1:115
    v_mfma_f32_16x16x32_bf16 v[216:219], v[72:75], v[144:147], v[216:219]
    v_mfma_f32_16x16x32_bf16 v[220:223], v[72:75], v[148:151], v[220:223]
    ds_read_b128 v[180:183], v40 offset:1472
    v_mfma_f32_16x16x32_bf16 v[204:207], v[76:79], v[128:131], v[204:207]
    ds_read2_b32 v[116:117], v34 offset0:240 offset1:241
    v_mfma_f32_16x16x32_bf16 v[208:211], v[76:79], v[132:135], v[208:211]
    ds_read2_b32 v[118:119], v34 offset0:242 offset1:243
    v_mfma_f32_16x16x32_bf16 v[212:215], v[76:79], v[136:139], v[212:215]
    v_mfma_f32_16x16x32_bf16 v[216:219], v[76:79], v[140:143], v[216:219]
    ds_read_b128 v[184:187], v40 offset:960
    v_mfma_f32_16x16x32_bf16 v[220:223], v[76:79], v[144:147], v[220:223]
    ds_read2_b32 v[120:121], v35 offset0:112 offset1:113
    v_mfma_f32_16x16x32_bf16 v[208:211], v[80:83], v[128:131], v[208:211]
    ds_read2_b32 v[122:123], v35 offset0:114 offset1:115
    v_mfma_f32_16x16x32_bf16 v[212:215], v[80:83], v[132:135], v[212:215]
    v_mfma_f32_16x16x32_bf16 v[216:219], v[80:83], v[136:139], v[216:219]
    ds_read_b128 v[188:191], v40 offset:448
    v_mfma_f32_16x16x32_bf16 v[220:223], v[80:83], v[140:143], v[220:223]
    ds_read2_b32 v[124:125], v35 offset0:240 offset1:241
    v_mfma_f32_16x16x32_bf16 v[212:215], v[84:87], v[128:131], v[212:215]
    ds_read2_b32 v[126:127], v35 offset0:242 offset1:243
    v_mfma_f32_16x16x32_bf16 v[216:219], v[84:87], v[132:135], v[216:219]
    v_mfma_f32_16x16x32_bf16 v[220:223], v[84:87], v[136:139], v[220:223]
    v_mfma_f32_16x16x32_bf16 v[216:219], v[88:91], v[128:131], v[216:219]
    v_mfma_f32_16x16x32_bf16 v[220:223], v[88:91], v[132:135], v[220:223]
    v_mfma_f32_16x16x32_bf16 v[220:223], v[92:95], v[128:131], v[220:223]
    s_waitcnt lgkmcnt(0)
    v_mfma_f32_16x16x32_bf16 v[192:195], v[96:99], v[160:163], v[192:195]
    s_waitcnt vmcnt(0)
    ds_read_b128 v[128:131], v40 offset:55296
    v_mfma_f32_16x16x32_bf16 v[196:199], v[96:99], v[164:167], v[196:199]
    ds_read2_b32 v[64:65], v36 offset0:0 offset1:1
    v_mfma_f32_16x16x32_bf16 v[200:203], v[96:99], v[168:171], v[200:203]
    ds_read2_b32 v[66:67], v36 offset0:2 offset1:3
    v_mfma_f32_16x16x32_bf16 v[204:207], v[96:99], v[172:175], v[204:207]
    v_mfma_f32_16x16x32_bf16 v[208:211], v[96:99], v[176:179], v[208:211]
    ds_read_b128 v[132:135], v40 offset:54784
    v_mfma_f32_16x16x32_bf16 v[212:215], v[96:99], v[180:183], v[212:215]
    ds_read2_b32 v[68:69], v36 offset0:128 offset1:129
    v_mfma_f32_16x16x32_bf16 v[216:219], v[96:99], v[184:187], v[216:219]
    ds_read2_b32 v[70:71], v36 offset0:130 offset1:131
    v_mfma_f32_16x16x32_bf16 v[220:223], v[96:99], v[188:191], v[220:223]
    v_mfma_f32_16x16x32_bf16 v[196:199], v[100:103], v[160:163], v[196:199]
    ds_read_b128 v[136:139], v40 offset:54272
    v_mfma_f32_16x16x32_bf16 v[200:203], v[100:103], v[164:167], v[200:203]
    ds_read2_b32 v[72:73], v37 offset0:0 offset1:1
    v_mfma_f32_16x16x32_bf16 v[204:207], v[100:103], v[168:171], v[204:207]
    ds_read2_b32 v[74:75], v37 offset0:2 offset1:3
    v_mfma_f32_16x16x32_bf16 v[208:211], v[100:103], v[172:175], v[208:211]
    v_mfma_f32_16x16x32_bf16 v[212:215], v[100:103], v[176:179], v[212:215]
    ds_read_b128 v[140:143], v40 offset:53760
    v_mfma_f32_16x16x32_bf16 v[216:219], v[100:103], v[180:183], v[216:219]
    ds_read2_b32 v[76:77], v37 offset0:128 offset1:129
    v_mfma_f32_16x16x32_bf16 v[220:223], v[100:103], v[184:187], v[220:223]
    ds_read2_b32 v[78:79], v37 offset0:130 offset1:131
    v_mfma_f32_16x16x32_bf16 v[200:203], v[104:107], v[160:163], v[200:203]
    v_mfma_f32_16x16x32_bf16 v[204:207], v[104:107], v[164:167], v[204:207]
    ds_read_b128 v[144:147], v40 offset:53248
    v_mfma_f32_16x16x32_bf16 v[208:211], v[104:107], v[168:171], v[208:211]
    ds_read2_b32 v[80:81], v38 offset0:0 offset1:1
    v_mfma_f32_16x16x32_bf16 v[212:215], v[104:107], v[172:175], v[212:215]
    ds_read2_b32 v[82:83], v38 offset0:2 offset1:3
    v_mfma_f32_16x16x32_bf16 v[216:219], v[104:107], v[176:179], v[216:219]
    v_mfma_f32_16x16x32_bf16 v[220:223], v[104:107], v[180:183], v[220:223]
    ds_read_b128 v[148:151], v40 offset:52736
    v_mfma_f32_16x16x32_bf16 v[204:207], v[108:111], v[160:163], v[204:207]
    ds_read2_b32 v[84:85], v38 offset0:128 offset1:129
    v_mfma_f32_16x16x32_bf16 v[208:211], v[108:111], v[164:167], v[208:211]
    ds_read2_b32 v[86:87], v38 offset0:130 offset1:131
    v_mfma_f32_16x16x32_bf16 v[212:215], v[108:111], v[168:171], v[212:215]
    v_mfma_f32_16x16x32_bf16 v[216:219], v[108:111], v[172:175], v[216:219]
    ds_read_b128 v[152:155], v40 offset:52224
    v_mfma_f32_16x16x32_bf16 v[220:223], v[108:111], v[176:179], v[220:223]
    ds_read2_b32 v[88:89], v39 offset0:0 offset1:1
    v_mfma_f32_16x16x32_bf16 v[208:211], v[112:115], v[160:163], v[208:211]
    ds_read2_b32 v[90:91], v39 offset0:2 offset1:3
    v_mfma_f32_16x16x32_bf16 v[212:215], v[112:115], v[164:167], v[212:215]
    v_mfma_f32_16x16x32_bf16 v[216:219], v[112:115], v[168:171], v[216:219]
    ds_read_b128 v[156:159], v40 offset:51712
    v_mfma_f32_16x16x32_bf16 v[220:223], v[112:115], v[172:175], v[220:223]
    ds_read2_b32 v[92:93], v39 offset0:128 offset1:129
    v_mfma_f32_16x16x32_bf16 v[212:215], v[116:119], v[160:163], v[212:215]
    ds_read2_b32 v[94:95], v39 offset0:130 offset1:131
    v_mfma_f32_16x16x32_bf16 v[216:219], v[116:119], v[164:167], v[216:219]
    v_mfma_f32_16x16x32_bf16 v[220:223], v[116:119], v[168:171], v[220:223]
    v_mfma_f32_16x16x32_bf16 v[216:219], v[120:123], v[160:163], v[216:219]
    v_mfma_f32_16x16x32_bf16 v[220:223], v[120:123], v[164:167], v[220:223]
    v_mfma_f32_16x16x32_bf16 v[220:223], v[124:127], v[160:163], v[220:223]
    v_cvt_pk_bf16_f32 v224, v192, v193
    v_cvt_pk_bf16_f32 v225, v194, v195
    v_cvt_pk_bf16_f32 v226, v196, v197
    v_cvt_pk_bf16_f32 v227, v198, v199
    v_cvt_pk_bf16_f32 v228, v200, v201
    v_cvt_pk_bf16_f32 v229, v202, v203
    v_cvt_pk_bf16_f32 v230, v204, v205
    v_cvt_pk_bf16_f32 v231, v206, v207
    v_cvt_pk_bf16_f32 v232, v208, v209
    v_cvt_pk_bf16_f32 v233, v210, v211
    v_cvt_pk_bf16_f32 v234, v212, v213
    v_cvt_pk_bf16_f32 v235, v214, v215
    v_cvt_pk_bf16_f32 v236, v216, v217
    v_cvt_pk_bf16_f32 v237, v218, v219
    v_cvt_pk_bf16_f32 v238, v220, v221
    v_cvt_pk_bf16_f32 v239, v222, v223
    v_permlane16_swap_b32 v224, v226
    v_permlane16_swap_b32 v225, v227
    v_permlane16_swap_b32 v228, v230
    v_permlane16_swap_b32 v229, v231
    v_permlane16_swap_b32 v232, v234
    v_permlane16_swap_b32 v233, v235
    v_permlane16_swap_b32 v236, v238
    v_permlane16_swap_b32 v237, v239
    buffer_store_dwordx4 v[224:227], v16, s[40:43], 0 offen offset:0 sc1
    buffer_store_dwordx4 v[228:231], v16, s[40:43], 0 offen offset:1024 sc1
    buffer_store_dwordx4 v[232:235], v16, s[40:43], 0 offen offset:2048 sc1
    buffer_store_dwordx4 v[236:239], v16, s[40:43], 0 offen offset:3072 sc1
L_round1:
    v_and_b32 v56, v21, v44
    v_and_b32 v57, v21, v45
    v_and_b32 v58, v21, v46
    v_and_b32 v59, v21, v47
    s_waitcnt lgkmcnt(0)
    s_nop 0
    v_mfma_f32_16x16x32_bf16 v[192:195], v[56:59], v[128:131], 0
    ds_read_b128 v[160:163], v40 offset:55360
    v_mfma_f32_16x16x32_bf16 v[196:199], v[56:59], v[132:135], 0
    ds_read2_b32 v[96:97], v36 offset0:16 offset1:17
    v_mfma_f32_16x16x32_bf16 v[200:203], v[56:59], v[136:139], 0
    v_mfma_f32_16x16x32_bf16 v[204:207], v[56:59], v[140:143], 0
    ds_read2_b32 v[98:99], v36 offset0:18 offset1:19
    v_mfma_f32_16x16x32_bf16 v[208:211], v[56:59], v[144:147], 0
    v_mfma_f32_16x16x32_bf16 v[212:215], v[56:59], v[148:151], 0
    ds_read_b128 v[164:167], v40 offset:54848
    v_mfma_f32_16x16x32_bf16 v[216:219], v[56:59], v[152:155], 0
    ds_read2_b32 v[100:101], v36 offset0:144 offset1:145
    v_mfma_f32_16x16x32_bf16 v[220:223], v[56:59], v[156:159], 0
    v_mfma_f32_16x16x32_bf16 v[192:195], v[64:67], v[128:131], v[192:195]
    ds_read2_b32 v[102:103], v36 offset0:146 offset1:147
    v_mfma_f32_16x16x32_bf16 v[196:199], v[64:67], v[132:135], v[196:199]
    v_mfma_f32_16x16x32_bf16 v[200:203], v[64:67], v[136:139], v[200:203]
    ds_read_b128 v[168:171], v40 offset:54336
    v_mfma_f32_16x16x32_bf16 v[204:207], v[64:67], v[140:143], v[204:207]
    ds_read2_b32 v[104:105], v37 offset0:16 offset1:17
    v_mfma_f32_16x16x32_bf16 v[208:211], v[64:67], v[144:147], v[208:211]
    v_mfma_f32_16x16x32_bf16 v[212:215], v[64:67], v[148:151], v[212:215]
    ds_read2_b32 v[106:107], v37 offset0:18 offset1:19
    v_mfma_f32_16x16x32_bf16 v[216:219], v[64:67], v[152:155], v[216:219]
    v_mfma_f32_16x16x32_bf16 v[220:223], v[64:67], v[156:159], v[220:223]
    ds_read_b128 v[172:175], v40 offset:53824
    v_mfma_f32_16x16x32_bf16 v[196:199], v[68:71], v[128:131], v[196:199]
    ds_read2_b32 v[108:109], v37 offset0:144 offset1:145
    v_mfma_f32_16x16x32_bf16 v[200:203], v[68:71], v[132:135], v[200:203]
    v_mfma_f32_16x16x32_bf16 v[204:207], v[68:71], v[136:139], v[204:207]
    ds_read2_b32 v[110:111], v37 offset0:146 offset1:147
    v_mfma_f32_16x16x32_bf16 v[208:211], v[68:71], v[140:143], v[208:211]
    v_mfma_f32_16x16x32_bf16 v[212:215], v[68:71], v[144:147], v[212:215]
    ds_read_b128 v[176:179], v40 offset:53312
    v_mfma_f32_16x16x32_bf16 v[216:219], v[68:71], v[148:151], v[216:219]
    ds_read2_b32 v[112:113], v38 offset0:16 offset1:17
    v_mfma_f32_16x16x32_bf16 v[220:223], v[68:71], v[152:155], v[220:223]
    v_mfma_f32_16x16x32_bf16 v[200:203], v[72:75], v[128:131], v[200:203]
    ds_read2_b32 v[114:115], v38 offset0:18 offset1:19
    v_mfma_f32_16x16x32_bf16 v[204:207], v[72:75], v[132:135], v[204:207]
    v_mfma_f32_16x16x32_bf16 v[208:211], v[72:75], v[136:139], v[208:211]
    ds_read_b128 v[180:183], v40 offset:52800
    v_mfma_f32_16x16x32_bf16 v[212:215], v[72:75], v[140:143], v[212:215]
    ds_read2_b32 v[116:117], v38 offset0:144 offset1:145
    v_mfma_f32_16x16x32_bf16 v[216:219], v[72:75], v[144:147], v[216:219]
    v_mfma_f32_16x16x32_bf16 v[220:223], v[72:75], v[148:151], v[220:223]
    ds_read2_b32 v[118:119], v38 offset0:146 offset1:147
    v_mfma_f32_16x16x32_bf16 v[204:207], v[76:79], v[128:131], v[204:207]
    v_mfma_f32_16x16x32_bf16 v[208:211], v[76:79], v[132:135], v[208:211]
    ds_read_b128 v[184:187], v40 offset:52288
    v_mfma_f32_16x16x32_bf16 v[212:215], v[76:79], v[136:139], v[212:215]
    ds_read2_b32 v[120:121], v39 offset0:16 offset1:17
    v_mfma_f32_16x16x32_bf16 v[216:219], v[76:79], v[140:143], v[216:219]
    v_mfma_f32_16x16x32_bf16 v[220:223], v[76:79], v[144:147], v[220:223]
    ds_read2_b32 v[122:123], v39 offset0:18 offset1:19
    v_mfma_f32_16x16x32_bf16 v[208:211], v[80:83], v[128:131], v[208:211]
    v_mfma_f32_16x16x32_bf16 v[212:215], v[80:83], v[132:135], v[212:215]
    ds_read_b128 v[188:191], v40 offset:51776
    v_mfma_f32_16x16x32_bf16 v[216:219], v[80:83], v[136:139], v[216:219]
    ds_read2_b32 v[124:125], v39 offset0:144 offset1:145
    v_mfma_f32_16x16x32_bf16 v[220:223], v[80:83], v[140:143], v[220:223]
    v_mfma_f32_16x16x32_bf16 v[212:215], v[84:87], v[128:131], v[212:215]
    ds_read2_b32 v[126:127], v39 offset0:146 offset1:147
    v_mfma_f32_16x16x32_bf16 v[216:219], v[84:87], v[132:135], v[216:219]
    v_mfma_f32_16x16x32_bf16 v[220:223], v[84:87], v[136:139], v[220:223]
    v_mfma_f32_16x16x32_bf16 v[216:219], v[88:91], v[128:131], v[216:219]
    v_mfma_f32_16x16x32_bf16 v[220:223], v[88:91], v[132:135], v[220:223]
    v_mfma_f32_16x16x32_bf16 v[220:223], v[92:95], v[128:131], v[220:223]
    s_waitcnt lgkmcnt(0)
    v_mfma_f32_16x16x32_bf16 v[192:195], v[96:99], v[160:163], v[192:195]
    ds_read_b128 v[128:131], v40 offset:55424
    v_mfma_f32_16x16x32_bf16 v[196:199], v[96:99], v[164:167], v[196:199]
    ds_read2_b32 v[64:65], v36 offset0:32 offset1:33
    v_mfma_f32_16x16x32_bf16 v[200:203], v[96:99], v[168:171], v[200:203]
    ds_read2_b32 v[66:67], v36 offset0:34 offset1:35
    v_mfma_f32_16x16x32_bf16 v[204:207], v[96:99], v[172:175], v[204:207]
    v_mfma_f32_16x16x32_bf16 v[208:211], v[96:99], v[176:179], v[208:211]
    ds_read_b128 v[132:135], v40 offset:54912
    v_mfma_f32_16x16x32_bf16 v[212:215], v[96:99], v[180:183], v[212:215]
    ds_read2_b32 v[68:69], v36 offset0:160 offset1:161
    v_mfma_f32_16x16x32_bf16 v[216:219], v[96:99], v[184:187], v[216:219]
    ds_read2_b32 v[70:71], v36 offset0:162 offset1:163
    v_mfma_f32_16x16x32_bf16 v[220:223], v[96:99], v[188:191], v[220:223]
    v_mfma_f32_16x16x32_bf16 v[196:199], v[100:103], v[160:163], v[196:199]
    ds_read_b128 v[136:139], v40 offset:54400
    v_mfma_f32_16x16x32_bf16 v[200:203], v[100:103], v[164:167], v[200:203]
    ds_read2_b32 v[72:73], v37 offset0:32 offset1:33
    v_mfma_f32_16x16x32_bf16 v[204:207], v[100:103], v[168:171], v[204:207]
    ds_read2_b32 v[74:75], v37 offset0:34 offset1:35
    v_mfma_f32_16x16x32_bf16 v[208:211], v[100:103], v[172:175], v[208:211]
    v_mfma_f32_16x16x32_bf16 v[212:215], v[100:103], v[176:179], v[212:215]
    ds_read_b128 v[140:143], v40 offset:53888
    v_mfma_f32_16x16x32_bf16 v[216:219], v[100:103], v[180:183], v[216:219]
    ds_read2_b32 v[76:77], v37 offset0:160 offset1:161
    v_mfma_f32_16x16x32_bf16 v[220:223], v[100:103], v[184:187], v[220:223]
    ds_read2_b32 v[78:79], v37 offset0:162 offset1:163
    v_mfma_f32_16x16x32_bf16 v[200:203], v[104:107], v[160:163], v[200:203]
    v_mfma_f32_16x16x32_bf16 v[204:207], v[104:107], v[164:167], v[204:207]
    ds_read_b128 v[144:147], v40 offset:53376
    v_mfma_f32_16x16x32_bf16 v[208:211], v[104:107], v[168:171], v[208:211]
    ds_read2_b32 v[80:81], v38 offset0:32 offset1:33
    v_mfma_f32_16x16x32_bf16 v[212:215], v[104:107], v[172:175], v[212:215]
    ds_read2_b32 v[82:83], v38 offset0:34 offset1:35
    v_mfma_f32_16x16x32_bf16 v[216:219], v[104:107], v[176:179], v[216:219]
    v_mfma_f32_16x16x32_bf16 v[220:223], v[104:107], v[180:183], v[220:223]
    ds_read_b128 v[148:151], v40 offset:52864
    v_mfma_f32_16x16x32_bf16 v[204:207], v[108:111], v[160:163], v[204:207]
    ds_read2_b32 v[84:85], v38 offset0:160 offset1:161
    v_mfma_f32_16x16x32_bf16 v[208:211], v[108:111], v[164:167], v[208:211]
    ds_read2_b32 v[86:87], v38 offset0:162 offset1:163
    v_mfma_f32_16x16x32_bf16 v[212:215], v[108:111], v[168:171], v[212:215]
    v_mfma_f32_16x16x32_bf16 v[216:219], v[108:111], v[172:175], v[216:219]
    ds_read_b128 v[152:155], v40 offset:52352
    v_mfma_f32_16x16x32_bf16 v[220:223], v[108:111], v[176:179], v[220:223]
    ds_read2_b32 v[88:89], v39 offset0:32 offset1:33
    v_mfma_f32_16x16x32_bf16 v[208:211], v[112:115], v[160:163], v[208:211]
    ds_read2_b32 v[90:91], v39 offset0:34 offset1:35
    v_mfma_f32_16x16x32_bf16 v[212:215], v[112:115], v[164:167], v[212:215]
    v_mfma_f32_16x16x32_bf16 v[216:219], v[112:115], v[168:171], v[216:219]
    ds_read_b128 v[156:159], v40 offset:51840
    v_mfma_f32_16x16x32_bf16 v[220:223], v[112:115], v[172:175], v[220:223]
    ds_read2_b32 v[92:93], v39 offset0:160 offset1:161
    v_mfma_f32_16x16x32_bf16 v[212:215], v[116:119], v[160:163], v[212:215]
    ds_read2_b32 v[94:95], v39 offset0:162 offset1:163
    v_mfma_f32_16x16x32_bf16 v[216:219], v[116:119], v[164:167], v[216:219]
    v_mfma_f32_16x16x32_bf16 v[220:223], v[116:119], v[168:171], v[220:223]
    v_mfma_f32_16x16x32_bf16 v[216:219], v[120:123], v[160:163], v[216:219]
    v_mfma_f32_16x16x32_bf16 v[220:223], v[120:123], v[164:167], v[220:223]
    v_mfma_f32_16x16x32_bf16 v[220:223], v[124:127], v[160:163], v[220:223]
    s_waitcnt lgkmcnt(0)
    v_mfma_f32_16x16x32_bf16 v[192:195], v[64:67], v[128:131], v[192:195]
    ds_read_b128 v[160:163], v40 offset:55488
    v_mfma_f32_16x16x32_bf16 v[196:199], v[64:67], v[132:135], v[196:199]
    ds_read2_b32 v[96:97], v36 offset0:48 offset1:49
    s_branch L_pgcs2
.p2align 12
L_pgc2:
    s_branch L_pgcret
L_pgcs2:
    v_mfma_f32_16x16x32_bf16 v[200:203], v[64:67], v[136:139], v[200:203]
    ds_read2_b32 v[98:99], v36 offset0:50 offset1:51
    v_mfma_f32_16x16x32_bf16 v[204:207], v[64:67], v[140:143], v[204:207]
    v_mfma_f32_16x16x32_bf16 v[208:211], v[64:67], v[144:147], v[208:211]
    ds_read_b128 v[164:167], v40 offset:54976
    v_mfma_f32_16x16x32_bf16 v[212:215], v[64:67], v[148:151], v[212:215]
    ds_read2_b32 v[100:101], v36 offset0:176 offset1:177
    v_mfma_f32_16x16x32_bf16 v[216:219], v[64:67], v[152:155], v[216:219]
    ds_read2_b32 v[102:103], v36 offset0:178 offset1:179
    v_mfma_f32_16x16x32_bf16 v[220:223], v[64:67], v[156:159], v[220:223]
    v_mfma_f32_16x16x32_bf16 v[196:199], v[68:71], v[128:131], v[196:199]
    ds_read_b128 v[168:171], v40 offset:54464
    v_mfma_f32_16x16x32_bf16 v[200:203], v[68:71], v[132:135], v[200:203]
    ds_read2_b32 v[104:105], v37 offset0:48 offset1:49
    v_mfma_f32_16x16x32_bf16 v[204:207], v[68:71], v[136:139], v[204:207]
    ds_read2_b32 v[106:107], v37 offset0:50 offset1:51
    v_mfma_f32_16x16x32_bf16 v[208:211], v[68:71], v[140:143], v[208:211]
    v_mfma_f32_16x16x32_bf16 v[212:215], v[68:71], v[144:147], v[212:215]
    ds_read_b128 v[172:175], v40 offset:53952
    v_mfma_f32_16x16x32_bf16 v[216:219], v[68:71], v[148:151], v[216:219]
    ds_read2_b32 v[108:109], v37 offset0:176 offset1:177
    v_mfma_f32_16x16x32_bf16 v[220:223], v[68:71], v[152:155], v[220:223]
    ds_read2_b32 v[110:111], v37 offset0:178 offset1:179
    v_mfma_f32_16x16x32_bf16 v[200:203], v[72:75], v[128:131], v[200:203]
    v_mfma_f32_16x16x32_bf16 v[204:207], v[72:75], v[132:135], v[204:207]
    ds_read_b128 v[176:179], v40 offset:53440
    v_mfma_f32_16x16x32_bf16 v[208:211], v[72:75], v[136:139], v[208:211]
    ds_read2_b32 v[112:113], v38 offset0:48 offset1:49
    v_mfma_f32_16x16x32_bf16 v[212:215], v[72:75], v[140:143], v[212:215]
    ds_read2_b32 v[114:115], v38 offset0:50 offset1:51
    v_mfma_f32_16x16x32_bf16 v[216:219], v[72:75], v[144:147], v[216:219]
    v_mfma_f32_16x16x32_bf16 v[220:223], v[72:75], v[148:151], v[220:223]
    ds_read_b128 v[180:183], v40 offset:52928
    v_mfma_f32_16x16x32_bf16 v[204:207], v[76:79], v[128:131], v[204:207]
    ds_read2_b32 v[116:117], v38 offset0:176 offset1:177
    v_mfma_f32_16x16x32_bf16 v[208:211], v[76:79], v[132:135], v[208:211]
    ds_read2_b32 v[118:119], v38 offset0:178 offset1:179
    v_mfma_f32_16x16x32_bf16 v[212:215], v[76:79], v[136:139], v[212:215]
    v_mfma_f32_16x16x32_bf16 v[216:219], v[76:79], v[140:143], v[216:219]
    ds_read_b128 v[184:187], v40 offset:52416
    v_mfma_f32_16x16x32_bf16 v[220:223], v[76:79], v[144:147], v[220:223]
    ds_read2_b32 v[120:121], v39 offset0:48 offset1:49
    v_mfma_f32_16x16x32_bf16 v[208:211], v[80:83], v[128:131], v[208:211]
    ds_read2_b32 v[122:123], v39 offset0:50 offset1:51
    v_mfma_f32_16x16x32_bf16 v[212:215], v[80:83], v[132:135], v[212:215]
    v_mfma_f32_16x16x32_bf16 v[216:219], v[80:83], v[136:139], v[216:219]
    ds_read_b128 v[188:191], v40 offset:51904
    v_mfma_f32_16x16x32_bf16 v[220:223], v[80:83], v[140:143], v[220:223]
    ds_read2_b32 v[124:125], v39 offset0:176 offset1:177
    v_mfma_f32_16x16x32_bf16 v[212:215], v[84:87], v[128:131], v[212:215]
    ds_read2_b32 v[126:127], v39 offset0:178 offset1:179
    v_mfma_f32_16x16x32_bf16 v[216:219], v[84:87], v[132:135], v[216:219]
    v_mfma_f32_16x16x32_bf16 v[220:223], v[84:87], v[136:139], v[220:223]
    v_mfma_f32_16x16x32_bf16 v[216:219], v[88:91], v[128:131], v[216:219]
    v_mfma_f32_16x16x32_bf16 v[220:223], v[88:91], v[132:135], v[220:223]
    v_mfma_f32_16x16x32_bf16 v[220:223], v[92:95], v[128:131], v[220:223]
    s_waitcnt lgkmcnt(0)
    v_mfma_f32_16x16x32_bf16 v[192:195], v[96:99], v[160:163], v[192:195]
    ds_read_b128 v[128:131], v40 offset:55552
    v_mfma_f32_16x16x32_bf16 v[196:199], v[96:99], v[164:167], v[196:199]
    ds_read2_b32 v[64:65], v36 offset0:64 offset1:65
    v_mfma_f32_16x16x32_bf16 v[200:203], v[96:99], v[168:171], v[200:203]
    ds_read2_b32 v[66:67], v36 offset0:66 offset1:67
    v_mfma_f32_16x16x32_bf16 v[204:207], v[96:99], v[172:175], v[204:207]
    v_mfma_f32_16x16x32_bf16 v[208:211], v[96:99], v[176:179], v[208:211]
    ds_read_b128 v[132:135], v40 offset:55040
    v_mfma_f32_16x16x32_bf16 v[212:215], v[96:99], v[180:183], v[212:215]
    ds_read2_b32 v[68:69], v36 offset0:192 offset1:193
    v_mfma_f32_16x16x32_bf16 v[216:219], v[96:99], v[184:187], v[216:219]
    ds_read2_b32 v[70:71], v36 offset0:194 offset1:195
    v_mfma_f32_16x16x32_bf16 v[220:223], v[96:99], v[188:191], v[220:223]
    v_mfma_f32_16x16x32_bf16 v[196:199], v[100:103], v[160:163], v[196:199]
    ds_read_b128 v[136:139], v40 offset:54528
    v_mfma_f32_16x16x32_bf16 v[200:203], v[100:103], v[164:167], v[200:203]
    ds_read2_b32 v[72:73], v37 offset0:64 offset1:65
    v_mfma_f32_16x16x32_bf16 v[204:207], v[100:103], v[168:171], v[204:207]
    ds_read2_b32 v[74:75], v37 offset0:66 offset1:67
    v_mfma_f32_16x16x32_bf16 v[208:211], v[100:103], v[172:175], v[208:211]
    v_mfma_f32_16x16x32_bf16 v[212:215], v[100:103], v[176:179], v[212:215]
    ds_read_b128 v[140:143], v40 offset:54016
    v_mfma_f32_16x16x32_bf16 v[216:219], v[100:103], v[180:183], v[216:219]
    ds_read2_b32 v[76:77], v37 offset0:192 offset1:193
    v_mfma_f32_16x16x32_bf16 v[220:223], v[100:103], v[184:187], v[220:223]
    ds_read2_b32 v[78:79], v37 offset0:194 offset1:195
    v_mfma_f32_16x16x32_bf16 v[200:203], v[104:107], v[160:163], v[200:203]
    v_mfma_f32_16x16x32_bf16 v[204:207], v[104:107], v[164:167], v[204:207]
    ds_read_b128 v[144:147], v40 offset:53504
    v_mfma_f32_16x16x32_bf16 v[208:211], v[104:107], v[168:171], v[208:211]
    ds_read2_b32 v[80:81], v38 offset0:64 offset1:65
    v_mfma_f32_16x16x32_bf16 v[212:215], v[104:107], v[172:175], v[212:215]
    ds_read2_b32 v[82:83], v38 offset0:66 offset1:67
    v_mfma_f32_16x16x32_bf16 v[216:219], v[104:107], v[176:179], v[216:219]
    v_mfma_f32_16x16x32_bf16 v[220:223], v[104:107], v[180:183], v[220:223]
    ds_read_b128 v[148:151], v40 offset:52992
    v_mfma_f32_16x16x32_bf16 v[204:207], v[108:111], v[160:163], v[204:207]
    ds_read2_b32 v[84:85], v38 offset0:192 offset1:193
    v_mfma_f32_16x16x32_bf16 v[208:211], v[108:111], v[164:167], v[208:211]
    ds_read2_b32 v[86:87], v38 offset0:194 offset1:195
    v_mfma_f32_16x16x32_bf16 v[212:215], v[108:111], v[168:171], v[212:215]
    v_mfma_f32_16x16x32_bf16 v[216:219], v[108:111], v[172:175], v[216:219]
    ds_read_b128 v[152:155], v40 offset:52480
    v_mfma_f32_16x16x32_bf16 v[220:223], v[108:111], v[176:179], v[220:223]
    ds_read2_b32 v[88:89], v39 offset0:64 offset1:65
    v_mfma_f32_16x16x32_bf16 v[208:211], v[112:115], v[160:163], v[208:211]
    ds_read2_b32 v[90:91], v39 offset0:66 offset1:67
    v_mfma_f32_16x16x32_bf16 v[212:215], v[112:115], v[164:167], v[212:215]
    v_mfma_f32_16x16x32_bf16 v[216:219], v[112:115], v[168:171], v[216:219]
    ds_read_b128 v[156:159], v40 offset:51968
    v_mfma_f32_16x16x32_bf16 v[220:223], v[112:115], v[172:175], v[220:223]
    ds_read2_b32 v[92:93], v39 offset0:192 offset1:193
    v_mfma_f32_16x16x32_bf16 v[212:215], v[116:119], v[160:163], v[212:215]
    ds_read2_b32 v[94:95], v39 offset0:194 offset1:195
    v_mfma_f32_16x16x32_bf16 v[216:219], v[116:119], v[164:167], v[216:219]
    v_mfma_f32_16x16x32_bf16 v[220:223], v[116:119], v[168:171], v[220:223]
    v_mfma_f32_16x16x32_bf16 v[216:219], v[120:123], v[160:163], v[216:219]
    v_mfma_f32_16x16x32_bf16 v[220:223], v[120:123], v[164:167], v[220:223]
    v_mfma_f32_16x16x32_bf16 v[220:223], v[124:127], v[160:163], v[220:223]
    s_waitcnt lgkmcnt(0)
    v_mfma_f32_16x16x32_bf16 v[192:195], v[64:67], v[128:131], v[192:195]
    ds_read_b128 v[160:163], v40 offset:55616
    v_mfma_f32_16x16x32_bf16 v[196:199], v[64:67], v[132:135], v[196:199]
    ds_read2_b32 v[96:97], v36 offset0:80 offset1:81
    v_mfma_f32_16x16x32_bf16 v[200:203], v[64:67], v[136:139], v[200:203]
    ds_read2_b32 v[98:99], v36 offset0:82 offset1:83
    v_mfma_f32_16x16x32_bf16 v[204:207], v[64:67], v[140:143], v[204:207]
    v_mfma_f32_16x16x32_bf16 v[208:211], v[64:67], v[144:147], v[208:211]
    ds_read_b128 v[164:167], v40 offset:55104
    v_mfma_f32_16x16x32_bf16 v[212:215], v[64:67], v[148:151], v[212:215]
    ds_read2_b32 v[100:101], v36 offset0:208 offset1:209
    v_mfma_f32_16x16x32_bf16 v[216:219], v[64:67], v[152:155], v[216:219]
    ds_read2_b32 v[102:103], v36 offset0:210 offset1:211
    v_mfma_f32_16x16x32_bf16 v[220:223], v[64:67], v[156:159], v[220:223]
    v_mfma_f32_16x16x32_bf16 v[196:199], v[68:71], v[128:131], v[196:199]
    ds_read_b128 v[168:171], v40 offset:54592
    v_mfma_f32_16x16x32_bf16 v[200:203], v[68:71], v[132:135], v[200:203]
    ds_read2_b32 v[104:105], v37 offset0:80 offset1:81
    v_mfma_f32_16x16x32_bf16 v[204:207], v[68:71], v[136:139], v[204:207]
    ds_read2_b32 v[106:107], v37 offset0:82 offset1:83
    v_mfma_f32_16x16x32_bf16 v[208:211], v[68:71], v[140:143], v[208:211]
    v_mfma_f32_16x16x32_bf16 v[212:215], v[68:71], v[144:147], v[212:215]
    ds_read_b128 v[172:175], v40 offset:54080
    v_mfma_f32_16x16x32_bf16 v[216:219], v[68:71], v[148:151], v[216:219]
    ds_read2_b32 v[108:109], v37 offset0:208 offset1:209
    v_mfma_f32_16x16x32_bf16 v[220:223], v[68:71], v[152:155], v[220:223]
    ds_read2_b32 v[110:111], v37 offset0:210 offset1:211
    v_mfma_f32_16x16x32_bf16 v[200:203], v[72:75], v[128:131], v[200:203]
    v_mfma_f32_16x16x32_bf16 v[204:207], v[72:75], v[132:135], v[204:207]
    ds_read_b128 v[176:179], v40 offset:53568
    v_mfma_f32_16x16x32_bf16 v[208:211], v[72:75], v[136:139], v[208:211]
    ds_read2_b32 v[112:113], v38 offset0:80 offset1:81
    v_mfma_f32_16x16x32_bf16 v[212:215], v[72:75], v[140:143], v[212:215]
    ds_read2_b32 v[114:115], v38 offset0:82 offset1:83
    v_mfma_f32_16x16x32_bf16 v[216:219], v[72:75], v[144:147], v[216:219]
    v_mfma_f32_16x16x32_bf16 v[220:223], v[72:75], v[148:151], v[220:223]
    ds_read_b128 v[180:183], v40 offset:53056
    v_mfma_f32_16x16x32_bf16 v[204:207], v[76:79], v[128:131], v[204:207]
    ds_read2_b32 v[116:117], v38 offset0:208 offset1:209
    v_mfma_f32_16x16x32_bf16 v[208:211], v[76:79], v[132:135], v[208:211]
    ds_read2_b32 v[118:119], v38 offset0:210 offset1:211
    v_mfma_f32_16x16x32_bf16 v[212:215], v[76:79], v[136:139], v[212:215]
    v_mfma_f32_16x16x32_bf16 v[216:219], v[76:79], v[140:143], v[216:219]
    ds_read_b128 v[184:187], v40 offset:52544
    v_mfma_f32_16x16x32_bf16 v[220:223], v[76:79], v[144:147], v[220:223]
    ds_read2_b32 v[120:121], v39 offset0:80 offset1:81
    v_mfma_f32_16x16x32_bf16 v[208:211], v[80:83], v[128:131], v[208:211]
    ds_read2_b32 v[122:123], v39 offset0:82 offset1:83
    v_mfma_f32_16x16x32_bf16 v[212:215], v[80:83], v[132:135], v[212:215]
    v_mfma_f32_16x16x32_bf16 v[216:219], v[80:83], v[136:139], v[216:219]
    ds_read_b128 v[188:191], v40 offset:52032
    v_mfma_f32_16x16x32_bf16 v[220:223], v[80:83], v[140:143], v[220:223]
    ds_read2_b32 v[124:125], v39 offset0:208 offset1:209
    v_mfma_f32_16x16x32_bf16 v[212:215], v[84:87], v[128:131], v[212:215]
    ds_read2_b32 v[126:127], v39 offset0:210 offset1:211
    v_mfma_f32_16x16x32_bf16 v[216:219], v[84:87], v[132:135], v[216:219]
    v_mfma_f32_16x16x32_bf16 v[220:223], v[84:87], v[136:139], v[220:223]
    v_mfma_f32_16x16x32_bf16 v[216:219], v[88:91], v[128:131], v[216:219]
    v_mfma_f32_16x16x32_bf16 v[220:223], v[88:91], v[132:135], v[220:223]
    v_mfma_f32_16x16x32_bf16 v[220:223], v[92:95], v[128:131], v[220:223]
    s_waitcnt lgkmcnt(0)
    v_mfma_f32_16x16x32_bf16 v[192:195], v[96:99], v[160:163], v[192:195]
    ds_read_b128 v[128:131], v40 offset:55680
    v_mfma_f32_16x16x32_bf16 v[196:199], v[96:99], v[164:167], v[196:199]
    ds_read2_b32 v[64:65], v36 offset0:96 offset1:97
    v_mfma_f32_16x16x32_bf16 v[200:203], v[96:99], v[168:171], v[200:203]
    ds_read2_b32 v[66:67], v36 offset0:98 offset1:99
    v_mfma_f32_16x16x32_bf16 v[204:207], v[96:99], v[172:175], v[204:207]
    v_mfma_f32_16x16x32_bf16 v[208:211], v[96:99], v[176:179], v[208:211]
    ds_read_b128 v[132:135], v40 offset:55168
    v_mfma_f32_16x16x32_bf16 v[212:215], v[96:99], v[180:183], v[212:215]
    ds_read2_b32 v[68:69], v36 offset0:224 offset1:225
    v_mfma_f32_16x16x32_bf16 v[216:219], v[96:99], v[184:187], v[216:219]
    ds_read2_b32 v[70:71], v36 offset0:226 offset1:227
    v_mfma_f32_16x16x32_bf16 v[220:223], v[96:99], v[188:191], v[220:223]
    v_mfma_f32_16x16x32_bf16 v[196:199], v[100:103], v[160:163], v[196:199]
    ds_read_b128 v[136:139], v40 offset:54656
    v_mfma_f32_16x16x32_bf16 v[200:203], v[100:103], v[164:167], v[200:203]
    ds_read2_b32 v[72:73], v37 offset0:96 offset1:97
    v_mfma_f32_16x16x32_bf16 v[204:207], v[100:103], v[168:171], v[204:207]
    ds_read2_b32 v[74:75], v37 offset0:98 offset1:99
    v_mfma_f32_16x16x32_bf16 v[208:211], v[100:103], v[172:175], v[208:211]
    v_mfma_f32_16x16x32_bf16 v[212:215], v[100:103], v[176:179], v[212:215]
    ds_read_b128 v[140:143], v40 offset:54144
    v_mfma_f32_16x16x32_bf16 v[216:219], v[100:103], v[180:183], v[216:219]
    ds_read2_b32 v[76:77], v37 offset0:224 offset1:225
    v_mfma_f32_16x16x32_bf16 v[220:223], v[100:103], v[184:187], v[220:223]
    ds_read2_b32 v[78:79], v37 offset0:226 offset1:227
    v_mfma_f32_16x16x32_bf16 v[200:203], v[104:107], v[160:163], v[200:203]
    v_mfma_f32_16x16x32_bf16 v[204:207], v[104:107], v[164:167], v[204:207]
    ds_read_b128 v[144:147], v40 offset:53632
    v_mfma_f32_16x16x32_bf16 v[208:211], v[104:107], v[168:171], v[208:211]
    ds_read2_b32 v[80:81], v38 offset0:96 offset1:97
    v_mfma_f32_16x16x32_bf16 v[212:215], v[104:107], v[172:175], v[212:215]
    ds_read2_b32 v[82:83], v38 offset0:98 offset1:99
    v_mfma_f32_16x16x32_bf16 v[216:219], v[104:107], v[176:179], v[216:219]
    v_mfma_f32_16x16x32_bf16 v[220:223], v[104:107], v[180:183], v[220:223]
    ds_read_b128 v[148:151], v40 offset:53120
    v_mfma_f32_16x16x32_bf16 v[204:207], v[108:111], v[160:163], v[204:207]
    ds_read2_b32 v[84:85], v38 offset0:224 offset1:225
    v_mfma_f32_16x16x32_bf16 v[208:211], v[108:111], v[164:167], v[208:211]
    ds_read2_b32 v[86:87], v38 offset0:226 offset1:227
    v_mfma_f32_16x16x32_bf16 v[212:215], v[108:111], v[168:171], v[212:215]
    v_mfma_f32_16x16x32_bf16 v[216:219], v[108:111], v[172:175], v[216:219]
    ds_read_b128 v[152:155], v40 offset:52608
    v_mfma_f32_16x16x32_bf16 v[220:223], v[108:111], v[176:179], v[220:223]
    ds_read2_b32 v[88:89], v39 offset0:96 offset1:97
    v_mfma_f32_16x16x32_bf16 v[208:211], v[112:115], v[160:163], v[208:211]
    ds_read2_b32 v[90:91], v39 offset0:98 offset1:99
    v_mfma_f32_16x16x32_bf16 v[212:215], v[112:115], v[164:167], v[212:215]
    v_mfma_f32_16x16x32_bf16 v[216:219], v[112:115], v[168:171], v[216:219]
    ds_read_b128 v[156:159], v40 offset:52096
    v_mfma_f32_16x16x32_bf16 v[220:223], v[112:115], v[172:175], v[220:223]
    ds_read2_b32 v[92:93], v39 offset0:224 offset1:225
    v_mfma_f32_16x16x32_bf16 v[212:215], v[116:119], v[160:163], v[212:215]
    ds_read2_b32 v[94:95], v39 offset0:226 offset1:227
    v_mfma_f32_16x16x32_bf16 v[216:219], v[116:119], v[164:167], v[216:219]
    v_mfma_f32_16x16x32_bf16 v[220:223], v[116:119], v[168:171], v[220:223]
    v_mfma_f32_16x16x32_bf16 v[216:219], v[120:123], v[160:163], v[216:219]
    v_mfma_f32_16x16x32_bf16 v[220:223], v[120:123], v[164:167], v[220:223]
    v_mfma_f32_16x16x32_bf16 v[220:223], v[124:127], v[160:163], v[220:223]
    s_waitcnt lgkmcnt(0)
    v_mfma_f32_16x16x32_bf16 v[192:195], v[64:67], v[128:131], v[192:195]
    ds_read_b128 v[160:163], v40 offset:55744
    v_mfma_f32_16x16x32_bf16 v[196:199], v[64:67], v[132:135], v[196:199]
    ds_read2_b32 v[96:97], v36 offset0:112 offset1:113
    v_mfma_f32_16x16x32_bf16 v[200:203], v[64:67], v[136:139], v[200:203]
    ds_read2_b32 v[98:99], v36 offset0:114 offset1:115
    v_mfma_f32_16x16x32_bf16 v[204:207], v[64:67], v[140:143], v[204:207]
    v_mfma_f32_16x16x32_bf16 v[208:211], v[64:67], v[144:147], v[208:211]
    ds_read_b128 v[164:167], v40 offset:55232
    v_mfma_f32_16x16x32_bf16 v[212:215], v[64:67], v[148:151], v[212:215]
    ds_read2_b32 v[100:101], v36 offset0:240 offset1:241
    v_mfma_f32_16x16x32_bf16 v[216:219], v[64:67], v[152:155], v[216:219]
    ds_read2_b32 v[102:103], v36 offset0:242 offset1:243
    v_mfma_f32_16x16x32_bf16 v[220:223], v[64:67], v[156:159], v[220:223]
    v_mfma_f32_16x16x32_bf16 v[196:199], v[68:71], v[128:131], v[196:199]
    ds_read_b128 v[168:171], v40 offset:54720
    v_mfma_f32_16x16x32_bf16 v[200:203], v[68:71], v[132:135], v[200:203]
    ds_read2_b32 v[104:105], v37 offset0:112 offset1:113
    v_mfma_f32_16x16x32_bf16 v[204:207], v[68:71], v[136:139], v[204:207]
    ds_read2_b32 v[106:107], v37 offset0:114 offset1:115
    v_mfma_f32_16x16x32_bf16 v[208:211], v[68:71], v[140:143], v[208:211]
    v_mfma_f32_16x16x32_bf16 v[212:215], v[68:71], v[144:147], v[212:215]
    ds_read_b128 v[172:175], v40 offset:54208
    v_mfma_f32_16x16x32_bf16 v[216:219], v[68:71], v[148:151], v[216:219]
    ds_read2_b32 v[108:109], v37 offset0:240 offset1:241
    v_mfma_f32_16x16x32_bf16 v[220:223], v[68:71], v[152:155], v[220:223]
    ds_read2_b32 v[110:111], v37 offset0:242 offset1:243
    v_mfma_f32_16x16x32_bf16 v[200:203], v[72:75], v[128:131], v[200:203]
    v_mfma_f32_16x16x32_bf16 v[204:207], v[72:75], v[132:135], v[204:207]
    ds_read_b128 v[176:179], v40 offset:53696
    v_mfma_f32_16x16x32_bf16 v[208:211], v[72:75], v[136:139], v[208:211]
    ds_read2_b32 v[112:113], v38 offset0:112 offset1:113
    v_mfma_f32_16x16x32_bf16 v[212:215], v[72:75], v[140:143], v[212:215]
    ds_read2_b32 v[114:115], v38 offset0:114 offset1:115
    v_mfma_f32_16x16x32_bf16 v[216:219], v[72:75], v[144:147], v[216:219]
    v_mfma_f32_16x16x32_bf16 v[220:223], v[72:75], v[148:151], v[220:223]
    ds_read_b128 v[180:183], v40 offset:53184
    v_mfma_f32_16x16x32_bf16 v[204:207], v[76:79], v[128:131], v[204:207]
    ds_read2_b32 v[116:117], v38 offset0:240 offset1:241
    v_mfma_f32_16x16x32_bf16 v[208:211], v[76:79], v[132:135], v[208:211]
    ds_read2_b32 v[118:119], v38 offset0:242 offset1:243
    v_mfma_f32_16x16x32_bf16 v[212:215], v[76:79], v[136:139], v[212:215]
    v_mfma_f32_16x16x32_bf16 v[216:219], v[76:79], v[140:143], v[216:219]
    ds_read_b128 v[184:187], v40 offset:52672
    v_mfma_f32_16x16x32_bf16 v[220:223], v[76:79], v[144:147], v[220:223]
    ds_read2_b32 v[120:121], v39 offset0:112 offset1:113
    v_mfma_f32_16x16x32_bf16 v[208:211], v[80:83], v[128:131], v[208:211]
    ds_read2_b32 v[122:123], v39 offset0:114 offset1:115
    v_mfma_f32_16x16x32_bf16 v[212:215], v[80:83], v[132:135], v[212:215]
    v_mfma_f32_16x16x32_bf16 v[216:219], v[80:83], v[136:139], v[216:219]
    ds_read_b128 v[188:191], v40 offset:52160
    v_mfma_f32_16x16x32_bf16 v[220:223], v[80:83], v[140:143], v[220:223]
    ds_read2_b32 v[124:125], v39 offset0:240 offset1:241
    v_mfma_f32_16x16x32_bf16 v[212:215], v[84:87], v[128:131], v[212:215]
    ds_read2_b32 v[126:127], v39 offset0:242 offset1:243
    v_mfma_f32_16x16x32_bf16 v[216:219], v[84:87], v[132:135], v[216:219]
    v_mfma_f32_16x16x32_bf16 v[220:223], v[84:87], v[136:139], v[220:223]
    v_mfma_f32_16x16x32_bf16 v[216:219], v[88:91], v[128:131], v[216:219]
    v_mfma_f32_16x16x32_bf16 v[220:223], v[88:91], v[132:135], v[220:223]
    v_mfma_f32_16x16x32_bf16 v[220:223], v[92:95], v[128:131], v[220:223]
    s_waitcnt lgkmcnt(0)
    v_mfma_f32_16x16x32_bf16 v[192:195], v[96:99], v[160:163], v[192:195]
    v_mfma_f32_16x16x32_bf16 v[196:199], v[96:99], v[164:167], v[196:199]
    v_mfma_f32_16x16x32_bf16 v[200:203], v[96:99], v[168:171], v[200:203]
    v_mfma_f32_16x16x32_bf16 v[204:207], v[96:99], v[172:175], v[204:207]
    v_mfma_f32_16x16x32_bf16 v[208:211], v[96:99], v[176:179], v[208:211]
    v_mfma_f32_16x16x32_bf16 v[212:215], v[96:99], v[180:183], v[212:215]
    v_mfma_f32_16x16x32_bf16 v[216:219], v[96:99], v[184:187], v[216:219]
    v_mfma_f32_16x16x32_bf16 v[220:223], v[96:99], v[188:191], v[220:223]
    v_mfma_f32_16x16x32_bf16 v[196:199], v[100:103], v[160:163], v[196:199]
    v_mfma_f32_16x16x32_bf16 v[200:203], v[100:103], v[164:167], v[200:203]
    v_mfma_f32_16x16x32_bf16 v[204:207], v[100:103], v[168:171], v[204:207]
    v_mfma_f32_16x16x32_bf16 v[208:211], v[100:103], v[172:175], v[208:211]
    v_mfma_f32_16x16x32_bf16 v[212:215], v[100:103], v[176:179], v[212:215]
    v_mfma_f32_16x16x32_bf16 v[216:219], v[100:103], v[180:183], v[216:219]
    v_mfma_f32_16x16x32_bf16 v[220:223], v[100:103], v[184:187], v[220:223]
    v_mfma_f32_16x16x32_bf16 v[200:203], v[104:107], v[160:163], v[200:203]
    v_mfma_f32_16x16x32_bf16 v[204:207], v[104:107], v[164:167], v[204:207]
    v_mfma_f32_16x16x32_bf16 v[208:211], v[104:107], v[168:171], v[208:211]
    v_mfma_f32_16x16x32_bf16 v[212:215], v[104:107], v[172:175], v[212:215]
    v_mfma_f32_16x16x32_bf16 v[216:219], v[104:107], v[176:179], v[216:219]
    v_mfma_f32_16x16x32_bf16 v[220:223], v[104:107], v[180:183], v[220:223]
    v_mfma_f32_16x16x32_bf16 v[204:207], v[108:111], v[160:163], v[204:207]
    v_mfma_f32_16x16x32_bf16 v[208:211], v[108:111], v[164:167], v[208:211]
    v_mfma_f32_16x16x32_bf16 v[212:215], v[108:111], v[168:171], v[212:215]
    v_mfma_f32_16x16x32_bf16 v[216:219], v[108:111], v[172:175], v[216:219]
    v_mfma_f32_16x16x32_bf16 v[220:223], v[108:111], v[176:179], v[220:223]
    v_mfma_f32_16x16x32_bf16 v[208:211], v[112:115], v[160:163], v[208:211]
    v_mfma_f32_16x16x32_bf16 v[212:215], v[112:115], v[164:167], v[212:215]
    v_mfma_f32_16x16x32_bf16 v[216:219], v[112:115], v[168:171], v[216:219]
    v_mfma_f32_16x16x32_bf16 v[220:223], v[112:115], v[172:175], v[220:223]
    v_mfma_f32_16x16x32_bf16 v[212:215], v[116:119], v[160:163], v[212:215]
    v_mfma_f32_16x16x32_bf16 v[216:219], v[116:119], v[164:167], v[216:219]
    v_mfma_f32_16x16x32_bf16 v[220:223], v[116:119], v[168:171], v[220:223]
    v_mfma_f32_16x16x32_bf16 v[216:219], v[120:123], v[160:163], v[216:219]
    v_mfma_f32_16x16x32_bf16 v[220:223], v[120:123], v[164:167], v[220:223]
    v_mfma_f32_16x16x32_bf16 v[220:223], v[124:127], v[160:163], v[220:223]
    v_cvt_pk_bf16_f32 v224, v192, v193
    v_cvt_pk_bf16_f32 v225, v194, v195
    v_cvt_pk_bf16_f32 v226, v196, v197
    v_cvt_pk_bf16_f32 v227, v198, v199
    v_cvt_pk_bf16_f32 v228, v200, v201
    v_cvt_pk_bf16_f32 v229, v202, v203
    v_cvt_pk_bf16_f32 v230, v204, v205
    v_cvt_pk_bf16_f32 v231, v206, v207
    v_cvt_pk_bf16_f32 v232, v208, v209
    v_cvt_pk_bf16_f32 v233, v210, v211
    v_cvt_pk_bf16_f32 v234, v212, v213
    v_cvt_pk_bf16_f32 v235, v214, v215
    v_cvt_pk_bf16_f32 v236, v216, v217
    v_cvt_pk_bf16_f32 v237, v218, v219
    v_cvt_pk_bf16_f32 v238, v220, v221
    v_cvt_pk_bf16_f32 v239, v222, v223
    v_permlane16_swap_b32 v224, v226
    v_permlane16_swap_b32 v225, v227
    v_permlane16_swap_b32 v228, v230
    v_permlane16_swap_b32 v229, v231
    v_permlane16_swap_b32 v232, v234
    v_permlane16_swap_b32 v233, v235
    v_permlane16_swap_b32 v236, v238
    v_permlane16_swap_b32 v237, v239
    buffer_store_dwordx4 v[224:227], v17, s[40:43], 0 offen offset:0 sc1
    buffer_store_dwordx4 v[228:231], v17, s[40:43], 0 offen offset:1024 sc1
    buffer_store_dwordx4 v[232:235], v17, s[40:43], 0 offen offset:2048 sc1
    buffer_store_dwordx4 v[236:239], v17, s[40:43], 0 offen offset:3072 sc1
    s_waitcnt vmcnt(0)
    s_barrier
    s_cmp_lg_u32 s48, 0
    s_cbranch_scc1 L_nf39
    s_mov_b64 exec, 1
    buffer_store_dwordx4 v[240:243], v6, s[40:43], s100 offen offset:16 sc1
    s_mov_b64 exec, -1
L_nf39:
    s_cmp_lg_u32 s49, 0
    s_cbranch_scc1 L_notag40
    v_lshlrev_b32 v7, 7, v0
    s_mov_b32 s55, 0
L_spin41:
    buffer_load_dwordx4 v[12:15], v7, s[40:43], s100 offen offset:16 sc1
    s_waitcnt vmcnt(0)
    v_xor_b32 v12, s65, v12
    v_xor_b32 v13, s65, v13
    v_xor_b32 v14, s65, v14
    v_xor_b32 v15, s65, v15
    v_or_b32 v12, v12, v13
    v_or_b32 v12, v12, v14
    v_or_b32 v12, v12, v15
    v_cmp_lt_u32 vcc, 0, v12
    s_cbranch_vccz L_spun42
    s_sleep 6
    s_add_u32 s55, s55, 1
    s_cmp_lt_u32 s55, 1048576
    s_cbranch_scc1 L_spin41
L_spun42:
    s_barrier
    s_cmp_lg_u32 s48, 0
    s_cbranch_scc1 L_notag40
    s_mov_b32 s56, 2064384
    s_mov_b64 exec, 1
    buffer_store_dword v240, v3, s[40:43], s56 offen sc1
    s_mov_b64 exec, -1
L_notag40:
    s_endpgm
L_agent:
    s_nop 7
    v_lshlrev_b32 v61, 7, v1
    s_mul_i32 s58, s49, 28672
    buffer_load_dword v60, v61, s[44:47], s58 offen
    s_add_u32 s58, s58, 8192
    buffer_load_dword v60, v61, s[44:47], s58 offen
    s_add_u32 s58, s58, 8192
    buffer_load_dword v60, v61, s[44:47], s58 offen
    s_add_u32 s58, s58, 4096
    buffer_load_dword v60, v61, s[44:47], s58 offen
    s_add_u32 s58, s58, 4096
    s_and_b32 s58, s49, 3
    s_mul_i32 s58, s58, 401408
    v_add_u32 v61, s58, v61
    s_lshr_b32 s58, s49, 2
    s_cmp_eq_u32 s58, 7
    s_cselect_b32 s58, 0, s58
    s_mul_i32 s58, s58, 57344
    s_add_u32 s59, s58, 0
    s_mov_b32 s55, 7
L_ag38:
    s_cmp_ge_u32 s59, 401408
    s_cselect_b32 s56, 401408, 0
    s_sub_u32 s59, s59, s56
    buffer_load_dword v60, v61, s[32:35], s59 offen
    s_add_u32 s59, s59, 8192
    s_sub_u32 s55, s55, 1
    s_cmp_lg_u32 s55, 0
    s_waitcnt vmcnt(6)
    s_cbranch_scc1 L_ag38
    s_add_u32 m0, s60, 51744
    s_nop 0
    buffer_load_dwordx4 v9, s[44:47], 0 offen lds
    buffer_load_dwordx4 v9, s[44:47], 0 offen offset:1024 lds
    buffer_load_dwordx4 v9, s[44:47], 0 offen offset:2048 lds
    buffer_load_dwordx4 v9, s[44:47], 0 offen offset:3072 lds
    s_add_u32 m0, s60, 55904
    s_mov_b32 s54, 2
    buffer_load_dwordx4 v9, s[44:47], s54 offen lds
    buffer_load_dwordx4 v9, s[44:47], s54 offen offset:1024 lds
    buffer_load_dwordx4 v9, s[44:47], s54 offen offset:2048 lds
    buffer_load_dwordx4 v9, s[44:47], s54 offen offset:3072 lds
    s_add_u32 m0, s60, 60032
    s_mov_b32 s54, 4718592
    buffer_load_dwordx4 v13, s[40:43], s54 offen sc1 lds
    buffer_load_dwordx4 v13, s[40:43], s54 offen offset:1024 sc1 lds
    buffer_load_dwordx4 v13, s[40:43], s54 offen offset:2048 sc1 lds
    buffer_load_dwordx4 v13, s[40:43], s54 offen offset:3072 sc1 lds
    s_waitcnt vmcnt(0)
    ds_read_b128 v[128:131], v40 offset:55296
    ds_read2_b32 v[64:65], v36 offset0:0 offset1:1
    ds_read2_b32 v[66:67], v36 offset0:2 offset1:3
    ds_read_b128 v[132:135], v40 offset:54784
    ds_read2_b32 v[68:69], v36 offset0:128 offset1:129
    ds_read2_b32 v[70:71], v36 offset0:130 offset1:131
    ds_read_b128 v[136:139], v40 offset:54272
    ds_read2_b32 v[72:73], v37 offset0:0 offset1:1
    ds_read2_b32 v[74:75], v37 offset0:2 offset1:3
    ds_read_b128 v[140:143], v40 offset:53760
    ds_read2_b32 v[76:77], v37 offset0:128 offset1:129
    ds_read2_b32 v[78:79], v37 offset0:130 offset1:131
    ds_read_b128 v[144:147], v40 offset:53248
    ds_read2_b32 v[80:81], v38 offset0:0 offset1:1
    ds_read2_b32 v[82:83], v38 offset0:2 offset1:3
    ds_read_b128 v[148:151], v40 offset:52736
    ds_read2_b32 v[84:85], v38 offset0:128 offset1:129
    ds_read2_b32 v[86:87], v38 offset0:130 offset1:131
    ds_read_b128 v[152:155], v40 offset:52224
    ds_read2_b32 v[88:89], v39 offset0:0 offset1:1
    ds_read2_b32 v[90:91], v39 offset0:2 offset1:3
    ds_read_b128 v[156:159], v40 offset:51712
    ds_read2_b32 v[92:93], v39 offset0:128 offset1:129
    ds_read2_b32 v[94:95], v39 offset0:130 offset1:131
    s_waitcnt lgkmcnt(0)
    s_branch L_round1
L_codeend:
L_far:
    s_nop 7
    s_waitcnt lgkmcnt(4)
    v_pk_fma_f32 v[176:177], v[192:193], v[200:201], v[176:177] op_sel_hi:[1,0,1]
    s_add_u32 m0, s81, 61440
    s_mov_b32 s54, 200704
    buffer_load_dwordx4 v6, s[24:27], s54 offen lds
    v_pk_fma_f32 v[178:179], v[194:195], v[200:201], v[178:179] op_sel_hi:[1,0,1]
    v_pk_fma_f32 v[180:181], v[192:193], v[204:205], v[180:181] op_sel_hi:[1,0,1]
    v_pk_fma_f32 v[182:183], v[194:195], v[204:205], v[182:183] op_sel_hi:[1,0,1]
    v_pk_mul_f32 v[144:145], v[176:177], v[176:177]
    v_pk_mul_f32 v[146:147], v[178:179], v[178:179]
    v_pk_mul_f32 v[148:149], v[180:181], v[180:181]
    v_pk_mul_f32 v[150:151], v[182:183], v[182:183]
    v_pk_fma_f32 v[144:145], v[144:145], v[202:203], v[200:201] op_sel:[0,0,1] op_sel_hi:[1,0,1]
    s_add_u32 m0, s81, 65536
    s_mov_b32 s54, 229376
    buffer_load_dwordx4 v6, s[24:27], s54 offen lds
    v_pk_fma_f32 v[146:147], v[146:147], v[202:203], v[200:201] op_sel:[0,0,1] op_sel_hi:[1,0,1]
    v_pk_fma_f32 v[148:149], v[148:149], v[206:207], v[204:205] op_sel:[0,0,1] op_sel_hi:[1,0,1]
    v_pk_fma_f32 v[150:151], v[150:151], v[206:207], v[204:205] op_sel:[0,0,1] op_sel_hi:[1,0,1]
    v_pk_mul_f32 v[144:145], v[176:177], v[144:145]
    v_pk_mul_f32 v[146:147], v[178:179], v[146:147]
    v_pk_mul_f32 v[148:149], v[180:181], v[148:149]
    v_pk_mul_f32 v[150:151], v[182:183], v[150:151]
    v_exp_f32 v144, v144
    v_exp_f32 v145, v145
    s_add_u32 m0, s81, 69632
    s_mov_b32 s54, 258048
    buffer_load_dwordx4 v6, s[24:27], s54 offen lds
    v_exp_f32 v146, v146
    v_exp_f32 v147, v147
    v_exp_f32 v148, v148
    v_exp_f32 v149, v149
    v_exp_f32 v150, v150
    v_exp_f32 v151, v151
    v_pk_fma_f32 v[144:145], v[144:145], v[202:203], v[202:203] op_sel:[0,1,1] op_sel_hi:[1,1,1]
    v_pk_fma_f32 v[146:147], v[146:147], v[202:203], v[202:203] op_sel:[0,1,1] op_sel_hi:[1,1,1]
    s_add_u32 m0, s81, 73728
    s_mov_b32 s54, 286720
    buffer_load_dwordx4 v6, s[24:27], s54 offen lds
    v_pk_fma_f32 v[148:149], v[148:149], v[206:207], v[206:207] op_sel:[0,1,1] op_sel_hi:[1,1,1]
    v_pk_fma_f32 v[150:151], v[150:151], v[206:207], v[206:207] op_sel:[0,1,1] op_sel_hi:[1,1,1]
    v_rcp_f32 v144, v144
    v_rcp_f32 v145, v145
    v_rcp_f32 v146, v146
    v_rcp_f32 v147, v147
    v_rcp_f32 v148, v148
    v_rcp_f32 v149, v149
    v_rcp_f32 v150, v150
    s_add_u32 m0, s81, 77824
    s_mov_b32 s54, 315392
    buffer_load_dwordx4 v6, s[24:27], s54 offen lds
    v_rcp_f32 v151, v151
    v_pk_mul_f32 v[144:145], v[176:177], v[144:145]
    v_pk_mul_f32 v[146:147], v[178:179], v[146:147]
    v_pk_mul_f32 v[148:149], v[180:181], v[148:149]
    v_pk_mul_f32 v[150:151], v[182:183], v[150:151]
    v_cvt_pk_bf16_f32 v136, v144, v145
    v_cvt_pk_bf16_f32 v137, v146, v147
    v_cvt_pk_bf16_f32 v138, v148, v149
    s_add_u32 m0, s81, 81920
    s_mov_b32 s54, 344064
    buffer_load_dwordx4 v6, s[24:27], s54 offen lds
    v_cvt_pk_bf16_f32 v139, v150, v151
    v_permlane32_swap_b32 v136, v138
    s_nop 0
    v_permlane32_swap_b32 v137, v139
    buffer_store_dwordx4 v[136:139], v243, s[40:43], 0 offen sc1
    s_waitcnt lgkmcnt(2)
    v_pk_fma_f32 v[184:185], v[192:193], v[208:209], v[184:185] op_sel_hi:[1,0,1]
    v_pk_fma_f32 v[186:187], v[194:195], v[208:209], v[186:187] op_sel_hi:[1,0,1]
    v_pk_fma_f32 v[188:189], v[192:193], v[212:213], v[188:189] op_sel_hi:[1,0,1]
    v_pk_fma_f32 v[190:191], v[194:195], v[212:213], v[190:191] op_sel_hi:[1,0,1]
    v_pk_mul_f32 v[144:145], v[184:185], v[184:185]
    s_add_u32 m0, s81, 86016
    s_mov_b32 s54, 372736
    buffer_load_dwordx4 v6, s[24:27], s54 offen lds
    v_pk_mul_f32 v[146:147], v[186:187], v[186:187]
    v_pk_mul_f32 v[148:149], v[188:189], v[188:189]
    v_pk_mul_f32 v[150:151], v[190:191], v[190:191]
    v_pk_fma_f32 v[144:145], v[144:145], v[210:211], v[208:209] op_sel:[0,0,1] op_sel_hi:[1,0,1]
    v_pk_fma_f32 v[146:147], v[146:147], v[210:211], v[208:209] op_sel:[0,0,1] op_sel_hi:[1,0,1]
    v_pk_fma_f32 v[148:149], v[148:149], v[214:215], v[212:213] op_sel:[0,0,1] op_sel_hi:[1,0,1]
    v_pk_fma_f32 v[150:151], v[150:151], v[214:215], v[212:213] op_sel:[0,0,1] op_sel_hi:[1,0,1]
    v_pk_mul_f32 v[144:145], v[184:185], v[144:145]
    v_pk_mul_f32 v[146:147], v[186:187], v[146:147]
    v_pk_mul_f32 v[148:149], v[188:189], v[148:149]
    v_pk_mul_f32 v[150:151], v[190:191], v[150:151]
    v_exp_f32 v144, v144
    v_exp_f32 v145, v145
    v_exp_f32 v146, v146
    v_exp_f32 v147, v147
    v_exp_f32 v148, v148
    v_exp_f32 v149, v149
    v_exp_f32 v150, v150
    v_exp_f32 v151, v151
    v_pk_fma_f32 v[144:145], v[144:145], v[210:211], v[210:211] op_sel:[0,1,1] op_sel_hi:[1,1,1]
    v_pk_fma_f32 v[146:147], v[146:147], v[210:211], v[210:211] op_sel:[0,1,1] op_sel_hi:[1,1,1]
    v_pk_fma_f32 v[148:149], v[148:149], v[214:215], v[214:215] op_sel:[0,1,1] op_sel_hi:[1,1,1]
    v_pk_fma_f32 v[150:151], v[150:151], v[214:215], v[214:215] op_sel:[0,1,1] op_sel_hi:[1,1,1]
    v_rcp_f32 v144, v144
    v_rcp_f32 v145, v145
    v_rcp_f32 v146, v146
    v_rcp_f32 v147, v147
    v_rcp_f32 v148, v148
    v_rcp_f32 v149, v149
    v_rcp_f32 v150, v150
    v_rcp_f32 v151, v151
    v_pk_mul_f32 v[144:145], v[184:185], v[144:145]
    v_pk_mul_f32 v[146:147], v[186:187], v[146:147]
    v_pk_mul_f32 v[148:149], v[188:189], v[148:149]
    v_pk_mul_f32 v[150:151], v[190:191], v[150:151]
    v_cvt_pk_bf16_f32 v140, v144, v145
    v_cvt_pk_bf16_f32 v141, v146, v147
    v_cvt_pk_bf16_f32 v142, v148, v149
    v_cvt_pk_bf16_f32 v143, v150, v151
    s_mov_b32 s56, 28672
    v_permlane32_swap_b32 v140, v142
    v_permlane32_swap_b32 v141, v143
    buffer_store_dwordx4 v[140:143], v243, s[40:43], s56 offen sc1
    s_waitcnt lgkmcnt(0)
    s_and_b32 s71, s50, 0
    s_add_u32 m0, s60, 90112
    s_add_u32 s54, s76, 0
    buffer_load_dwordx4 v7, s[28:31], s54 offen offset:0 lds
    s_lshl_b32 s71, s71, 1
    s_xor_b32 s71, s71, s48
    s_mul_i32 s56, s71, 401408
    s_sub_u32 s56, s56, s60
    v_add_u32 v6, s56, v6
    v_lshlrev_b32 v176, 16, v216
    v_and_b32 v177, 0xffff0000, v216
    v_lshlrev_b32 v178, 16, v217
    s_add_u32 s54, s76, 56320
    buffer_load_dwordx4 v7, s[28:31], s54 offen offset:1024 lds
    v_and_b32 v179, 0xffff0000, v217
    v_lshlrev_b32 v180, 16, v218
    v_and_b32 v181, 0xffff0000, v218
    v_lshlrev_b32 v182, 16, v219
    v_and_b32 v183, 0xffff0000, v219
    v_lshlrev_b32 v184, 16, v220
    v_and_b32 v185, 0xffff0000, v220
    v_lshlrev_b32 v186, 16, v221
    s_add_u32 s54, s76, 112640
    buffer_load_dwordx4 v7, s[28:31], s54 offen offset:2048 lds
    v_and_b32 v187, 0xffff0000, v221
    v_lshlrev_b32 v188, 16, v222
    v_and_b32 v189, 0xffff0000, v222
    v_lshlrev_b32 v190, 16, v223
    v_and_b32 v191, 0xffff0000, v223
    v_pk_add_f32 v[176:177], v[176:177], v[246:247] op_sel_hi:[1,0]
    v_pk_add_f32 v[178:179], v[178:179], v[246:247] op_sel_hi:[1,0]
    v_pk_add_f32 v[180:181], v[180:181], v[246:247] op_sel_hi:[1,0]
    s_add_u32 s54, s76, 168960
    buffer_load_dwordx4 v7, s[28:31], s54 offen offset:3072 lds
    v_pk_add_f32 v[182:183], v[182:183], v[246:247] op_sel_hi:[1,0]
    v_pk_add_f32 v[184:185], v[184:185], v[246:247] op_sel_hi:[1,0]
    v_pk_add_f32 v[186:187], v[186:187], v[246:247] op_sel_hi:[1,0]
    v_pk_add_f32 v[188:189], v[188:189], v[246:247] op_sel_hi:[1,0]
    v_pk_add_f32 v[190:191], v[190:191], v[246:247] op_sel_hi:[1,0]
    v_pk_mul_f32 v[176:177], v[176:177], v[246:247] op_sel:[0,1] op_sel_hi:[1,1]
    v_pk_mul_f32 v[178:179], v[178:179], v[246:247] op_sel:[0,1] op_sel_hi:[1,1]
    v_pk_mul_f32 v[180:181], v[180:181], v[246:247] op_sel:[0,1] op_sel_hi:[1,1]
    v_pk_mul_f32 v[182:183], v[182:183], v[246:247] op_sel:[0,1] op_sel_hi:[1,1]
    s_add_u32 m0, s60, 94208
    s_add_u32 s54, s76, 229376
    buffer_load_dwordx4 v7, s[28:31], s54 offen offset:0 lds
    v_pk_mul_f32 v[184:185], v[184:185], v[246:247] op_sel:[0,1] op_sel_hi:[1,1]
    v_pk_mul_f32 v[186:187], v[186:187], v[246:247] op_sel:[0,1] op_sel_hi:[1,1]
    v_pk_mul_f32 v[188:189], v[188:189], v[246:247] op_sel:[0,1] op_sel_hi:[1,1]
    v_pk_mul_f32 v[190:191], v[190:191], v[246:247] op_sel:[0,1] op_sel_hi:[1,1]
    v_accvgpr_write_b32 a224, v176
    v_accvgpr_write_b32 a225, v177
    v_accvgpr_write_b32 a226, v178
    v_accvgpr_write_b32 a227, v179
    s_add_u32 s54, s76, 285696
    buffer_load_dwordx4 v7, s[28:31], s54 offen offset:1024 lds
    v_accvgpr_write_b32 a228, v180
    v_accvgpr_write_b32 a229, v181
    v_accvgpr_write_b32 a230, v182
    v_accvgpr_write_b32 a231, v183
    v_accvgpr_write_b32 a232, v184
    v_accvgpr_write_b32 a233, v185
    v_accvgpr_write_b32 a234, v186
    v_accvgpr_write_b32 a235, v187
    s_add_u32 s54, s76, 342016
    buffer_load_dwordx4 v7, s[28:31], s54 offen offset:2048 lds
    v_accvgpr_write_b32 a236, v188
    v_accvgpr_write_b32 a237, v189
    v_accvgpr_write_b32 a238, v190
    v_accvgpr_write_b32 a239, v191
    s_and_b32 s56, s61, 0xfffffbff
    v_add_u32 v228, s56, v2
    v_add_u32 v12, 118784, v3
    v_add_u32 v4, 61440, v3
    s_waitcnt vmcnt(7)
    s_mov_b64 exec, 15
    buffer_store_dword v13, v251, s[40:43], s3 offen sc1
    s_mov_b64 exec, -1
    s_barrier
    ds_read_b64_tr_b16 a[0:1], v12 offset:0
    ds_read_b64_tr_b16 a[2:3], v12 offset:1024
    ds_read_b64_tr_b16 a[4:5], v12 offset:2048
    ds_read_b64_tr_b16 a[6:7], v12 offset:3072
    ds_read_b64_tr_b16 a[8:9], v12 offset:4096
    ds_read_b64_tr_b16 a[10:11], v12 offset:5120
    ds_read_b64_tr_b16 a[12:13], v12 offset:6144
    ds_read_b64_tr_b16 a[14:15], v12 offset:7168
    ds_read_b64_tr_b16 a[16:17], v12 offset:8192
    ds_read_b64_tr_b16 a[18:19], v12 offset:9216
    ds_read_b64_tr_b16 a[20:21], v12 offset:10240
    ds_read_b64_tr_b16 a[22:23], v12 offset:11264
    ds_read_b64_tr_b16 a[24:25], v12 offset:12288
    ds_read_b64_tr_b16 a[26:27], v12 offset:13312
    ds_read_b64_tr_b16 a[28:29], v12 offset:14336
    ds_read_b64_tr_b16 a[30:31], v12 offset:15360
    ds_read_b64_tr_b16 a[32:33], v12 offset:16384
    ds_read_b64_tr_b16 a[34:35], v12 offset:17408
    ds_read_b64_tr_b16 a[36:37], v12 offset:18432
    ds_read_b64_tr_b16 a[38:39], v12 offset:19456
    ds_read_b64_tr_b16 a[40:41], v12 offset:20480
    ds_read_b64_tr_b16 a[42:43], v12 offset:21504
    ds_read_b64_tr_b16 a[44:45], v12 offset:22528
    ds_read_b64_tr_b16 a[46:47], v12 offset:23552
    ds_read_b64_tr_b16 a[48:49], v12 offset:24576
    ds_read_b64_tr_b16 a[50:51], v12 offset:25600
    ds_read_b64_tr_b16 a[52:53], v12 offset:26624
    ds_read_b64_tr_b16 a[54:55], v12 offset:27648
    s_lshl_b32 s101, s48, 6
    s_add_u32 s101, s101, s3
    s_load_dwordx8 s[4:11], s[40:41], s101
    ds_read_b64_tr_b16 a[56:57], v4 offset:0
    ds_read_b64_tr_b16 a[58:59], v4 offset:1024
    ds_read_b64_tr_b16 a[60:61], v4 offset:2048
    ds_read_b64_tr_b16 a[62:63], v4 offset:3072
    ds_read_b64_tr_b16 a[64:65], v4 offset:4096
    ds_read_b64_tr_b16 a[66:67], v4 offset:5120
    ds_read_b64_tr_b16 a[68:69], v4 offset:6144
    ds_read_b64_tr_b16 a[70:71], v4 offset:7168
    ds_read_b64_tr_b16 a[72:73], v4 offset:8192
    ds_read_b64_tr_b16 a[74:75], v4 offset:9216
    ds_read_b64_tr_b16 a[76:77], v4 offset:10240
    ds_read_b64_tr_b16 a[78:79], v4 offset:11264
    ds_read_b64_tr_b16 a[80:81], v4 offset:12288
    ds_read_b64_tr_b16 a[82:83], v4 offset:13312
    ds_read_b64_tr_b16 a[84:85], v4 offset:14336
    ds_read_b64_tr_b16 a[86:87], v4 offset:15360
    s_mov_b32 s55, 0
L_cl43:
    s_waitcnt lgkmcnt(0)
    s_mov_b32 s11, s10
    s_and_b64 s[20:21], s[4:5], s[6:7]
    s_or_b64 s[22:23], s[4:5], s[6:7]
    s_and_b64 s[20:21], s[20:21], s[8:9]
    s_or_b64 s[22:23], s[22:23], s[8:9]
    s_and_b64 s[20:21], s[20:21], s[10:11]
    s_or_b64 s[22:23], s[22:23], s[10:11]
    s_and_b32 s20, s20, s21
    s_or_b32 s21, s22, s23
    s_cmp_eq_u64 s[20:21], s[64:65]
    s_cbranch_scc1 L_ce44
    s_add_u32 s55, s55, 1
    s_cmp_eq_u32 s55, 4
    s_cbranch_scc1 L_cv46
    s_add_u32 s101, s101, 256
    s_load_dwordx8 s[4:11], s[40:41], s101
    s_branch L_cl43
L_cv46:
    v_and_b32 v9, 15, v1
    v_min_u32 v9, 6, v9
    v_and_b32 v250, 48, v1
    v_add_lshl_u32 v9, v9, v250, 2
    v_add_u32 v9, s3, v9
    v_subrev_u32 v9, 16, v9
    s_mov_b32 s55, 0
L_spin47:
    buffer_load_dword v250, v9, s[40:43], 0 offen offset:16 sc1
    s_waitcnt vmcnt(0)
    v_cmp_ne_u32 vcc, s65, v250
    s_cbranch_vccz L_spun48
    s_add_u32 s55, s55, 1
    s_cmp_lt_u32 s55, 1048576
    s_cbranch_scc1 L_spin47
L_spun48:
L_ce44:
    s_barrier
    s_add_u32 m0, s61, 0
    s_nop 0
    buffer_load_dwordx4 v252, s[40:43], 0 offen offset:0 sc1 lds
    buffer_load_dwordx4 v252, s[40:43], 0 offen offset:2048 sc1 lds
    s_add_u32 m0, s61, 4096
    s_mov_b32 s54, 4096
    buffer_load_dwordx4 v252, s[40:43], s54 offen offset:0 sc1 lds
    ds_read_b64_tr_b16 a[88:89], v4 offset:16384
    buffer_load_dwordx4 v252, s[40:43], s54 offen offset:2048 sc1 lds
    ds_read_b64_tr_b16 a[90:91], v4 offset:17408
    ds_read_b64_tr_b16 a[92:93], v4 offset:18432
    s_add_u32 m0, s61, 8192
    s_mov_b32 s54, 8192
    buffer_load_dwordx4 v252, s[40:43], s54 offen offset:0 sc1 lds
    ds_read_b64_tr_b16 a[94:95], v4 offset:19456
    ds_read_b64_tr_b16 a[96:97], v4 offset:20480
    buffer_load_dwordx4 v252, s[40:43], s54 offen offset:2048 sc1 lds
    ds_read_b64_tr_b16 a[98:99], v4 offset:21504
    ds_read_b64_tr_b16 a[100:101], v4 offset:22528
    ds_read_b64_tr_b16 a[102:103], v4 offset:23552
    s_add_u32 m0, s61, 12288
    s_mov_b32 s54, 12288
    buffer_load_dwordx4 v252, s[40:43], s54 offen offset:0 sc1 lds
    ds_read_b64_tr_b16 a[104:105], v4 offset:24576
    ds_read_b64_tr_b16 a[106:107], v4 offset:25600
    buffer_load_dwordx4 v252, s[40:43], s54 offen offset:2048 sc1 lds
    ds_read_b64_tr_b16 a[108:109], v4 offset:26624
    ds_read_b64_tr_b16 a[110:111], v4 offset:27648
    s_waitcnt lgkmcnt(0)
    s_waitcnt vmcnt(5)
    s_barrier
    ds_read_b128 v[128:131], v228 offset:0
    ds_read_b128 v[132:135], v228 offset:1024
    ds_read_b128 v[136:139], v228 offset:2048
    ds_read_b128 v[140:143], v228 offset:3072
    s_waitcnt lgkmcnt(3)
    v_mfma_f32_32x32x16_bf16 v[176:191], a[0:3], v[128:131], v[176:191]
    ds_read_b128 v[128:131], v228 offset:4096
    s_add_u32 m0, s61, 16384
    s_mov_b32 s54, 16384
    buffer_load_dwordx4 v252, s[40:43], s54 offen offset:0 sc1 lds
    s_waitcnt lgkmcnt(3)
    v_mfma_f32_32x32x16_bf16 v[176:191], a[4:7], v[132:135], v[176:191]
    v_lshlrev_b32 v160, 16, v216
    v_and_b32 v161, 0xffff0000, v216
    buffer_load_dwordx4 v252, s[40:43], s54 offen offset:2048 sc1 lds
    v_add_u32 v10, 90112, v5
    ds_read_b128 v[132:135], v228 offset:5120
    s_waitcnt lgkmcnt(3)
    v_mfma_f32_32x32x16_bf16 v[176:191], a[8:11], v[136:139], v[176:191]
    ds_read_b64_tr_b16 v[16:17], v10 offset:0
    v_lshlrev_b32 v162, 16, v217
    v_and_b32 v163, 0xffff0000, v217
    v_lshlrev_b32 v164, 16, v218
    s_waitcnt vmcnt(3)
    s_barrier
    ds_read_b128 v[136:139], v228 offset:6144
    s_waitcnt lgkmcnt(4)
    v_mfma_f32_32x32x16_bf16 v[176:191], a[12:15], v[140:143], v[176:191]
    ds_read_b64_tr_b16 v[18:19], v10 offset:512
    ds_read_b128 v[140:143], v228 offset:7168
    v_and_b32 v165, 0xffff0000, v218
    s_add_u32 m0, s61, 20480
    s_mov_b32 s54, 20480
    buffer_load_dwordx4 v252, s[40:43], s54 offen offset:0 sc1 lds
    s_waitcnt lgkmcnt(5)
    v_mfma_f32_32x32x16_bf16 v[176:191], a[16:19], v[128:131], v[176:191]
    ds_read_b64_tr_b16 v[20:21], v10 offset:1024
    ds_read_b128 v[128:131], v228 offset:8192
    v_lshlrev_b32 v166, 16, v219
    v_and_b32 v167, 0xffff0000, v219
    v_lshlrev_b32 v168, 16, v220
    buffer_load_dwordx4 v252, s[40:43], s54 offen offset:2048 sc1 lds
    s_waitcnt lgkmcnt(6)
    v_mfma_f32_32x32x16_bf16 v[176:191], a[20:23], v[132:135], v[176:191]
    ds_read_b64_tr_b16 v[22:23], v10 offset:1536
    ds_read_b128 v[132:135], v228 offset:9216
    v_and_b32 v169, 0xffff0000, v220
    v_lshlrev_b32 v170, 16, v221
    v_and_b32 v171, 0xffff0000, v221
    v_lshlrev_b32 v172, 16, v222
    v_and_b32 v173, 0xffff0000, v222
    s_waitcnt lgkmcnt(6)
    v_mfma_f32_32x32x16_bf16 v[176:191], a[24:27], v[136:139], v[176:191]
    ds_read_b64_tr_b16 v[24:25], v10 offset:2048
    ds_read_b128 v[136:139], v228 offset:10240
    v_lshlrev_b32 v174, 16, v223
    s_add_u32 m0, s61, 24576
    s_mov_b32 s54, 24576
    buffer_load_dwordx4 v252, s[40:43], s54 offen offset:0 sc1 lds
    s_waitcnt lgkmcnt(6)
    v_mfma_f32_32x32x16_bf16 v[176:191], a[28:31], v[140:143], v[176:191]
    ds_read_b64_tr_b16 v[26:27], v10 offset:2560
    ds_read_b128 v[140:143], v228 offset:11264
    v_and_b32 v175, 0xffff0000, v223
    v_mov_b32 v208, 0
    v_mov_b32 v209, 0
    buffer_load_dwordx4 v252, s[40:43], s54 offen offset:2048 sc1 lds
    s_waitcnt lgkmcnt(6)
    v_mfma_f32_32x32x16_bf16 v[176:191], a[32:35], v[128:131], v[176:191]
    ds_read_b64_tr_b16 v[28:29], v10 offset:3072
    ds_read_b128 v[128:131], v228 offset:12288
    v_lshrrev_b32 v153, 4, v1
    v_and_b32 v152, 15, v1
    v_xor_b32 v148, v153, v152
    v_and_b32 v148, 1, v148
    v_subrev_u32 v148, 1, v148
    s_waitcnt lgkmcnt(6)
    v_mfma_f32_32x32x16_bf16 v[176:191], a[36:39], v[132:135], v[176:191]
    ds_read_b64_tr_b16 v[30:31], v10 offset:3584
    ds_read_b128 v[132:135], v228 offset:13312
    v_and_b32 v148, s63, v148
    v_mov_b32 v149, v148
    v_mov_b32 v150, v148
    v_mov_b32 v151, v148
    s_mul_i32 s56, s52, 114688
    s_waitcnt lgkmcnt(6)
    v_mfma_f32_32x32x16_bf16 v[176:191], a[40:43], v[136:139], v[176:191]
    ds_read_b64_tr_b16 v[32:33], v10 offset:4096
    s_add_u32 m0, s60, 118784
    s_add_u32 s54, s77, 0
    buffer_load_dwordx4 v7, s[28:31], s54 offen offset:0 lds
    s_waitcnt vmcnt(4)
    s_barrier
    ds_read_b128 v[136:139], v228 offset:14336
    s_waitcnt lgkmcnt(6)
    v_mfma_f32_32x32x16_bf16 v[176:191], a[44:47], v[140:143], v[176:191]
    ds_read_b64_tr_b16 v[34:35], v10 offset:4608
    ds_read_b128 v[140:143], v228 offset:15360
    s_add_u32 s54, s77, 56320
    buffer_load_dwordx4 v7, s[28:31], s54 offen offset:1024 lds
    s_add_u32 s56, s56, s80
    s_waitcnt lgkmcnt(6)
    v_mfma_f32_32x32x16_bf16 v[176:191], a[48:51], v[128:131], v[176:191]
    ds_read_b64_tr_b16 v[36:37], v10 offset:5120
    ds_read_b128 v[128:131], v228 offset:16384
    s_add_u32 s54, s77, 112640
    buffer_load_dwordx4 v7, s[28:31], s54 offen offset:2048 lds
    v_add_u32 v240, s56, v2
    v_add_u32 v241, 61440, v2
    s_waitcnt lgkmcnt(6)
    v_mfma_f32_32x32x16_bf16 v[176:191], a[52:55], v[132:135], v[176:191]
    ds_read_b64_tr_b16 v[38:39], v10 offset:5632
    ds_read_b128 v[132:135], v228 offset:17408
    s_add_u32 s54, s77, 168960
    buffer_load_dwordx4 v7, s[28:31], s54 offen offset:3072 lds
    s_lshl_b32 s56, s52, 2
    s_add_u32 s56, s56, s48
    s_waitcnt lgkmcnt(6)
    v_mfma_f32_32x32x16_bf16 v[176:191], a[56:59], v[136:139], v[176:191]
    ds_read_b64_tr_b16 v[40:41], v10 offset:6144
    ds_read_b128 v[136:139], v228 offset:18432
    s_mul_i32 s56, s56, 3584
    s_add_u32 s56, s56, 4194304
    v_lshl_add_u32 v242, v1, 2, s56
    v_and_b32 v243, 31, v1
    v_lshlrev_b32 v243, 4, v243
    s_waitcnt lgkmcnt(6)
    v_mfma_f32_32x32x16_bf16 v[176:191], a[60:63], v[140:143], v[176:191]
    ds_read_b64_tr_b16 v[42:43], v10 offset:6656
    ds_read_b128 v[140:143], v228 offset:19456
    s_add_u32 m0, s60, 122880
    s_add_u32 s54, s77, 229376
    buffer_load_dwordx4 v7, s[28:31], s54 offen offset:0 lds
    v_add_u32 v243, 147456, v243
    s_waitcnt lgkmcnt(6)
    v_mfma_f32_32x32x16_bf16 v[176:191], a[64:67], v[128:131], v[176:191]
    ds_read_b128 v[128:131], v228 offset:20480
    s_add_u32 s54, s77, 285696
    buffer_load_dwordx4 v7, s[28:31], s54 offen offset:1024 lds
    s_lshl_b32 s56, s51, 13
    s_add_u32 s56, s56, s75
    v_add_u32 v244, s56, v2
    s_waitcnt lgkmcnt(5)
    v_mfma_f32_32x32x16_bf16 v[176:191], a[68:71], v[132:135], v[176:191]
    ds_read_b128 v[132:135], v228 offset:21504
    s_add_u32 s54, s77, 342016
    buffer_load_dwordx4 v7, s[28:31], s54 offen offset:2048 lds
    s_mul_i32 s56, s52, 458752
    s_mul_i32 s57, s52, 114688
    s_waitcnt lgkmcnt(4)
    v_mfma_f32_32x32x16_bf16 v[176:191], a[72:75], v[136:139], v[176:191]
    s_add_u32 s24, s56, 8912896
    s_add_u32 s25, s57, 65536
    s_add_u32 s26, s56, 9142272
    s_add_u32 s27, s57, 2097152
    s_add_u32 s3, s97, 16384
    s_waitcnt vmcnt(7)
    s_barrier
    ds_read_b128 v[136:139], v228 offset:22528
    s_waitcnt lgkmcnt(3)
    v_mfma_f32_32x32x16_bf16 v[176:191], a[76:79], v[140:143], v[176:191]
    ds_read_b128 v[140:143], v228 offset:23552
    s_add_u32 m0, s60, 61440
    s_add_u32 s54, s78, 0
    buffer_load_dwordx4 v7, s[28:31], s54 offen offset:0 lds
    s_lshl_b32 s56, s48, 7
    s_waitcnt lgkmcnt(3)
    v_mfma_f32_32x32x16_bf16 v[176:191], a[80:83], v[128:131], v[176:191]
    ds_read_b128 v[128:131], v228 offset:24576
    s_add_u32 s54, s78, 56320
    buffer_load_dwordx4 v7, s[28:31], s54 offen offset:1024 lds
    s_add_u32 s56, s56, 149504
    v_add_u32 v236, 1, v152
    v_and_b32 v237, 1, v236
    s_waitcnt lgkmcnt(3)
    v_mfma_f32_32x32x16_bf16 v[176:191], a[84:87], v[132:135], v[176:191]
    ds_read_b128 v[132:135], v228 offset:25600
    s_add_u32 s54, s78, 112640
    buffer_load_dwordx4 v7, s[28:31], s54 offen offset:2048 lds
    v_mul_u32_u24 v237, 4160, v237
    v_and_b32 v236, 30, v236
    v_lshl_add_u32 v236, v153, 3, v236
    s_waitcnt lgkmcnt(3)
    v_mfma_f32_32x32x16_bf16 v[176:191], a[88:91], v[136:139], v[176:191]
    ds_read_b128 v[136:139], v228 offset:26624
    s_add_u32 s54, s78, 168960
    buffer_load_dwordx4 v7, s[28:31], s54 offen offset:3072 lds
    v_lshl_add_u32 v236, v236, 1, v237
    v_add_u32 v232, s56, v236
    v_lshlrev_b32 v236, 4, v153
    s_waitcnt lgkmcnt(3)
    v_mfma_f32_32x32x16_bf16 v[176:191], a[92:95], v[140:143], v[176:191]
    ds_read_b128 v[140:143], v228 offset:27648
    v_lshlrev_b32 v237, 5, v152
    v_sub_u32 v236, v236, v237
    v_add_u32 v236, 8800, v236
    v_add_u32 v246, s56, v236
    s_mov_b32 s98, 0x06543210
    s_mov_b32 s99, 0x10654321
    s_waitcnt lgkmcnt(3)
    v_mfma_f32_32x32x16_bf16 v[176:191], a[96:99], v[128:131], v[176:191]
    s_add_u32 m0, s60, 65536
    s_add_u32 s54, s78, 229376
    buffer_load_dwordx4 v7, s[28:31], s54 offen offset:0 lds
    s_and_b32 s56, s49, 28
    s_lshr_b64 s[98:99], s[98:99], s56
    s_bfe_u32 s90, s98, 196608
    s_waitcnt lgkmcnt(2)
    v_mfma_f32_32x32x16_bf16 v[176:191], a[100:103], v[132:135], v[176:191]
    s_add_u32 s54, s78, 285696
    buffer_load_dwordx4 v7, s[28:31], s54 offen offset:1024 lds
    s_mul_i32 s90, s90, 57344
    s_bfe_u32 s91, s98, 196612
    s_mul_i32 s91, s91, 57344
    s_bfe_u32 s92, s98, 196616
    s_waitcnt lgkmcnt(1)
    v_mfma_f32_32x32x16_bf16 v[176:191], a[104:107], v[136:139], v[176:191]
    s_add_u32 s54, s78, 342016
    buffer_load_dwordx4 v7, s[28:31], s54 offen offset:2048 lds
    s_mul_i32 s92, s92, 57344
    s_bfe_u32 s93, s98, 196620
    s_mul_i32 s93, s93, 57344
    s_bfe_u32 s94, s98, 196624
    s_waitcnt lgkmcnt(0)
    v_mfma_f32_32x32x16_bf16 v[176:191], a[108:111], v[140:143], v[176:191]
    s_mul_i32 s94, s94, 57344
    s_bfe_u32 s95, s98, 196628
    s_mul_i32 s95, s95, 57344
    s_bfe_u32 s96, s98, 196632
    s_mul_i32 s96, s96, 57344
    v_add_u32 v233, 1024, v232
    v_add_u32 v234, 2048, v232
    v_add_u32 v235, 3072, v232
    s_nop 3
    v_cvt_pk_bf16_f32 v200, v176, v177
    v_cvt_pk_bf16_f32 v201, v178, v179
    v_cvt_pk_bf16_f32 v202, v180, v181
    v_cvt_pk_bf16_f32 v203, v182, v183
    v_cvt_pk_bf16_f32 v204, v184, v185
    v_cvt_pk_bf16_f32 v205, v186, v187
    v_cvt_pk_bf16_f32 v206, v188, v189
    v_cvt_pk_bf16_f32 v207, v190, v191
    buffer_store_dwordx4 v[200:203], v14, s[40:43], 0 offen sc1
    buffer_store_dwordx4 v[204:207], v14, s[40:43], 0 offen offset:1024 sc1
    v_dot2c_f32_bf16 v208, s63, v200
    v_dot2c_f32_bf16 v209, v200, v200
    v_dot2c_f32_bf16 v208, s63, v201
    v_dot2c_f32_bf16 v209, v201, v201
    v_dot2c_f32_bf16 v208, s63, v202
    v_dot2c_f32_bf16 v209, v202, v202
    v_dot2c_f32_bf16 v208, s63, v203
    v_dot2c_f32_bf16 v209, v203, v203
    v_dot2c_f32_bf16 v208, s63, v204
    v_dot2c_f32_bf16 v209, v204, v204
    v_dot2c_f32_bf16 v208, s63, v205
    v_dot2c_f32_bf16 v209, v205, v205
    v_dot2c_f32_bf16 v208, s63, v206
    v_dot2c_f32_bf16 v209, v206, v206
    v_dot2c_f32_bf16 v208, s63, v207
    v_dot2c_f32_bf16 v209, v207, v207
    s_nop 2
    v_permlane32_swap_b32 v208, v209
    v_add_f32 v208, v208, v209
    buffer_store_dword v208, v15, s[40:43], 0 offen sc1
    v_pk_add_f32 v[176:177], v[176:177], v[160:161]
    v_pk_add_f32 v[178:179], v[178:179], v[162:163]
    v_pk_add_f32 v[180:181], v[180:181], v[164:165]
    v_pk_add_f32 v[182:183], v[182:183], v[166:167]
    v_pk_add_f32 v[184:185], v[184:185], v[168:169]
    v_pk_add_f32 v[186:187], v[186:187], v[170:171]
    v_pk_add_f32 v[188:189], v[188:189], v[172:173]
    v_pk_add_f32 v[190:191], v[190:191], v[174:175]
    v_accvgpr_write_b32 a240, v176
    v_accvgpr_write_b32 a241, v177
    v_accvgpr_write_b32 a242, v178
    v_accvgpr_write_b32 a243, v179
    v_accvgpr_write_b32 a244, v180
    v_accvgpr_write_b32 a245, v181
    v_accvgpr_write_b32 a246, v182
    v_accvgpr_write_b32 a247, v183
    v_accvgpr_write_b32 a248, v184
    v_accvgpr_write_b32 a249, v185
    v_accvgpr_write_b32 a250, v186
    v_accvgpr_write_b32 a251, v187
    v_accvgpr_write_b32 a252, v188
    v_accvgpr_write_b32 a253, v189
    v_accvgpr_write_b32 a254, v190
    v_accvgpr_write_b32 a255, v191
    v_lshrrev_b32 v247, 3, v1
    s_bfe_u32 s56, s53, 0x20004
    s_lshl_b32 s56, s56, 2
    s_sub_u32 s56, s56, s81
    s_add_u32 s56, s56, 31744
    v_lshl_add_u32 v247, v247, 7, s56
    s_and_b32 s56, s53, 1
    s_lshl_b32 s56, s56, 4
    s_lshr_b32 s68, s68, s56
    s_and_b32 s68, s68, 0xffff
    s_min_u32 s56, s48, 1
    s_lshl_b32 s56, s56, 4
    s_lshr_b32 s68, s68, s56
    v_lshl_add_u32 v252, v153, 3, v152
    v_sub_u32 v252, 15, v252
    v_and_b32 v248, 1, v252
    v_lshlrev_b32 v248, 4, v248
    v_lshlrev_b32 v248, v248, s68
    v_lshrrev_b32 v252, 1, v252
    v_cmp_eq_u32 s[4:5], 0, v252
    v_cmp_eq_u32 s[6:7], 1, v252
    v_cmp_eq_u32 s[8:9], 2, v252
    v_cmp_eq_u32 s[10:11], 3, v252
    v_cndmask_b32 v236, 0, v248, s[4:5]
    v_cndmask_b32 v237, 0, v248, s[6:7]
    v_cndmask_b32 v238, 0, v248, s[8:9]
    v_cndmask_b32 v239, 0, v248, s[10:11]
    s_waitcnt vmcnt(0)
    s_mov_b64 exec, 15
    buffer_store_dword v13, v11, s[40:43], s89 offen sc1
    s_mov_b64 exec, -1
    s_add_u32 m0, s60, 90112
    s_add_u32 s54, s79, 0
    buffer_load_dwordx4 v7, s[28:31], s54 offen offset:0 lds
    s_add_u32 s54, s79, 56320
    buffer_load_dwordx4 v7, s[28:31], s54 offen offset:1024 lds
    s_add_u32 s54, s79, 112640
    buffer_load_dwordx4 v7, s[28:31], s54 offen offset:2048 lds
    s_add_u32 s54, s79, 168960
    buffer_load_dwordx4 v7, s[28:31], s54 offen offset:3072 lds
    s_add_u32 m0, s60, 94208
    s_add_u32 s54, s79, 229376
    buffer_load_dwordx4 v7, s[28:31], s54 offen offset:0 lds
    s_add_u32 s54, s79, 285696
    buffer_load_dwordx4 v7, s[28:31], s54 offen offset:1024 lds
    s_add_u32 s54, s79, 342016
    buffer_load_dwordx4 v7, s[28:31], s54 offen offset:2048 lds
    v_mfma_f32_16x16x32_bf16 v[144:147], v[148:151], v[16:19], 0
    v_add_u32 v10, 118784, v5
    ds_read_b64_tr_b16 v[44:45], v10 offset:0
    ds_read_b64_tr_b16 v[46:47], v10 offset:512
    v_mfma_f32_16x16x32_bf16 v[144:147], v[148:151], v[20:23], v[144:147]
    ds_read_b64_tr_b16 v[48:49], v10 offset:1024
    ds_read_b64_tr_b16 v[50:51], v10 offset:1536
    v_mfma_f32_16x16x32_bf16 v[144:147], v[148:151], v[24:27], v[144:147]
    ds_read_b64_tr_b16 v[52:53], v10 offset:2048
    ds_read_b64_tr_b16 v[54:55], v10 offset:2560
    v_mfma_f32_16x16x32_bf16 v[144:147], v[148:151], v[28:31], v[144:147]
    ds_read_b64_tr_b16 v[56:57], v10 offset:3072
    ds_read_b64_tr_b16 v[58:59], v10 offset:3584
    v_mfma_f32_16x16x32_bf16 v[144:147], v[148:151], v[32:35], v[144:147]
    ds_read_b64_tr_b16 v[60:61], v10 offset:4096
    ds_read_b64_tr_b16 v[62:63], v10 offset:4608
    v_mfma_f32_16x16x32_bf16 v[144:147], v[148:151], v[36:39], v[144:147]
    ds_read_b64_tr_b16 v[64:65], v10 offset:5120
    ds_read_b64_tr_b16 v[66:67], v10 offset:5632
    v_mfma_f32_16x16x32_bf16 v[144:147], v[148:151], v[40:43], v[144:147]
    ds_read_b64_tr_b16 v[68:69], v10 offset:6144
    ds_read_b64_tr_b16 v[70:71], v10 offset:6656
    s_waitcnt lgkmcnt(0)
    v_mfma_f32_16x16x32_bf16 v[144:147], v[148:151], v[44:47], v[144:147]
    v_add_u32 v10, 61440, v5
    ds_read_b64_tr_b16 v[72:73], v10 offset:0
    ds_read_b64_tr_b16 v[74:75], v10 offset:512
    v_mfma_f32_16x16x32_bf16 v[144:147], v[148:151], v[48:51], v[144:147]
    ds_read_b64_tr_b16 v[76:77], v10 offset:1024
    ds_read_b64_tr_b16 v[78:79], v10 offset:1536
    v_mfma_f32_16x16x32_bf16 v[144:147], v[148:151], v[52:55], v[144:147]
    ds_read_b64_tr_b16 v[80:81], v10 offset:2048
    ds_read_b64_tr_b16 v[82:83], v10 offset:2560
    v_mfma_f32_16x16x32_bf16 v[144:147], v[148:151], v[56:59], v[144:147]
    ds_read_b64_tr_b16 v[84:85], v10 offset:3072
    ds_read_b64_tr_b16 v[86:87], v10 offset:3584
    v_mfma_f32_16x16x32_bf16 v[144:147], v[148:151], v[60:63], v[144:147]
    ds_read_b64_tr_b16 v[88:89], v10 offset:4096
    ds_read_b64_tr_b16 v[90:91], v10 offset:4608
    v_mfma_f32_16x16x32_bf16 v[144:147], v[148:151], v[64:67], v[144:147]
    ds_read_b64_tr_b16 v[92:93], v10 offset:5120
    ds_read_b64_tr_b16 v[94:95], v10 offset:5632
    v_mfma_f32_16x16x32_bf16 v[144:147], v[148:151], v[68:71], v[144:147]
    ds_read_b64_tr_b16 v[96:97], v10 offset:6144
    ds_read_b64_tr_b16 v[98:99], v10 offset:6656
    s_waitcnt lgkmcnt(0)
    s_lshl_b32 s101, s48, 6
    s_add_u32 s101, s101, s89
    s_load_dwordx16 s[4:19], s[40:41], s101
    v_mfma_f32_16x16x32_bf16 v[144:147], v[148:151], v[72:75], v[144:147]
    v_bfe_u32 v128, v1, 3, 1
    v_mul_u32_u24 v128, 4160, v128
    v_mfma_f32_16x16x32_bf16 v[144:147], v[148:151], v[76:79], v[144:147]
    v_and_b32 v129, 7, v1
    v_lshl_add_u32 v128, v129, 2, v128
    v_add_u32 v128, 149504, v128
    v_mfma_f32_16x16x32_bf16 v[144:147], v[148:151], v[80:83], v[144:147]
    s_lshl_b32 s69, s69, 16
    v_mov_b32 v129, s69
    v_mfma_f32_16x16x32_bf16 v[144:147], v[148:151], v[84:87], v[144:147]
    v_cmp_eq_u32 vcc, 15, v152
    v_lshlrev_b32 v132, 3, v1
    v_mfma_f32_16x16x32_bf16 v[144:147], v[148:151], v[88:91], v[144:147]
    v_add_u32 v132, 161920, v132
    v_cndmask_b32 v129, 0, v129, vcc
    v_mfma_f32_16x16x32_bf16 v[144:147], v[148:151], v[92:95], v[144:147]
    v_mov_b32 v130, 0
    v_mov_b32 v131, 0
    v_mov_b32 v133, 0
    v_mfma_f32_16x16x32_bf16 v[144:147], v[148:151], v[96:99], v[144:147]
    v_mov_b32 v134, 0
    v_mov_b32 v135, 0
    ds_write_b32 v128, v129
    ds_write_b64 v132, v[130:131]
    s_mov_b32 s55, 0
L_cl49:
    s_waitcnt lgkmcnt(0)
    s_and_b64 s[20:21], s[4:5], s[6:7]
    s_or_b64 s[22:23], s[4:5], s[6:7]
    s_and_b64 s[20:21], s[20:21], s[8:9]
    s_or_b64 s[22:23], s[22:23], s[8:9]
    s_and_b64 s[20:21], s[20:21], s[10:11]
    s_or_b64 s[22:23], s[22:23], s[10:11]
    s_and_b64 s[20:21], s[20:21], s[12:13]
    s_or_b64 s[22:23], s[22:23], s[12:13]
    s_and_b64 s[20:21], s[20:21], s[14:15]
    s_or_b64 s[22:23], s[22:23], s[14:15]
    s_and_b64 s[20:21], s[20:21], s[16:17]
    s_or_b64 s[22:23], s[22:23], s[16:17]
    s_and_b32 s20, s20, s21
    s_or_b32 s21, s22, s23
    s_cmp_eq_u64 s[20:21], s[64:65]
    s_cbranch_scc1 L_ce50
    s_add_u32 s55, s55, 1
    s_cmp_eq_u32 s55, 4
    s_cbranch_scc1 L_cv52
    s_add_u32 s101, s101, 256
    s_load_dwordx16 s[4:19], s[40:41], s101
    s_branch L_cl49
L_cv52:
    v_and_b32 v9, 15, v1
    v_min_u32 v9, 13, v9
    v_and_b32 v250, 48, v1
    v_add_lshl_u32 v9, v9, v250, 2
    v_add_u32 v9, s89, v9
    v_subrev_u32 v9, 16, v9
    s_mov_b32 s55, 0
L_spin53:
    buffer_load_dword v250, v9, s[40:43], 0 offen offset:16 sc1
    s_waitcnt vmcnt(0)
    v_cmp_ne_u32 vcc, s65, v250
    s_cbranch_vccz L_spun54
    s_add_u32 s55, s55, 1
    s_cmp_lt_u32 s55, 1048576
    s_cbranch_scc1 L_spin53
L_spun54:
L_ce50:
    s_barrier
    s_add_u32 m0, s60, 0
    s_mov_b32 s54, 2097152
    buffer_load_dwordx4 v240, s[40:43], s54 offen sc1 lds
    buffer_load_dwordx4 v240, s[40:43], s54 offen offset:1024 sc1 lds
    s_waitcnt vmcnt(2)
    v_add_u32 v10, 90112, v5
    buffer_load_dwordx4 v240, s[40:43], s54 offen offset:2048 sc1 lds
    ds_read_b64_tr_b16 v[100:101], v10 offset:0
    ds_read_b64_tr_b16 v[102:103], v10 offset:512
    ds_read_b64_tr_b16 v[104:105], v10 offset:1024
    ds_read_b64_tr_b16 v[106:107], v10 offset:1536
    ds_read_b64_tr_b16 v[108:109], v10 offset:2048
    buffer_load_dwordx4 v240, s[40:43], s54 offen offset:3072 sc1 lds
    ds_read_b64_tr_b16 v[110:111], v10 offset:2560
    ds_read_b64_tr_b16 v[112:113], v10 offset:3072
    ds_read_b64_tr_b16 v[114:115], v10 offset:3584
    ds_read_b64_tr_b16 v[116:117], v10 offset:4096
    ds_read_b64_tr_b16 v[118:119], v10 offset:4608
    s_add_u32 m0, s60, 4096
    s_mov_b32 s54, 2101248
    buffer_load_dwordx4 v240, s[40:43], s54 offen sc1 lds
    ds_read_b64_tr_b16 v[120:121], v10 offset:5120
    ds_read_b64_tr_b16 v[122:123], v10 offset:5632
    ds_read_b64_tr_b16 v[124:125], v10 offset:6144
    ds_read_b64_tr_b16 v[126:127], v10 offset:6656
    s_waitcnt lgkmcnt(0)
    v_mfma_f32_16x16x32_bf16 v[144:147], v[148:151], v[100:103], v[144:147]
    buffer_load_dwordx4 v240, s[40:43], s54 offen offset:1024 sc1 lds
    v_mfma_f32_16x16x32_bf16 v[144:147], v[148:151], v[104:107], v[144:147]
    v_and_b32 v252, 1, v153
    v_cmp_eq_u32 s[82:83], 1, v252
    v_mfma_f32_16x16x32_bf16 v[144:147], v[148:151], v[108:111], v[144:147]
    v_lshlrev_b32 v252, 9, v252
    v_lshl_add_u32 v252, v152, 5, v252
    v_mfma_f32_16x16x32_bf16 v[144:147], v[148:151], v[112:115], v[144:147]
    buffer_load_dwordx4 v240, s[40:43], s54 offen offset:2048 sc1 lds
    v_mfma_f32_16x16x32_bf16 v[144:147], v[148:151], v[116:119], v[144:147]
    v_lshrrev_b32 v153, 1, v153
    v_lshl_add_u32 v252, v153, 4, v252
    v_mfma_f32_16x16x32_bf16 v[144:147], v[148:151], v[120:123], v[144:147]
    s_mul_i32 s70, s53, 4224
    s_add_u32 s70, s70, s81
    v_mfma_f32_16x16x32_bf16 v[144:147], v[148:151], v[124:127], v[144:147]
    v_add_u32 v252, s70, v252
    v_cmp_gt_u32 vcc, 32, v1
    v_add_u32 v3, s60, v3
    s_add_u32 m0, s60, 28672
    s_mov_b32 s54, 2125824
    buffer_load_dwordx4 v240, s[40:43], s54 offen sc1 lds
    v_xor_b32 v4, 64, v3
    v_add_u32 v10, 61440, v3
    v_add_u32 v12, 61440, v4
    v_cndmask_b32 v144, v144, v145, s[82:83]
    v_cvt_pk_bf16_f32 v128, v144, v144
    buffer_load_dwordx4 v240, s[40:43], s54 offen offset:1024 sc1 lds
    v_lshlrev_b32 v145, 16, v128
    v_sub_f32 v145, v144, v145
    v_cvt_pk_bf16_f32 v145, v145, v145
    v_cndmask_b32 v128, v145, v128, vcc
    v_mov_b32 v129, 0
    s_waitcnt vmcnt(2)
    s_barrier
    ds_read_b128 v[176:179], v2 offset:0
    ds_read_b128 v[180:183], v2 offset:1024
    ds_read_b128 v[184:187], v2 offset:2048
    ds_read_b128 v[188:191], v2 offset:3072
    ds_read_b128 v[192:195], v2 offset:4096
    ds_read_b128 v[196:199], v2 offset:5120
    ds_read_b128 v[200:203], v2 offset:6144
    buffer_load_dword v216, v242, s[40:43], 0 offen offset:0 sc1
    buffer_load_dword v217, v242, s[40:43], 0 offen offset:256 sc1
    buffer_load_dword v218, v242, s[40:43], 0 offen offset:512 sc1
    buffer_load_dword v219, v242, s[40:43], 0 offen offset:768 sc1
    buffer_load_dword v220, v242, s[40:43], 0 offen offset:1024 sc1
    buffer_load_dword v221, v242, s[40:43], 0 offen offset:1280 sc1
    s_waitcnt lgkmcnt(3)
    v_mfma_f32_32x32x16_bf16 v[144:159], v[16:19], v[176:179], 0
    ds_read_b128 v[204:207], v2 offset:7168
    buffer_load_dword v222, v242, s[40:43], 0 offen offset:1536 sc1
    buffer_load_dword v223, v242, s[40:43], 0 offen offset:1792 sc1
    v_mfma_f32_32x32x16_bf16 v[144:159], v[20:23], v[180:183], v[144:159]
    ds_read_b128 v[176:179], v2 offset:8192
    buffer_load_dword v224, v242, s[40:43], 0 offen offset:2048 sc1
    buffer_load_dword v225, v242, s[40:43], 0 offen offset:2304 sc1
    v_mfma_f32_32x32x16_bf16 v[144:159], v[24:27], v[184:187], v[144:159]
    ds_read_b128 v[180:183], v2 offset:9216
    buffer_load_dword v226, v242, s[40:43], 0 offen offset:2560 sc1
    buffer_load_dword v227, v242, s[40:43], 0 offen offset:2816 sc1
    v_mfma_f32_32x32x16_bf16 v[144:159], v[28:31], v[188:191], v[144:159]
    ds_read_b128 v[184:187], v2 offset:10240
    buffer_load_dword v228, v242, s[40:43], 0 offen offset:3072 sc1
    buffer_load_dword v229, v242, s[40:43], 0 offen offset:3328 sc1
    s_waitcnt lgkmcnt(3)
    v_mfma_f32_32x32x16_bf16 v[144:159], v[32:35], v[192:195], v[144:159]
    ds_read_b128 v[188:191], v2 offset:11264
    buffer_load_dwordx4 v240, s[40:43], s54 offen offset:2048 sc1 lds
    v_mfma_f32_32x32x16_bf16 v[144:159], v[36:39], v[196:199], v[144:159]
    ds_read_b128 v[192:195], v2 offset:12288
    buffer_load_dwordx4 v240, s[40:43], s54 offen offset:3072 sc1 lds
    v_mfma_f32_32x32x16_bf16 v[144:159], v[40:43], v[200:203], v[144:159]
    ds_read_b128 v[196:199], v2 offset:13312
    v_mfma_f32_32x32x16_bf16 v[144:159], v[44:47], v[204:207], v[144:159]
    ds_read_b128 v[200:203], v2 offset:14336
    s_add_u32 m0, s60, 32768
    s_mov_b32 s54, 2129920
    buffer_load_dwordx4 v240, s[40:43], s54 offen sc1 lds
    s_waitcnt lgkmcnt(3)
    v_mfma_f32_32x32x16_bf16 v[144:159], v[48:51], v[176:179], v[144:159]
    ds_read_b128 v[204:207], v2 offset:15360
    buffer_load_dwordx4 v240, s[40:43], s54 offen offset:1024 sc1 lds
    v_mfma_f32_32x32x16_bf16 v[144:159], v[52:55], v[180:183], v[144:159]
    ds_read_b128 v[176:179], v2 offset:16384
    v_mfma_f32_32x32x16_bf16 v[144:159], v[56:59], v[184:187], v[144:159]
    ds_read_b128 v[180:183], v2 offset:17408
    buffer_load_dwordx4 v240, s[40:43], s54 offen offset:2048 sc1 lds
    v_mfma_f32_32x32x16_bf16 v[144:159], v[60:63], v[188:191], v[144:159]
    ds_read_b128 v[184:187], v2 offset:18432
    s_waitcnt vmcnt(5)
    v_add_f32 v216, v216, v223
    v_add_f32 v217, v217, v224
    v_add_f32 v218, v218, v225
    v_add_f32 v219, v219, v226
    s_waitcnt lgkmcnt(3)
    v_mfma_f32_32x32x16_bf16 v[144:159], v[64:67], v[192:195], v[144:159]
    ds_read_b128 v[188:191], v2 offset:19456
    v_add_f32 v220, v220, v227
    v_add_f32 v221, v221, v228
    v_add_f32 v222, v222, v229
    v_add_f32 v216, v216, v219
    v_add_f32 v217, v217, v220
    v_mfma_f32_32x32x16_bf16 v[144:159], v[68:71], v[196:199], v[144:159]
    ds_read_b128 v[192:195], v2 offset:20480
    s_add_u32 m0, s60, 61440
    s_mov_b32 s54, 2154496
    buffer_load_dwordx4 v240, s[40:43], s54 offen sc1 lds
    v_add_f32 v218, v218, v221
    v_add_f32 v216, v216, v222
    v_mfma_f32_32x32x16_bf16 v[144:159], v[72:75], v[200:203], v[144:159]
    ds_read_b128 v[196:199], v2 offset:21504
    v_add_f32 v217, v217, v218
    v_add_f32 v216, v216, v217
    v_mov_b32 v217, v216
    s_lshl_b32 s56, s48, 9
    v_add_u32 v218, s56, v243
    v_mfma_f32_32x32x16_bf16 v[144:159], v[76:79], v[204:207], v[144:159]
    ds_read_b128 v[200:203], v2 offset:22528
    buffer_load_dwordx4 v240, s[40:43], s54 offen offset:1024 sc1 lds
    v_permlane32_swap_b32 v216, v217
    v_mul_f32 v219, 0xbb124925, v216
    s_waitcnt lgkmcnt(3)
    v_mfma_f32_32x32x16_bf16 v[144:159], v[80:83], v[176:179], v[144:159]
    ds_read_b128 v[204:207], v2 offset:23552
    v_mul_f32 v217, 0x3b124925, v217
    v_cvt_pk_bf16_f32 v220, v219, v219
    v_fma_f32 v217, -v219, v219, v217
    v_lshlrev_b32 v220, 16, v220
    v_max_f32 v217, 0, v217
    v_sub_f32 v220, v219, v220
    v_mfma_f32_32x32x16_bf16 v[144:159], v[84:87], v[180:183], v[144:159]
    ds_read_b128 v[176:179], v2 offset:24576
    buffer_load_dwordx4 v240, s[40:43], s54 offen offset:2048 sc1 lds
    v_add_f32 v217, 0x3727c5ac, v217
    v_cvt_pk_bf16_f32 v220, v219, v220
    v_rsq_f32 v216, v217
    v_mfma_f32_32x32x16_bf16 v[144:159], v[88:91], v[184:187], v[144:159]
    ds_read_b128 v[180:183], v2 offset:25600
    v_sqrt_f32 v223, v217
    v_mul_f32 v221, 0xc0135761, v216
    v_mul_f32 v216, v216, v216
    v_mul_f32 v216, 0x3d372713, v216
    v_mfma_f32_32x32x16_bf16 v[144:159], v[92:95], v[188:191], v[144:159]
    ds_read_b128 v[184:187], v2 offset:26624
    buffer_load_dwordx4 v240, s[40:43], s54 offen offset:3072 sc1 lds
    v_mul_f32 v222, v221, v216
    ds_write_b128 v218, v[220:223]
    s_waitcnt lgkmcnt(4)
    v_mfma_f32_32x32x16_bf16 v[144:159], v[96:99], v[192:195], v[144:159]
    ds_read_b128 v[188:191], v2 offset:27648
    s_waitcnt vmcnt(4)
    s_waitcnt lgkmcnt(1)
    s_barrier
    v_mfma_f32_32x32x16_bf16 v[144:159], v[100:103], v[196:199], v[144:159]
    ds_read_b128 v[208:211], v243 offset:0
    ds_read_b128 v[192:195], v2 offset:28672
    v_mfma_f32_32x32x16_bf16 v[144:159], v[104:107], v[200:203], v[144:159]
    ds_read_b32 v132, v243 offset:0
    ds_read_b128 v[196:199], v2 offset:29696
    s_add_u32 m0, s60, 65536
    s_mov_b32 s54, 2158592
    buffer_load_dwordx4 v240, s[40:43], s54 offen sc1 lds
    v_mfma_f32_32x32x16_bf16 v[144:159], v[108:111], v[204:207], v[144:159]
    ds_read_b128 v[200:203], v2 offset:30720
    s_waitcnt lgkmcnt(5)
    v_mfma_f32_32x32x16_bf16 v[144:159], v[112:115], v[176:179], v[144:159]
    ds_read_b128 v[204:207], v2 offset:31744
    buffer_load_dwordx4 v240, s[40:43], s54 offen offset:1024 sc1 lds
    v_mfma_f32_32x32x16_bf16 v[144:159], v[116:119], v[180:183], v[144:159]
    ds_read_b128 v[176:179], v2 offset:32768
    v_mfma_f32_32x32x16_bf16 v[144:159], v[120:123], v[184:187], v[144:159]
    ds_read_b128 v[180:183], v2 offset:33792
    buffer_load_dwordx4 v240, s[40:43], s54 offen offset:2048 sc1 lds
    v_mfma_f32_32x32x16_bf16 v[144:159], v[124:127], v[188:191], v[144:159]
    ds_read_b128 v[184:187], v2 offset:34816
    s_waitcnt lgkmcnt(6)
    v_mfma_f32_32x32x16_bf16 v[144:159], v[128:131], v[132:135], v[144:159]
    s_waitcnt lgkmcnt(3)
    v_mfma_f32_32x32x16_bf16 v[160:175], v[16:19], v[192:195], 0
    ds_read_b128 v[188:191], v2 offset:35840
    s_add_u32 m0, s60, 90112
    s_mov_b32 s54, 2183168
    buffer_load_dwordx4 v240, s[40:43], s54 offen sc1 lds
    v_mfma_f32_32x32x16_bf16 v[160:175], v[20:23], v[196:199], v[160:175]
    ds_read_b128 v[192:195], v2 offset:36864
    buffer_load_dwordx4 v240, s[40:43], s54 offen offset:1024 sc1 lds
    s_nop 2
    v_mul_f32 v216, v144, v144
    v_mul_f32 v217, v145, v145
    v_mul_f32 v218, v146, v146
    v_mul_f32 v219, v147, v147
    v_fma_f32 v216, v216, v210, v209
    v_fma_f32 v217, v217, v210, v209
    v_mfma_f32_32x32x16_bf16 v[160:175], v[24:27], v[200:203], v[160:175]
    ds_read_b128 v[196:199], v2 offset:37888
    v_fma_f32 v218, v218, v210, v209
    v_fma_f32 v219, v219, v210, v209
    v_mul_f32 v216, v144, v216
    v_mul_f32 v217, v145, v217
    v_mul_f32 v218, v146, v218
    v_mul_f32 v219, v147, v219
    v_exp_f32 v216, v216
    v_mfma_f32_32x32x16_bf16 v[160:175], v[28:31], v[204:207], v[160:175]
    ds_read_b128 v[200:203], v2 offset:38912
    buffer_load_dwordx4 v240, s[40:43], s54 offen offset:2048 sc1 lds
    v_exp_f32 v217, v217
    v_exp_f32 v218, v218
    s_waitcnt lgkmcnt(3)
    v_mfma_f32_32x32x16_bf16 v[160:175], v[32:35], v[176:179], v[160:175]
    ds_read_b128 v[204:207], v2 offset:39936
    v_exp_f32 v219, v219
    v_fma_f32 v216, v216, v211, v211
    v_fma_f32 v217, v217, v211, v211
    v_fma_f32 v218, v218, v211, v211
    v_fma_f32 v219, v219, v211, v211
    v_rcp_f32 v216, v216
    v_mfma_f32_32x32x16_bf16 v[160:175], v[36:39], v[180:183], v[160:175]
    ds_read_b128 v[176:179], v2 offset:40960
    buffer_load_dwordx4 v240, s[40:43], s54 offen offset:3072 sc1 lds
    v_rcp_f32 v217, v217
    v_rcp_f32 v218, v218
    v_rcp_f32 v219, v219
    v_mfma_f32_32x32x16_bf16 v[160:175], v[40:43], v[184:187], v[160:175]
    ds_read_b128 v[180:183], v2 offset:41984
    s_add_u32 m0, s60, 94208
    s_mov_b32 s54, 2187264
    buffer_load_dwordx4 v240, s[40:43], s54 offen sc1 lds
    v_mul_f32 v216, v144, v216
    v_mul_f32 v217, v145, v217
    v_mul_f32 v218, v146, v218
    v_mfma_f32_32x32x16_bf16 v[160:175], v[44:47], v[188:191], v[160:175]
    ds_read_b128 v[184:187], v2 offset:43008
    v_mul_f32 v219, v147, v219
    v_cvt_pk_bf16_f32 v224, v216, v217
    v_cvt_pk_bf16_f32 v225, v218, v219
    v_mul_f32 v220, v148, v148
    v_mul_f32 v221, v149, v149
    v_mul_f32 v222, v150, v150
    v_mul_f32 v223, v151, v151
    v_fma_f32 v220, v220, v210, v209
    s_waitcnt lgkmcnt(3)
    v_mfma_f32_32x32x16_bf16 v[160:175], v[48:51], v[192:195], v[160:175]
    ds_read_b128 v[188:191], v2 offset:44032
    buffer_load_dwordx4 v240, s[40:43], s54 offen offset:1024 sc1 lds
    v_fma_f32 v221, v221, v210, v209
    v_fma_f32 v222, v222, v210, v209
    v_fma_f32 v223, v223, v210, v209
    v_mul_f32 v220, v148, v220
    v_mul_f32 v221, v149, v221
    v_mfma_f32_32x32x16_bf16 v[160:175], v[52:55], v[196:199], v[160:175]
    ds_read_b128 v[192:195], v2 offset:45056
    v_mul_f32 v222, v150, v222
    v_mul_f32 v223, v151, v223
    v_exp_f32 v220, v220
    v_exp_f32 v221, v221
    v_exp_f32 v222, v222
    v_mfma_f32_32x32x16_bf16 v[160:175], v[56:59], v[200:203], v[160:175]
    ds_read_b128 v[196:199], v2 offset:46080
    buffer_load_dwordx4 v240, s[40:43], s54 offen offset:2048 sc1 lds
    v_exp_f32 v223, v223
    v_fma_f32 v220, v220, v211, v211
    v_fma_f32 v221, v221, v211, v211
    v_fma_f32 v222, v222, v211, v211
    v_fma_f32 v223, v223, v211, v211
    v_mfma_f32_32x32x16_bf16 v[160:175], v[60:63], v[204:207], v[160:175]
    ds_read_b128 v[200:203], v2 offset:47104
    s_lshl_b32 s54, s53, 12
    s_add_u32 s54, s54, s81
    s_add_u32 m0, s81, 149536
    s_nop 0
    buffer_load_dwordx4 v2, s[44:47], s54 offen lds
    v_rcp_f32 v220, v220
    s_waitcnt lgkmcnt(3)
    v_mfma_f32_32x32x16_bf16 v[160:175], v[64:67], v[176:179], v[160:175]
    ds_read_b128 v[204:207], v2 offset:48128
    v_rcp_f32 v221, v221
    v_rcp_f32 v222, v222
    v_rcp_f32 v223, v223
    v_mul_f32 v220, v148, v220
    v_mfma_f32_32x32x16_bf16 v[160:175], v[68:71], v[180:183], v[160:175]
    ds_read_b128 v[176:179], v2 offset:49152
    s_add_u32 s54, s54, 2
    s_add_u32 m0, s81, 153696
    s_nop 0
    buffer_load_dwordx4 v2, s[44:47], s54 offen lds
    v_mul_f32 v221, v149, v221
    v_mul_f32 v222, v150, v222
    v_mul_f32 v223, v151, v223
    v_cvt_pk_bf16_f32 v226, v220, v221
    v_mfma_f32_32x32x16_bf16 v[160:175], v[72:75], v[184:187], v[160:175]
    ds_read_b128 v[180:183], v2 offset:50176
    v_cvt_pk_bf16_f32 v227, v222, v223
    v_mul_f32 v216, v152, v152
    v_mul_f32 v217, v153, v153
    v_mul_f32 v218, v154, v154
    v_mul_f32 v219, v155, v155
    v_fma_f32 v216, v216, v210, v209
    v_fma_f32 v217, v217, v210, v209
    v_fma_f32 v218, v218, v210, v209
    v_mfma_f32_32x32x16_bf16 v[160:175], v[76:79], v[188:191], v[160:175]
    ds_read_b128 v[184:187], v2 offset:51200
    s_add_u32 m0, s60, 118784
    s_add_u32 m0, s60, 118784
    s_add_u32 s54, s90, 0
    buffer_load_dwordx4 v6, s[32:35], s54 offen offset:0 lds
    v_fma_f32 v219, v219, v210, v209
    v_mul_f32 v216, v152, v216
    s_waitcnt lgkmcnt(3)
    v_mfma_f32_32x32x16_bf16 v[160:175], v[80:83], v[192:195], v[160:175]
    ds_read_b128 v[188:191], v2 offset:52224
    v_mul_f32 v217, v153, v217
    v_mul_f32 v218, v154, v218
    v_mul_f32 v219, v155, v219
    v_exp_f32 v216, v216
    v_exp_f32 v217, v217
    v_mfma_f32_32x32x16_bf16 v[160:175], v[84:87], v[196:199], v[160:175]
    ds_read_b128 v[192:195], v2 offset:53248
    s_add_u32 s54, s90, 6144
    buffer_load_dwordx4 v6, s[32:35], s54 offen offset:1024 lds
    v_exp_f32 v218, v218
    v_exp_f32 v219, v219
    v_fma_f32 v216, v216, v211, v211
    v_mfma_f32_32x32x16_bf16 v[160:175], v[88:91], v[200:203], v[160:175]
    ds_read_b128 v[196:199], v2 offset:54272
    s_add_u32 s54, s90, 12288
    buffer_load_dwordx4 v6, s[32:35], s54 offen offset:2048 lds
    v_fma_f32 v217, v217, v211, v211
    v_fma_f32 v218, v218, v211, v211
    v_fma_f32 v219, v219, v211, v211
    v_rcp_f32 v216, v216
    v_mfma_f32_32x32x16_bf16 v[160:175], v[92:95], v[204:207], v[160:175]
    ds_read_b128 v[200:203], v2 offset:55296
    v_rcp_f32 v217, v217
    v_rcp_f32 v218, v218
    v_rcp_f32 v219, v219
    v_mul_f32 v216, v152, v216
    s_waitcnt lgkmcnt(3)
    v_mfma_f32_32x32x16_bf16 v[160:175], v[96:99], v[176:179], v[160:175]
    ds_read_b128 v[204:207], v2 offset:56320
    s_add_u32 s54, s90, 18432
    buffer_load_dwordx4 v6, s[32:35], s54 offen offset:3072 lds
    v_mul_f32 v217, v153, v217
    v_mul_f32 v218, v154, v218
    s_waitcnt vmcnt(13)
    s_barrier
    v_mfma_f32_32x32x16_bf16 v[160:175], v[100:103], v[180:183], v[160:175]
    ds_read_b128 v[212:215], v243 offset:512
    ds_read_b128 v[176:179], v241 offset:0
    v_mul_f32 v219, v155, v219
    v_cvt_pk_bf16_f32 v228, v216, v217
    v_cvt_pk_bf16_f32 v229, v218, v219
    v_mul_f32 v220, v156, v156
    v_mul_f32 v221, v157, v157
    v_mul_f32 v222, v158, v158
    v_mul_f32 v223, v159, v159
    v_fma_f32 v220, v220, v210, v209
    v_mfma_f32_32x32x16_bf16 v[160:175], v[104:107], v[184:187], v[160:175]
    ds_read_b32 v132, v243 offset:512
    ds_read_b128 v[180:183], v241 offset:1024
    s_add_u32 m0, s60, 122880
    s_add_u32 s54, s90, 28672
    buffer_load_dwordx4 v6, s[32:35], s54 offen offset:0 lds
    v_fma_f32 v221, v221, v210, v209
    v_fma_f32 v222, v222, v210, v209
    v_mfma_f32_32x32x16_bf16 v[160:175], v[108:111], v[188:191], v[160:175]
    ds_read_b128 v[184:187], v241 offset:2048
    s_add_u32 s54, s90, 34816
    buffer_load_dwordx4 v6, s[32:35], s54 offen offset:1024 lds
    v_fma_f32 v223, v223, v210, v209
    v_mul_f32 v220, v156, v220
    v_mul_f32 v221, v157, v221
    v_mul_f32 v222, v158, v222
    s_waitcnt lgkmcnt(5)
    v_mfma_f32_32x32x16_bf16 v[160:175], v[112:115], v[192:195], v[160:175]
    ds_read_b128 v[188:191], v241 offset:3072
    v_mul_f32 v223, v159, v223
    v_exp_f32 v220, v220
    v_exp_f32 v221, v221
    v_exp_f32 v222, v222
    v_mfma_f32_32x32x16_bf16 v[160:175], v[116:119], v[196:199], v[160:175]
    ds_read_b128 v[192:195], v241 offset:4096
    s_add_u32 s54, s90, 40960
    buffer_load_dwordx4 v6, s[32:35], s54 offen offset:2048 lds
    v_exp_f32 v223, v223
    v_fma_f32 v220, v220, v211, v211
    v_fma_f32 v221, v221, v211, v211
    v_fma_f32 v222, v222, v211, v211
    v_mfma_f32_32x32x16_bf16 v[160:175], v[120:123], v[200:203], v[160:175]
    ds_read_b128 v[196:199], v241 offset:5120
    v_fma_f32 v223, v223, v211, v211
    v_rcp_f32 v220, v220
    v_rcp_f32 v221, v221
    v_rcp_f32 v222, v222
    v_rcp_f32 v223, v223
    v_mfma_f32_32x32x16_bf16 v[160:175], v[124:127], v[204:207], v[160:175]
    ds_read_b128 v[200:203], v241 offset:6144
    s_add_u32 m0, s60, 0
    s_add_u32 s54, s90, 50176
    buffer_load_dwordx4 v6, s[32:35], s54 offen offset:0 lds
    v_mul_f32 v220, v156, v220
    v_mul_f32 v221, v157, v221
    s_waitcnt lgkmcnt(6)
    v_mfma_f32_32x32x16_bf16 v[160:175], v[128:131], v[132:135], v[160:175]
    v_mul_f32 v222, v158, v222
    v_mul_f32 v223, v159, v223
    v_cvt_pk_bf16_f32 v230, v220, v221
    v_cvt_pk_bf16_f32 v231, v222, v223
    buffer_store_dwordx4 v[224:227], v244, s[40:43], s24 offen sc1
    buffer_store_dwordx4 v[228:231], v244, s[40:43], s24 offen offset:1024 sc1
    s_waitcnt lgkmcnt(3)
    v_mfma_f32_32x32x16_bf16 v[144:159], v[16:19], v[176:179], 0
    ds_read_b128 v[204:207], v241 offset:7168
    s_add_u32 m0, s60, 1024
    s_add_u32 s54, s91, 0
    buffer_load_dwordx4 v6, s[32:35], s54 offen offset:0 lds
    v_mfma_f32_32x32x16_bf16 v[144:159], v[20:23], v[180:183], v[144:159]
    ds_read_b128 v[176:179], v241 offset:8192
    s_add_u32 s54, s91, 6144
    buffer_load_dwordx4 v6, s[32:35], s54 offen offset:1024 lds
    v_mul_f32 v216, v160, v160
    v_mul_f32 v217, v161, v161
    v_mul_f32 v218, v162, v162
    v_mul_f32 v219, v163, v163
    v_fma_f32 v216, v216, v214, v213
    v_mfma_f32_32x32x16_bf16 v[144:159], v[24:27], v[184:187], v[144:159]
    v_fma_f32 v217, v217, v214, v213
    v_fma_f32 v218, v218, v214, v213
    v_fma_f32 v219, v219, v214, v213
    v_mul_f32 v216, v160, v216
    v_mul_f32 v217, v161, v217
    v_mul_f32 v218, v162, v218
    v_mul_f32 v219, v163, v219
    s_waitcnt vmcnt(5)
    ds_read_b64_tr_b16 a[0:1], v10 offset:57344
    ds_read_b128 v[180:183], v241 offset:9216
    v_mfma_f32_32x32x16_bf16 v[144:159], v[28:31], v[188:191], v[144:159]
    ds_read_b64_tr_b16 a[4:5], v12 offset:57344
    ds_read_b128 v[184:187], v241 offset:10240
    s_add_u32 s54, s91, 12288
    buffer_load_dwordx4 v6, s[32:35], s54 offen offset:2048 lds
    v_exp_f32 v216, v216
    s_waitcnt lgkmcnt(5)
    v_mfma_f32_32x32x16_bf16 v[144:159], v[32:35], v[192:195], v[144:159]
    ds_read_b64_tr_b16 a[2:3], v10 offset:58368
    ds_read_b128 v[188:191], v241 offset:11264
    v_exp_f32 v217, v217
    v_exp_f32 v218, v218
    v_exp_f32 v219, v219
    v_fma_f32 v216, v216, v215, v215
    v_fma_f32 v217, v217, v215, v215
    v_mfma_f32_32x32x16_bf16 v[144:159], v[36:39], v[196:199], v[144:159]
    ds_read_b64_tr_b16 a[6:7], v12 offset:58368
    ds_read_b128 v[192:195], v241 offset:12288
    s_add_u32 s54, s91, 18432
    buffer_load_dwordx4 v6, s[32:35], s54 offen offset:3072 lds
    v_fma_f32 v218, v218, v215, v215
    v_fma_f32 v219, v219, v215, v215
    v_rcp_f32 v216, v216
    v_mfma_f32_32x32x16_bf16 v[144:159], v[40:43], v[200:203], v[144:159]
    ds_read_b64_tr_b16 a[8:9], v10 offset:59392
    ds_read_b128 v[196:199], v241 offset:13312
    v_rcp_f32 v217, v217
    v_rcp_f32 v218, v218
    v_rcp_f32 v219, v219
    v_mul_f32 v216, v160, v216
    v_mul_f32 v217, v161, v217
    v_mfma_f32_32x32x16_bf16 v[144:159], v[44:47], v[204:207], v[144:159]
    ds_read_b64_tr_b16 a[12:13], v12 offset:59392
    ds_read_b128 v[200:203], v241 offset:14336
    buffer_load_dword v248, v247, s[40:43], 0 offen offset:16 sc1
    v_mul_f32 v218, v162, v218
    v_mul_f32 v219, v163, v219
    v_cvt_pk_bf16_f32 v224, v216, v217
    v_cvt_pk_bf16_f32 v225, v218, v219
    s_waitcnt lgkmcnt(6)
    v_mfma_f32_32x32x16_bf16 v[144:159], v[48:51], v[176:179], v[144:159]
    ds_read_b64_tr_b16 a[10:11], v10 offset:60416
    ds_read_b128 v[204:207], v241 offset:15360
    v_mul_f32 v220, v164, v164
    v_mul_f32 v221, v165, v165
    v_mul_f32 v222, v166, v166
    v_mul_f32 v223, v167, v167
    v_fma_f32 v220, v220, v214, v213
    v_fma_f32 v221, v221, v214, v213
    v_fma_f32 v222, v222, v214, v213
    v_fma_f32 v223, v223, v214, v213
    v_mfma_f32_32x32x16_bf16 v[144:159], v[52:55], v[180:183], v[144:159]
    ds_read_b64_tr_b16 a[14:15], v12 offset:60416
    ds_read_b128 v[176:179], v241 offset:16384
    s_add_u32 m0, s60, 5120
    s_add_u32 s54, s91, 28672
    buffer_load_dwordx4 v6, s[32:35], s54 offen offset:0 lds
    v_mul_f32 v220, v164, v220
    v_mul_f32 v221, v165, v221
    v_mul_f32 v222, v166, v222
    v_mfma_f32_32x32x16_bf16 v[144:159], v[56:59], v[184:187], v[144:159]
    ds_read_b64_tr_b16 a[16:17], v10 offset:61440
    ds_read_b128 v[180:183], v241 offset:17408
    v_mul_f32 v223, v167, v223
    v_exp_f32 v220, v220
    v_exp_f32 v221, v221
    v_exp_f32 v222, v222
    v_mfma_f32_32x32x16_bf16 v[144:159], v[60:63], v[188:191], v[144:159]
    ds_read_b64_tr_b16 a[20:21], v12 offset:61440
    ds_read_b128 v[184:187], v241 offset:18432
    s_add_u32 s54, s91, 34816
    buffer_load_dwordx4 v6, s[32:35], s54 offen offset:1024 lds
    v_exp_f32 v223, v223
    v_fma_f32 v220, v220, v215, v215
    s_waitcnt lgkmcnt(6)
    v_mfma_f32_32x32x16_bf16 v[144:159], v[64:67], v[192:195], v[144:159]
    ds_read_b64_tr_b16 a[18:19], v10 offset:62464
    ds_read_b128 v[188:191], v241 offset:19456
    v_fma_f32 v221, v221, v215, v215
    v_fma_f32 v222, v222, v215, v215
    v_fma_f32 v223, v223, v215, v215
    v_rcp_f32 v220, v220
    v_rcp_f32 v221, v221
    v_rcp_f32 v222, v222
    v_mfma_f32_32x32x16_bf16 v[144:159], v[68:71], v[196:199], v[144:159]
    ds_read_b64_tr_b16 a[22:23], v12 offset:62464
    ds_read_b128 v[192:195], v241 offset:20480
    s_add_u32 m0, s60, 28672
    s_add_u32 s54, s91, 43008
    buffer_load_dwordx4 v6, s[32:35], s54 offen offset:0 lds
    v_rcp_f32 v223, v223
    v_mfma_f32_32x32x16_bf16 v[144:159], v[72:75], v[200:203], v[144:159]
    ds_read_b64_tr_b16 a[24:25], v10 offset:63488
    ds_read_b128 v[196:199], v241 offset:21504
    v_mul_f32 v220, v164, v220
    v_mul_f32 v221, v165, v221
    v_mul_f32 v222, v166, v222
    v_mul_f32 v223, v167, v223
    v_cvt_pk_bf16_f32 v226, v220, v221
    v_cvt_pk_bf16_f32 v227, v222, v223
    v_mul_f32 v216, v168, v168
    v_mul_f32 v217, v169, v169
    v_mfma_f32_32x32x16_bf16 v[144:159], v[76:79], v[204:207], v[144:159]
    ds_read_b64_tr_b16 a[28:29], v12 offset:63488
    ds_read_b128 v[200:203], v241 offset:22528
    s_add_u32 s54, s91, 49152
    buffer_load_dwordx4 v6, s[32:35], s54 offen offset:1024 lds
    v_mul_f32 v218, v170, v170
    v_mul_f32 v219, v171, v171
    v_fma_f32 v216, v216, v214, v213
    s_waitcnt lgkmcnt(6)
    v_mfma_f32_32x32x16_bf16 v[144:159], v[80:83], v[176:179], v[144:159]
    ds_read_b128 v[204:207], v241 offset:23552
    v_fma_f32 v217, v217, v214, v213
    v_fma_f32 v218, v218, v214, v213
    v_fma_f32 v219, v219, v214, v213
    v_mul_f32 v216, v168, v216
    v_mul_f32 v217, v169, v217
    v_mul_f32 v218, v170, v218
    v_mul_f32 v219, v171, v219
    v_exp_f32 v216, v216
    v_mfma_f32_32x32x16_bf16 v[144:159], v[84:87], v[180:183], v[144:159]
    ds_read_b128 v[176:179], v241 offset:24576
    s_add_u32 m0, s60, 30720
    s_add_u32 s54, s92, 0
    buffer_load_dwordx4 v6, s[32:35], s54 offen offset:0 lds
    v_exp_f32 v217, v217
    v_exp_f32 v218, v218
    v_mfma_f32_32x32x16_bf16 v[144:159], v[88:91], v[184:187], v[144:159]
    ds_read_b128 v[180:183], v241 offset:25600
    v_exp_f32 v219, v219
    v_fma_f32 v216, v216, v215, v215
    v_fma_f32 v217, v217, v215, v215
    v_fma_f32 v218, v218, v215, v215
    v_fma_f32 v219, v219, v215, v215
    v_rcp_f32 v216, v216
    v_mfma_f32_32x32x16_bf16 v[144:159], v[92:95], v[188:191], v[144:159]
    ds_read_b128 v[184:187], v241 offset:26624
    s_add_u32 s54, s92, 6144
    buffer_load_dwordx4 v6, s[32:35], s54 offen offset:1024 lds
    v_rcp_f32 v217, v217
    v_rcp_f32 v218, v218
    s_waitcnt lgkmcnt(3)
    v_mfma_f32_32x32x16_bf16 v[144:159], v[96:99], v[192:195], v[144:159]
    ds_read_b128 v[188:191], v241 offset:27648
    v_rcp_f32 v219, v219
    s_mov_b64 exec, 15
    buffer_store_dword v13, v11, s[40:43], s3 offen sc1
    s_mov_b64 exec, -1
    s_barrier
    v_mfma_f32_32x32x16_bf16 v[144:159], v[100:103], v[196:199], v[144:159]
    ds_read_b128 v[208:211], v243 offset:1024
    ds_read_b128 v[192:195], v241 offset:28672
    s_add_u32 s54, s92, 12288
    buffer_load_dwordx4 v6, s[32:35], s54 offen offset:2048 lds
    v_mul_f32 v216, v168, v216
    v_mul_f32 v217, v169, v217
    v_mul_f32 v218, v170, v218
    v_mul_f32 v219, v171, v219
    v_mfma_f32_32x32x16_bf16 v[144:159], v[104:107], v[200:203], v[144:159]
    ds_read_b32 v132, v243 offset:1024
    ds_read_b128 v[196:199], v241 offset:29696
    v_cvt_pk_bf16_f32 v228, v216, v217
    v_cvt_pk_bf16_f32 v229, v218, v219
    v_mul_f32 v220, v172, v172
    v_mul_f32 v221, v173, v173
    v_mul_f32 v222, v174, v174
    v_mul_f32 v223, v175, v175
    v_fma_f32 v220, v220, v214, v213
    v_fma_f32 v221, v221, v214, v213
    v_mfma_f32_32x32x16_bf16 v[144:159], v[108:111], v[204:207], v[144:159]
    ds_read_b128 v[200:203], v241 offset:30720
    s_add_u32 s54, s92, 18432
    buffer_load_dwordx4 v6, s[32:35], s54 offen offset:3072 lds
    v_fma_f32 v222, v222, v214, v213
    v_fma_f32 v223, v223, v214, v213
    v_mul_f32 v220, v172, v220
    v_mul_f32 v221, v173, v221
    s_waitcnt lgkmcnt(5)
    v_mfma_f32_32x32x16_bf16 v[144:159], v[112:115], v[176:179], v[144:159]
    ds_read_b128 v[204:207], v241 offset:31744
    v_mul_f32 v222, v174, v222
    v_mul_f32 v223, v175, v223
    v_exp_f32 v220, v220
    v_exp_f32 v221, v221
    v_exp_f32 v222, v222
    v_mfma_f32_32x32x16_bf16 v[144:159], v[116:119], v[180:183], v[144:159]
    ds_read_b128 v[176:179], v241 offset:32768
    s_add_u32 m0, s60, 34816
    s_add_u32 s54, s92, 28672
    buffer_load_dwordx4 v6, s[32:35], s54 offen offset:0 lds
    v_exp_f32 v223, v223
    v_fma_f32 v220, v220, v215, v215
    v_fma_f32 v221, v221, v215, v215
    v_fma_f32 v222, v222, v215, v215
    v_mfma_f32_32x32x16_bf16 v[144:159], v[120:123], v[184:187], v[144:159]
    ds_read_b128 v[180:183], v241 offset:33792
    v_fma_f32 v223, v223, v215, v215
    v_rcp_f32 v220, v220
    v_rcp_f32 v221, v221
    v_rcp_f32 v222, v222
    v_rcp_f32 v223, v223
    v_mfma_f32_32x32x16_bf16 v[144:159], v[124:127], v[188:191], v[144:159]
    ds_read_b128 v[184:187], v241 offset:34816
    s_add_u32 m0, s60, 118784
    s_add_u32 s54, s92, 35840
    buffer_load_dwordx4 v6, s[32:35], s54 offen offset:0 lds
    v_mul_f32 v220, v172, v220
    s_waitcnt lgkmcnt(6)
    v_mfma_f32_32x32x16_bf16 v[144:159], v[128:131], v[132:135], v[144:159]
    v_mul_f32 v221, v173, v221
    v_mul_f32 v222, v174, v222
    v_mul_f32 v223, v175, v223
    v_cvt_pk_bf16_f32 v230, v220, v221
    v_cvt_pk_bf16_f32 v231, v222, v223
    buffer_store_dwordx4 v[224:227], v244, s[40:43], s25 offen sc1
    buffer_store_dwordx4 v[228:231], v244, s[40:43], s25 offen offset:1024 sc1
    s_waitcnt vmcnt(13)
    v_cmp_ne_u32 vcc, s65, v248
    s_cbranch_vccz L_ok55
    s_mov_b32 s55, 0
L_spin56:
    buffer_load_dword v248, v247, s[40:43], 0 offen offset:16 sc1
    s_waitcnt vmcnt(0)
    v_cmp_ne_u32 vcc, s65, v248
    s_cbranch_vccz L_spun57
    s_add_u32 s55, s55, 1
    s_cmp_lt_u32 s55, 1048576
    s_cbranch_scc1 L_spin56
L_spun57:
L_ok55:
    s_add_u32 s54, s70, 4718592
    s_add_u32 m0, s81, 157824
    s_nop 0
    buffer_load_dwordx4 v2, s[40:43], s54 offen sc1 lds
    s_add_u32 m0, s60, 118784
    s_waitcnt lgkmcnt(3)
    v_mfma_f32_32x32x16_bf16 v[160:175], v[16:19], v[192:195], 0
    ds_read_b128 v[188:191], v241 offset:35840
    s_add_u32 s54, s92, 41984
    buffer_load_dwordx4 v6, s[32:35], s54 offen offset:1024 lds
    v_mfma_f32_32x32x16_bf16 v[160:175], v[20:23], v[196:199], v[160:175]
    ds_read_b128 v[192:195], v241 offset:36864
    v_mul_f32 v216, v144, v144
    v_mul_f32 v217, v145, v145
    v_mul_f32 v218, v146, v146
    v_mul_f32 v219, v147, v147
    v_fma_f32 v216, v216, v210, v209
    v_fma_f32 v217, v217, v210, v209
    v_fma_f32 v218, v218, v210, v209
    v_fma_f32 v219, v219, v210, v209
    v_mul_f32 v216, v144, v216
    v_mfma_f32_32x32x16_bf16 v[160:175], v[24:27], v[200:203], v[160:175]
    s_add_u32 s54, s92, 48128
    buffer_load_dwordx4 v6, s[32:35], s54 offen offset:2048 lds
    v_mul_f32 v217, v145, v217
    v_mul_f32 v218, v146, v218
    v_mul_f32 v219, v147, v219
    s_waitcnt vmcnt(14)
    ds_read_b64_tr_b16 a[26:27], v3 offset:0
    ds_read_b128 v[196:199], v241 offset:37888
    v_mfma_f32_32x32x16_bf16 v[160:175], v[28:31], v[204:207], v[160:175]
    ds_read_b64_tr_b16 a[30:31], v4 offset:0
    ds_read_b128 v[200:203], v241 offset:38912
    v_exp_f32 v216, v216
    v_exp_f32 v217, v217
    v_exp_f32 v218, v218
    s_waitcnt lgkmcnt(5)
    v_mfma_f32_32x32x16_bf16 v[160:175], v[32:35], v[176:179], v[160:175]
    ds_read_b64_tr_b16 a[32:33], v3 offset:1024
    ds_read_b128 v[204:207], v241 offset:39936
    s_add_u32 m0, s60, 121856
    s_add_u32 s54, s93, 0
    buffer_load_dwordx4 v6, s[32:35], s54 offen offset:0 lds
    v_exp_f32 v219, v219
    v_fma_f32 v216, v216, v211, v211
    v_fma_f32 v217, v217, v211, v211
    v_mfma_f32_32x32x16_bf16 v[160:175], v[36:39], v[180:183], v[160:175]
    ds_read_b64_tr_b16 a[36:37], v4 offset:1024
    ds_read_b128 v[176:179], v241 offset:40960
    v_fma_f32 v218, v218, v211, v211
    v_fma_f32 v219, v219, v211, v211
    v_rcp_f32 v216, v216
    v_rcp_f32 v217, v217
    v_rcp_f32 v218, v218
    v_mfma_f32_32x32x16_bf16 v[160:175], v[40:43], v[184:187], v[160:175]
    ds_read_b64_tr_b16 a[34:35], v3 offset:2048
    ds_read_b128 v[180:183], v241 offset:41984
    s_add_u32 s54, s93, 6144
    buffer_load_dwordx4 v6, s[32:35], s54 offen offset:1024 lds
    v_rcp_f32 v219, v219
    v_mul_f32 v216, v144, v216
    v_mul_f32 v217, v145, v217
    v_mfma_f32_32x32x16_bf16 v[160:175], v[44:47], v[188:191], v[160:175]
    ds_read_b64_tr_b16 a[38:39], v4 offset:2048
    ds_read_b128 v[184:187], v241 offset:43008
    v_mul_f32 v218, v146, v218
    v_mul_f32 v219, v147, v219
    v_cvt_pk_bf16_f32 v224, v216, v217
    v_cvt_pk_bf16_f32 v225, v218, v219
    v_mul_f32 v220, v148, v148
    v_mul_f32 v221, v149, v149
    v_mul_f32 v222, v150, v150
    s_waitcnt lgkmcnt(6)
    v_mfma_f32_32x32x16_bf16 v[160:175], v[48:51], v[192:195], v[160:175]
    ds_read_b64_tr_b16 a[40:41], v3 offset:3072
    ds_read_b128 v[188:191], v241 offset:44032
    s_add_u32 s54, s93, 12288
    buffer_load_dwordx4 v6, s[32:35], s54 offen offset:2048 lds
    v_mul_f32 v223, v151, v151
    v_fma_f32 v220, v220, v210, v209
    v_fma_f32 v221, v221, v210, v209
    v_fma_f32 v222, v222, v210, v209
    v_mfma_f32_32x32x16_bf16 v[160:175], v[52:55], v[196:199], v[160:175]
    ds_read_b64_tr_b16 a[44:45], v4 offset:3072
    ds_read_b128 v[192:195], v241 offset:45056
    v_fma_f32 v223, v223, v210, v209
    v_mul_f32 v220, v148, v220
    v_mul_f32 v221, v149, v221
    v_mul_f32 v222, v150, v222
    v_mul_f32 v223, v151, v223
    v_exp_f32 v220, v220
    v_mfma_f32_32x32x16_bf16 v[160:175], v[56:59], v[200:203], v[160:175]
    ds_read_b64_tr_b16 a[42:43], v3 offset:4096
    ds_read_b128 v[196:199], v241 offset:46080
    v_exp_f32 v221, v221
    v_exp_f32 v222, v222
    v_exp_f32 v223, v223
    v_fma_f32 v220, v220, v211, v211
    v_fma_f32 v221, v221, v211, v211
    v_mfma_f32_32x32x16_bf16 v[160:175], v[60:63], v[204:207], v[160:175]
    ds_read_b64_tr_b16 a[46:47], v4 offset:4096
    ds_read_b128 v[200:203], v241 offset:47104
    s_add_u32 s54, s93, 18432
    buffer_load_dwordx4 v6, s[32:35], s54 offen offset:3072 lds
    v_fma_f32 v222, v222, v211, v211
    v_fma_f32 v223, v223, v211, v211
    v_rcp_f32 v220, v220
    s_waitcnt lgkmcnt(6)
    v_mfma_f32_32x32x16_bf16 v[160:175], v[64:67], v[176:179], v[160:175]
    ds_read_b64_tr_b16 a[48:49], v3 offset:5120
    ds_read_b128 v[204:207], v241 offset:48128
    v_rcp_f32 v221, v221
    v_rcp_f32 v222, v222
    v_rcp_f32 v223, v223
    v_mul_f32 v220, v148, v220
    v_mfma_f32_32x32x16_bf16 v[160:175], v[68:71], v[180:183], v[160:175]
    ds_read_b64_tr_b16 a[52:53], v4 offset:5120
    ds_read_b128 v[176:179], v241 offset:49152
    s_add_u32 m0, s60, 61440
    s_add_u32 s54, s93, 28672
    buffer_load_dwordx4 v6, s[32:35], s54 offen offset:0 lds
    v_mul_f32 v221, v149, v221
    v_mul_f32 v222, v150, v222
    v_mul_f32 v223, v151, v223
    v_mfma_f32_32x32x16_bf16 v[160:175], v[72:75], v[184:187], v[160:175]
    ds_read_b64_tr_b16 a[50:51], v3 offset:6144
    ds_read_b128 v[180:183], v241 offset:50176
    v_cvt_pk_bf16_f32 v226, v220, v221
    v_cvt_pk_bf16_f32 v227, v222, v223
    v_mul_f32 v216, v152, v152
    v_mul_f32 v217, v153, v153
    v_mul_f32 v218, v154, v154
    v_mul_f32 v219, v155, v155
    v_fma_f32 v216, v216, v210, v209
    v_fma_f32 v217, v217, v210, v209
    v_mfma_f32_32x32x16_bf16 v[160:175], v[76:79], v[188:191], v[160:175]
    ds_read_b64_tr_b16 a[54:55], v4 offset:6144
    ds_read_b128 v[184:187], v241 offset:51200
    s_add_u32 s54, s93, 34816
    buffer_load_dwordx4 v6, s[32:35], s54 offen offset:1024 lds
    v_fma_f32 v218, v218, v210, v209
    v_fma_f32 v219, v219, v210, v209
    v_mul_f32 v216, v152, v216
    s_waitcnt lgkmcnt(6)
    v_mfma_f32_32x32x16_bf16 v[160:175], v[80:83], v[192:195], v[160:175]
    ds_read_b128 v[188:191], v241 offset:52224
    v_mul_f32 v217, v153, v217
    v_mul_f32 v218, v154, v218
    v_mul_f32 v219, v155, v219
    v_exp_f32 v216, v216
    v_exp_f32 v217, v217
    v_exp_f32 v218, v218
    v_mfma_f32_32x32x16_bf16 v[160:175], v[84:87], v[196:199], v[160:175]
    ds_read_b128 v[192:195], v241 offset:53248
    s_add_u32 s54, s93, 40960
    buffer_load_dwordx4 v6, s[32:35], s54 offen offset:2048 lds
    v_exp_f32 v219, v219
    v_fma_f32 v216, v216, v211, v211
    v_fma_f32 v217, v217, v211, v211
    v_fma_f32 v218, v218, v211, v211
    v_mfma_f32_32x32x16_bf16 v[160:175], v[88:91], v[200:203], v[160:175]
    ds_read_b128 v[196:199], v241 offset:54272
    v_fma_f32 v219, v219, v211, v211
    v_rcp_f32 v216, v216
    v_rcp_f32 v217, v217
    v_rcp_f32 v218, v218
    v_rcp_f32 v219, v219
    v_mfma_f32_32x32x16_bf16 v[160:175], v[92:95], v[204:207], v[160:175]
    ds_read_b128 v[200:203], v241 offset:55296
    v_mul_f32 v216, v152, v216
    v_mul_f32 v217, v153, v217
    v_mul_f32 v218, v154, v218
    v_mul_f32 v219, v155, v219
    v_cvt_pk_bf16_f32 v228, v216, v217
    v_cvt_pk_bf16_f32 v229, v218, v219
    v_mul_f32 v220, v156, v156
    v_mul_f32 v221, v157, v157
    s_waitcnt lgkmcnt(3)
    v_mfma_f32_32x32x16_bf16 v[160:175], v[96:99], v[176:179], v[160:175]
    ds_read_b128 v[204:207], v241 offset:56320
    s_add_u32 s54, s93, 47104
    buffer_load_dwordx4 v6, s[32:35], s54 offen offset:3072 lds
    v_mul_f32 v222, v158, v158
    v_mul_f32 v223, v159, v159
    v_fma_f32 v220, v220, v210, v209
    s_waitcnt vmcnt(10)
    s_barrier
    v_mfma_f32_32x32x16_bf16 v[160:175], v[100:103], v[180:183], v[160:175]
    ds_read_b128 v[48:51], v246 offset:3584
    ds_read2_b32 v[16:17], v232 offset0:0 offset1:1
    ds_read2_b32 v[18:19], v232 offset0:2 offset1:3
    ds_read_b128 v[212:215], v243 offset:1536
    v_fma_f32 v221, v221, v210, v209
    v_fma_f32 v222, v222, v210, v209
    v_fma_f32 v223, v223, v210, v209
    v_mul_f32 v220, v156, v220
    v_mul_f32 v221, v157, v221
    v_mul_f32 v222, v158, v222
    v_mfma_f32_32x32x16_bf16 v[160:175], v[104:107], v[184:187], v[160:175]
    ds_read_b128 v[52:55], v246 offset:3072
    ds_read2_b32 v[20:21], v232 offset0:128 offset1:129
    ds_read2_b32 v[22:23], v232 offset0:130 offset1:131
    ds_read_b32 v132, v243 offset:1536
    s_add_u32 m0, s60, 65536
    s_add_u32 s54, s94, 0
    buffer_load_dwordx4 v6, s[32:35], s54 offen offset:0 lds
    v_mul_f32 v223, v159, v223
    v_mfma_f32_32x32x16_bf16 v[160:175], v[108:111], v[188:191], v[160:175]
    ds_read_b128 v[56:59], v246 offset:2560
    ds_read2_b32 v[24:25], v233 offset0:0 offset1:1
    ds_read2_b32 v[26:27], v233 offset0:2 offset1:3
    v_exp_f32 v220, v220
    v_exp_f32 v221, v221
    v_exp_f32 v222, v222
    s_waitcnt lgkmcnt(11)
    v_mfma_f32_32x32x16_bf16 v[160:175], v[112:115], v[192:195], v[160:175]
    ds_read_b128 v[60:63], v246 offset:2048
    ds_read2_b32 v[28:29], v233 offset0:128 offset1:129
    ds_read2_b32 v[30:31], v233 offset0:130 offset1:131
    s_add_u32 s54, s94, 6144
    buffer_load_dwordx4 v6, s[32:35], s54 offen offset:1024 lds
    v_exp_f32 v223, v223
    v_fma_f32 v220, v220, v211, v211
    v_mfma_f32_32x32x16_bf16 v[160:175], v[116:119], v[196:199], v[160:175]
    ds_read_b128 v[64:67], v246 offset:1536
    ds_read2_b32 v[32:33], v234 offset0:0 offset1:1
    ds_read2_b32 v[34:35], v234 offset0:2 offset1:3
    v_fma_f32 v221, v221, v211, v211
    v_fma_f32 v222, v222, v211, v211
    v_fma_f32 v223, v223, v211, v211
    v_rcp_f32 v220, v220
    v_rcp_f32 v221, v221
    v_mfma_f32_32x32x16_bf16 v[160:175], v[120:123], v[200:203], v[160:175]
    ds_read_b128 v[68:71], v246 offset:1024
    ds_read2_b32 v[36:37], v234 offset0:128 offset1:129
    ds_read2_b32 v[38:39], v234 offset0:130 offset1:131
    s_add_u32 s54, s94, 12288
    buffer_load_dwordx4 v6, s[32:35], s54 offen offset:2048 lds
    v_rcp_f32 v222, v222
    v_mfma_f32_32x32x16_bf16 v[160:175], v[124:127], v[204:207], v[160:175]
    ds_read_b128 v[72:75], v246 offset:512
    ds_read2_b32 v[40:41], v235 offset0:0 offset1:1
    ds_read2_b32 v[42:43], v235 offset0:2 offset1:3
    v_rcp_f32 v223, v223
    v_mul_f32 v220, v156, v220
    v_mul_f32 v221, v157, v221
    v_mul_f32 v222, v158, v222
    v_mul_f32 v223, v159, v223
    s_waitcnt lgkmcnt(15)
    v_mfma_f32_32x32x16_bf16 v[160:175], v[128:131], v[132:135], v[160:175]
    ds_read_b128 v[76:79], v246 offset:0
    ds_read2_b32 v[44:45], v235 offset0:128 offset1:129
    ds_read2_b32 v[46:47], v235 offset0:130 offset1:131
    v_cvt_pk_bf16_f32 v230, v220, v221
    v_cvt_pk_bf16_f32 v231, v222, v223
    buffer_store_dwordx4 v[224:227], v244, s[40:43], s26 offen sc1
    buffer_store_dwordx4 v[228:231], v244, s[40:43], s26 offen offset:1024 sc1
    s_lshl_b32 s101, s48, 6
    s_add_u32 s101, s101, s3
    s_load_dwordx16 s[4:19], s[40:41], s101
    s_nop 1
    v_pk_mul_f32 v[216:217], v[160:161], v[160:161]
    s_add_u32 m0, s60, 0
    s_add_u32 s54, s94, 21504
    buffer_load_dwordx4 v6, s[32:35], s54 offen offset:0 lds
    v_pk_mul_f32 v[218:219], v[162:163], v[162:163]
    v_pk_mul_f32 v[220:221], v[164:165], v[164:165]
    v_pk_mul_f32 v[222:223], v[166:167], v[166:167]
    v_pk_fma_f32 v[216:217], v[216:217], v[214:215], v[212:213] op_sel:[0,0,1] op_sel_hi:[1,0,1]
    v_pk_fma_f32 v[218:219], v[218:219], v[214:215], v[212:213] op_sel:[0,0,1] op_sel_hi:[1,0,1]
    v_pk_fma_f32 v[220:221], v[220:221], v[214:215], v[212:213] op_sel:[0,0,1] op_sel_hi:[1,0,1]
    v_pk_fma_f32 v[222:223], v[222:223], v[214:215], v[212:213] op_sel:[0,0,1] op_sel_hi:[1,0,1]
    v_pk_mul_f32 v[216:217], v[160:161], v[216:217]
    v_pk_mul_f32 v[218:219], v[162:163], v[218:219]
    v_pk_mul_f32 v[220:221], v[164:165], v[220:221]
    s_add_u32 s54, s94, 27648
    buffer_load_dwordx4 v6, s[32:35], s54 offen offset:1024 lds
    v_pk_mul_f32 v[222:223], v[166:167], v[222:223]
    v_exp_f32 v216, v216
    v_exp_f32 v217, v217
    v_exp_f32 v218, v218
    v_exp_f32 v219, v219
    v_exp_f32 v220, v220
    v_exp_f32 v221, v221
    v_exp_f32 v222, v222
    v_exp_f32 v223, v223
    v_pk_fma_f32 v[216:217], v[216:217], v[214:215], v[214:215] op_sel:[0,1,1] op_sel_hi:[1,1,1]
    s_add_u32 s54, s94, 33792
    buffer_load_dwordx4 v6, s[32:35], s54 offen offset:2048 lds
    v_pk_fma_f32 v[218:219], v[218:219], v[214:215], v[214:215] op_sel:[0,1,1] op_sel_hi:[1,1,1]
    v_pk_fma_f32 v[220:221], v[220:221], v[214:215], v[214:215] op_sel:[0,1,1] op_sel_hi:[1,1,1]
    v_pk_fma_f32 v[222:223], v[222:223], v[214:215], v[214:215] op_sel:[0,1,1] op_sel_hi:[1,1,1]
    v_rcp_f32 v216, v216
    v_rcp_f32 v217, v217
    v_rcp_f32 v218, v218
    v_rcp_f32 v219, v219
    v_rcp_f32 v220, v220
    v_rcp_f32 v221, v221
    v_rcp_f32 v222, v222
    s_add_u32 s54, s94, 39936
    buffer_load_dwordx4 v6, s[32:35], s54 offen offset:3072 lds
    v_rcp_f32 v223, v223
    v_pk_mul_f32 v[216:217], v[160:161], v[216:217]
    v_pk_mul_f32 v[218:219], v[162:163], v[218:219]
    v_pk_mul_f32 v[220:221], v[164:165], v[220:221]
    v_pk_mul_f32 v[222:223], v[166:167], v[222:223]
    v_cvt_pk_bf16_f32 v224, v216, v217
    v_cvt_pk_bf16_f32 v225, v218, v219
    v_cvt_pk_bf16_f32 v226, v220, v221
    v_cvt_pk_bf16_f32 v227, v222, v223
    s_mov_b32 s55, 0
L_cl58:
    s_waitcnt lgkmcnt(0)
    s_and_b64 s[20:21], s[4:5], s[6:7]
    s_or_b64 s[22:23], s[4:5], s[6:7]
    s_and_b64 s[20:21], s[20:21], s[8:9]
    s_or_b64 s[22:23], s[22:23], s[8:9]
    s_and_b64 s[20:21], s[20:21], s[10:11]
    s_or_b64 s[22:23], s[22:23], s[10:11]
    s_and_b64 s[20:21], s[20:21], s[12:13]
    s_or_b64 s[22:23], s[22:23], s[12:13]
    s_and_b64 s[20:21], s[20:21], s[14:15]
    s_or_b64 s[22:23], s[22:23], s[14:15]
    s_and_b64 s[20:21], s[20:21], s[16:17]
    s_or_b64 s[22:23], s[22:23], s[16:17]
    s_and_b32 s20, s20, s21
    s_or_b32 s21, s22, s23
    s_cmp_eq_u64 s[20:21], s[64:65]
    s_cbranch_scc1 L_ce59
    s_add_u32 s55, s55, 1
    s_cmp_eq_u32 s55, 4
    s_cbranch_scc1 L_cv61
    s_add_u32 s101, s101, 256
    s_load_dwordx16 s[4:19], s[40:41], s101
    s_branch L_cl58
L_cv61:
    v_and_b32 v9, 15, v1
    v_min_u32 v9, 13, v9
    v_and_b32 v250, 48, v1
    v_add_lshl_u32 v9, v9, v250, 2
    v_add_u32 v9, s3, v9
    v_subrev_u32 v9, 16, v9
    s_mov_b32 s55, 0
L_spin62:
    buffer_load_dword v250, v9, s[40:43], 0 offen offset:16 sc1
    s_waitcnt vmcnt(0)
    v_cmp_ne_u32 vcc, s65, v250
    s_cbranch_vccz L_spun63
    s_add_u32 s55, s55, 1
    s_cmp_lt_u32 s55, 1048576
    s_cbranch_scc1 L_spin62
L_spun63:
L_ce59:
    s_barrier
    buffer_store_dwordx4 v[224:227], v244, s[40:43], s27 offen offset:0 sc1
    v_pk_mul_f32 v[216:217], v[168:169], v[168:169]
    s_add_u32 m0, s60, 4096
    s_add_u32 s54, s94, 50176
    buffer_load_dwordx4 v6, s[32:35], s54 offen offset:0 lds
    v_pk_mul_f32 v[218:219], v[170:171], v[170:171]
    v_pk_mul_f32 v[220:221], v[172:173], v[172:173]
    v_pk_mul_f32 v[222:223], v[174:175], v[174:175]
    v_pk_fma_f32 v[216:217], v[216:217], v[214:215], v[212:213] op_sel:[0,0,1] op_sel_hi:[1,0,1]
    v_pk_fma_f32 v[218:219], v[218:219], v[214:215], v[212:213] op_sel:[0,0,1] op_sel_hi:[1,0,1]
    v_pk_fma_f32 v[220:221], v[220:221], v[214:215], v[212:213] op_sel:[0,0,1] op_sel_hi:[1,0,1]
    v_pk_fma_f32 v[222:223], v[222:223], v[214:215], v[212:213] op_sel:[0,0,1] op_sel_hi:[1,0,1]
    v_pk_mul_f32 v[216:217], v[168:169], v[216:217]
    v_pk_mul_f32 v[218:219], v[170:171], v[218:219]
    v_pk_mul_f32 v[220:221], v[172:173], v[220:221]
    v_pk_mul_f32 v[222:223], v[174:175], v[222:223]
    v_exp_f32 v216, v216
    v_exp_f32 v217, v217
    v_exp_f32 v218, v218
    v_exp_f32 v219, v219
    v_exp_f32 v220, v220
    v_exp_f32 v221, v221
    v_exp_f32 v222, v222
    v_exp_f32 v223, v223
    v_pk_fma_f32 v[216:217], v[216:217], v[214:215], v[214:215] op_sel:[0,1,1] op_sel_hi:[1,1,1]
    v_pk_fma_f32 v[218:219], v[218:219], v[214:215], v[214:215] op_sel:[0,1,1] op_sel_hi:[1,1,1]
    v_pk_fma_f32 v[220:221], v[220:221], v[214:215], v[214:215] op_sel:[0,1,1] op_sel_hi:[1,1,1]
    v_pk_fma_f32 v[222:223], v[222:223], v[214:215], v[214:215] op_sel:[0,1,1] op_sel_hi:[1,1,1]
    v_rcp_f32 v216, v216
    v_rcp_f32 v217, v217
    v_rcp_f32 v218, v218
    v_rcp_f32 v219, v219
    v_rcp_f32 v220, v220
    v_rcp_f32 v221, v221
    v_rcp_f32 v222, v222
    v_rcp_f32 v223, v223
    v_pk_mul_f32 v[216:217], v[168:169], v[216:217]
    v_pk_mul_f32 v[218:219], v[170:171], v[218:219]
    v_pk_mul_f32 v[220:221], v[172:173], v[220:221]
    v_pk_mul_f32 v[222:223], v[174:175], v[222:223]
    v_cvt_pk_bf16_f32 v228, v216, v217
    v_cvt_pk_bf16_f32 v229, v218, v219
    v_cvt_pk_bf16_f32 v230, v220, v221
    v_cvt_pk_bf16_f32 v231, v222, v223
    buffer_store_dwordx4 v[228:231], v244, s[40:43], s27 offen offset:1024 sc1
    v_mfma_f32_16x16x32_bf16 v[176:179], v[236:239], v[48:51], 0
    s_add_u32 m0, s60, 5120
    s_add_u32 s54, s95, 0
    buffer_load_dwordx4 v6, s[32:35], s54 offen offset:0 lds
    ds_read_b64_tr_b16 a[56:57], v3 offset:28672
    v_mfma_f32_16x16x32_bf16 v[180:183], v[236:239], v[52:55], 0
    ds_read_b64_tr_b16 a[60:61], v4 offset:28672
    v_mfma_f32_16x16x32_bf16 v[184:187], v[236:239], v[56:59], 0
    ds_read_b64_tr_b16 a[58:59], v3 offset:29696
    v_mfma_f32_16x16x32_bf16 v[188:191], v[236:239], v[60:63], 0
    ds_read_b64_tr_b16 a[62:63], v4 offset:29696
    v_mfma_f32_16x16x32_bf16 v[192:195], v[236:239], v[64:67], 0
    ds_read_b64_tr_b16 a[64:65], v3 offset:30720
    s_add_u32 s54, s95, 6144
    buffer_load_dwordx4 v6, s[32:35], s54 offen offset:1024 lds
    v_mfma_f32_16x16x32_bf16 v[196:199], v[236:239], v[68:71], 0
    ds_read_b64_tr_b16 a[68:69], v4 offset:30720
    v_mfma_f32_16x16x32_bf16 v[200:203], v[236:239], v[72:75], 0
    ds_read_b64_tr_b16 a[66:67], v3 offset:31744
    s_and_b32 s58, s49, 1
    v_mfma_f32_16x16x32_bf16 v[204:207], v[236:239], v[76:79], 0
    ds_read_b64_tr_b16 a[70:71], v4 offset:31744
    s_sub_u32 s56, s26, s24
    v_mfma_f32_16x16x32_bf16 v[176:179], v[16:19], v[48:51], v[176:179]
    ds_read_b64_tr_b16 a[72:73], v3 offset:32768
    s_mul_i32 s56, s56, s58
    s_add_u32 s56, s56, s24
    v_mfma_f32_16x16x32_bf16 v[180:183], v[16:19], v[52:55], v[180:183]
    ds_read_b64_tr_b16 a[76:77], v4 offset:32768
    s_add_u32 m0, s60, 90112
    s_add_u32 s54, s95, 14336
    buffer_load_dwordx4 v6, s[32:35], s54 offen offset:0 lds
    v_mfma_f32_16x16x32_bf16 v[184:187], v[16:19], v[56:59], v[184:187]
    ds_read_b64_tr_b16 a[74:75], v3 offset:33792
    v_mfma_f32_16x16x32_bf16 v[188:191], v[16:19], v[60:63], v[188:191]
    ds_read_b64_tr_b16 a[78:79], v4 offset:33792
    v_mfma_f32_16x16x32_bf16 v[192:195], v[16:19], v[64:67], v[192:195]
    ds_read_b64_tr_b16 a[80:81], v3 offset:34816
    s_sub_u32 s57, s27, s25
    v_mfma_f32_16x16x32_bf16 v[196:199], v[16:19], v[68:71], v[196:199]
    ds_read_b64_tr_b16 a[84:85], v4 offset:34816
    s_mul_i32 s57, s57, s58
    v_mfma_f32_16x16x32_bf16 v[200:203], v[16:19], v[72:75], v[200:203]
    ds_read_b128 v[112:115], v246 offset:3648
    s_add_u32 s54, s95, 20480
    buffer_load_dwordx4 v6, s[32:35], s54 offen offset:1024 lds
    v_mfma_f32_16x16x32_bf16 v[204:207], v[16:19], v[76:79], v[204:207]
    ds_read2_b32 v[80:81], v232 offset0:16 offset1:17
    v_mfma_f32_16x16x32_bf16 v[180:183], v[20:23], v[48:51], v[180:183]
    ds_read2_b32 v[82:83], v232 offset0:18 offset1:19
    s_add_u32 s57, s57, s25
    v_mfma_f32_16x16x32_bf16 v[184:187], v[20:23], v[52:55], v[184:187]
    ds_read_b128 v[116:119], v246 offset:3136
    s_lshr_b32 s58, s48, 1
    v_mfma_f32_16x16x32_bf16 v[188:191], v[20:23], v[56:59], v[188:191]
    ds_read2_b32 v[84:85], v232 offset0:144 offset1:145
    s_sub_u32 s59, s57, s56
    s_mul_i32 s59, s59, s58
    v_mfma_f32_16x16x32_bf16 v[192:195], v[20:23], v[60:63], v[192:195]
    s_add_u32 s54, s95, 26624
    buffer_load_dwordx4 v6, s[32:35], s54 offen offset:2048 lds
    v_mfma_f32_16x16x32_bf16 v[196:199], v[20:23], v[64:67], v[196:199]
    ds_read2_b32 v[86:87], v232 offset0:146 offset1:147
    v_mfma_f32_16x16x32_bf16 v[200:203], v[20:23], v[68:71], v[200:203]
    ds_read_b128 v[120:123], v246 offset:2624
    s_add_u32 s56, s56, s59
    v_mfma_f32_16x16x32_bf16 v[204:207], v[20:23], v[72:75], v[204:207]
    ds_read2_b32 v[88:89], v233 offset0:16 offset1:17
    s_sub_u32 s57, s57, s59
    s_mul_i32 s59, s71, 28672
    v_mfma_f32_16x16x32_bf16 v[184:187], v[24:27], v[48:51], v[184:187]
    ds_read2_b32 v[90:91], v233 offset0:18 offset1:19
    s_add_u32 s56, s56, s59
    s_waitcnt vmcnt(5)
    s_mov_b64 exec, 15
    buffer_store_dword v13, v11, s[40:43], s97 offen sc1
    s_mov_b64 exec, -1
    v_mfma_f32_16x16x32_bf16 v[188:191], v[24:27], v[52:55], v[188:191]
    ds_read_b128 v[124:127], v246 offset:2112
    s_add_u32 s54, s95, 32768
    buffer_load_dwordx4 v6, s[32:35], s54 offen offset:3072 lds
    v_mfma_f32_16x16x32_bf16 v[192:195], v[24:27], v[56:59], v[192:195]
    ds_read2_b32 v[92:93], v233 offset0:144 offset1:145
    v_mfma_f32_16x16x32_bf16 v[196:199], v[24:27], v[60:63], v[196:199]
    ds_read2_b32 v[94:95], v233 offset0:146 offset1:147
    s_add_u32 s57, s57, s59
    v_mfma_f32_16x16x32_bf16 v[200:203], v[24:27], v[64:67], v[200:203]
    ds_read_b128 v[128:131], v246 offset:1600
    v_add_u32 v240, s56, v2
    v_mfma_f32_16x16x32_bf16 v[204:207], v[24:27], v[68:71], v[204:207]
    ds_read2_b32 v[96:97], v234 offset0:16 offset1:17
    v_add_u32 v241, s57, v2
    s_bfe_u32 s82, s98, 196608
    v_mfma_f32_16x16x32_bf16 v[188:191], v[28:31], v[48:51], v[188:191]
    ds_read2_b32 v[98:99], v234 offset0:18 offset1:19
    s_add_u32 m0, s60, 94208
    s_add_u32 s54, s95, 43008
    buffer_load_dwordx4 v6, s[32:35], s54 offen offset:0 lds
    v_mfma_f32_16x16x32_bf16 v[192:195], v[28:31], v[52:55], v[192:195]
    ds_read_b128 v[132:135], v246 offset:1088
    v_mfma_f32_16x16x32_bf16 v[196:199], v[28:31], v[56:59], v[196:199]
    ds_read2_b32 v[100:101], v234 offset0:144 offset1:145
    v_mfma_f32_16x16x32_bf16 v[200:203], v[28:31], v[60:63], v[200:203]
    ds_read2_b32 v[102:103], v234 offset0:146 offset1:147
    s_lshl_b32 s82, s82, 12
    v_mfma_f32_16x16x32_bf16 v[204:207], v[28:31], v[64:67], v[204:207]
    ds_read_b128 v[136:139], v246 offset:576
    s_bfe_u32 s83, s98, 196612
    v_mfma_f32_16x16x32_bf16 v[192:195], v[32:35], v[48:51], v[192:195]
    ds_read2_b32 v[104:105], v235 offset0:16 offset1:17
    s_add_u32 s54, s95, 49152
    buffer_load_dwordx4 v6, s[32:35], s54 offen offset:1024 lds
    v_mfma_f32_16x16x32_bf16 v[196:199], v[32:35], v[52:55], v[196:199]
    ds_read2_b32 v[106:107], v235 offset0:18 offset1:19
    v_mfma_f32_16x16x32_bf16 v[200:203], v[32:35], v[56:59], v[200:203]
    ds_read_b128 v[140:143], v246 offset:64
    s_lshl_b32 s83, s83, 12
    v_mfma_f32_16x16x32_bf16 v[204:207], v[32:35], v[60:63], v[204:207]
    ds_read2_b32 v[108:109], v235 offset0:144 offset1:145
    s_bfe_u32 s84, s98, 196616
    v_mfma_f32_16x16x32_bf16 v[196:199], v[36:39], v[48:51], v[196:199]
    ds_read2_b32 v[110:111], v235 offset0:146 offset1:147
    s_lshl_b32 s84, s84, 12
    s_bfe_u32 s85, s98, 196620
    v_mfma_f32_16x16x32_bf16 v[200:203], v[36:39], v[52:55], v[200:203]
    s_add_u32 m0, s60, 96256
    s_add_u32 s54, s96, 0
    buffer_load_dwordx4 v6, s[32:35], s54 offen offset:0 lds
    v_mfma_f32_16x16x32_bf16 v[204:207], v[36:39], v[56:59], v[204:207]
    v_mfma_f32_16x16x32_bf16 v[200:203], v[40:43], v[48:51], v[200:203]
    s_lshl_b32 s85, s85, 12
    s_bfe_u32 s86, s98, 196624
    v_mfma_f32_16x16x32_bf16 v[204:207], v[40:43], v[52:55], v[204:207]
    s_lshl_b32 s86, s86, 12
    s_bfe_u32 s87, s98, 196628
    s_lshl_b32 s87, s87, 12
    v_mfma_f32_16x16x32_bf16 v[204:207], v[44:47], v[48:51], v[204:207]
    s_bfe_u32 s88, s98, 196632
    s_lshl_b32 s88, s88, 12
    s_waitcnt lgkmcnt(0)
    v_mfma_f32_16x16x32_bf16 v[176:179], v[80:83], v[112:115], v[176:179]
    s_add_u32 m0, s60, 28672
    s_add_u32 s54, s96, 7168
    buffer_load_dwordx4 v6, s[32:35], s54 offen offset:0 lds
    ds_read_b64_tr_b16 a[82:83], v10 offset:57344
    v_mfma_f32_16x16x32_bf16 v[180:183], v[80:83], v[116:119], v[180:183]
    ds_read_b64_tr_b16 a[86:87], v12 offset:57344
    v_mfma_f32_16x16x32_bf16 v[184:187], v[80:83], v[120:123], v[184:187]
    ds_read_b64_tr_b16 a[88:89], v10 offset:58368
    v_mfma_f32_16x16x32_bf16 v[188:191], v[80:83], v[124:127], v[188:191]
    ds_read_b64_tr_b16 a[92:93], v12 offset:58368
    v_mfma_f32_16x16x32_bf16 v[192:195], v[80:83], v[128:131], v[192:195]
    ds_read_b64_tr_b16 a[90:91], v10 offset:59392
    s_add_u32 s54, s96, 13312
    buffer_load_dwordx4 v6, s[32:35], s54 offen offset:1024 lds
    v_mfma_f32_16x16x32_bf16 v[196:199], v[80:83], v[132:135], v[196:199]
    ds_read_b64_tr_b16 a[94:95], v12 offset:59392
    v_mfma_f32_16x16x32_bf16 v[200:203], v[80:83], v[136:139], v[200:203]
    ds_read_b64_tr_b16 a[96:97], v10 offset:60416
    v_mfma_f32_16x16x32_bf16 v[204:207], v[80:83], v[140:143], v[204:207]
    v_mfma_f32_16x16x32_bf16 v[180:183], v[84:87], v[112:115], v[180:183]
    ds_read_b64_tr_b16 a[100:101], v12 offset:60416
    v_mfma_f32_16x16x32_bf16 v[184:187], v[84:87], v[116:119], v[184:187]
    ds_read_b64_tr_b16 a[98:99], v10 offset:61440
    s_add_u32 s54, s96, 19456
    buffer_load_dwordx4 v6, s[32:35], s54 offen offset:2048 lds
    v_mfma_f32_16x16x32_bf16 v[188:191], v[84:87], v[120:123], v[188:191]
    ds_read_b64_tr_b16 a[102:103], v12 offset:61440
    v_mfma_f32_16x16x32_bf16 v[192:195], v[84:87], v[124:127], v[192:195]
    ds_read_b64_tr_b16 a[104:105], v10 offset:62464
    s_lshl_b32 s101, s48, 6
    s_add_u32 s101, s101, s97
    s_load_dwordx16 s[4:19], s[40:41], s101
    v_mfma_f32_16x16x32_bf16 v[196:199], v[84:87], v[128:131], v[196:199]
    ds_read_b64_tr_b16 a[108:109], v12 offset:62464
    v_mfma_f32_16x16x32_bf16 v[200:203], v[84:87], v[132:135], v[200:203]
    ds_read_b64_tr_b16 a[106:107], v10 offset:63488
    v_mfma_f32_16x16x32_bf16 v[204:207], v[84:87], v[136:139], v[204:207]
    ds_read_b64_tr_b16 a[110:111], v12 offset:63488
    s_add_u32 s54, s96, 25600
    buffer_load_dwordx4 v6, s[32:35], s54 offen offset:3072 lds
    v_mfma_f32_16x16x32_bf16 v[184:187], v[88:91], v[112:115], v[184:187]
    v_mfma_f32_16x16x32_bf16 v[188:191], v[88:91], v[116:119], v[188:191]
    ds_read_b64_tr_b16 a[112:113], v10 offset:0
    v_mfma_f32_16x16x32_bf16 v[192:195], v[88:91], v[120:123], v[192:195]
    ds_read_b64_tr_b16 a[116:117], v12 offset:0
    v_mfma_f32_16x16x32_bf16 v[196:199], v[88:91], v[124:127], v[196:199]
    ds_read_b64_tr_b16 a[114:115], v10 offset:1024
    s_add_u32 s56, s60, 61440
    v_mfma_f32_16x16x32_bf16 v[200:203], v[88:91], v[128:131], v[200:203]
    ds_read_b64_tr_b16 a[118:119], v12 offset:1024
    s_add_u32 m0, s60, 32768
    s_add_u32 s54, s96, 35840
    buffer_load_dwordx4 v6, s[32:35], s54 offen offset:0 lds
    v_mfma_f32_16x16x32_bf16 v[204:207], v[88:91], v[132:135], v[204:207]
    ds_read_b64_tr_b16 a[120:121], v10 offset:2048
    v_mfma_f32_16x16x32_bf16 v[188:191], v[92:95], v[112:115], v[188:191]
    ds_read_b64_tr_b16 a[124:125], v12 offset:2048
    v_mfma_f32_16x16x32_bf16 v[192:195], v[92:95], v[116:119], v[192:195]
    ds_read_b64_tr_b16 a[122:123], v10 offset:3072
    v_mfma_f32_16x16x32_bf16 v[196:199], v[92:95], v[120:123], v[196:199]
    v_add_u32 v230, s56, v2
    v_mfma_f32_16x16x32_bf16 v[200:203], v[92:95], v[124:127], v[200:203]
    ds_read_b64_tr_b16 a[126:127], v12 offset:3072
    s_add_u32 s54, s96, 41984
    buffer_load_dwordx4 v6, s[32:35], s54 offen offset:1024 lds
    v_mfma_f32_16x16x32_bf16 v[204:207], v[92:95], v[128:131], v[204:207]
    ds_read_b64_tr_b16 a[128:129], v10 offset:4096
    v_mfma_f32_16x16x32_bf16 v[192:195], v[96:99], v[112:115], v[192:195]
    ds_read_b64_tr_b16 a[132:133], v12 offset:4096
    v_mfma_f32_16x16x32_bf16 v[196:199], v[96:99], v[116:119], v[196:199]
    ds_read_b64_tr_b16 a[130:131], v10 offset:5120
    v_mfma_f32_16x16x32_bf16 v[200:203], v[96:99], v[120:123], v[200:203]
    ds_read_b64_tr_b16 a[134:135], v12 offset:5120
    v_mfma_f32_16x16x32_bf16 v[204:207], v[96:99], v[124:127], v[204:207]
    ds_read_b64_tr_b16 a[136:137], v10 offset:6144
    s_add_u32 s54, s96, 48128
    buffer_load_dwordx4 v6, s[32:35], s54 offen offset:2048 lds
    v_mfma_f32_16x16x32_bf16 v[196:199], v[100:103], v[112:115], v[196:199]
    ds_read_b64_tr_b16 a[140:141], v12 offset:6144
    v_mfma_f32_16x16x32_bf16 v[200:203], v[100:103], v[116:119], v[200:203]
    s_lshl_b32 s56, s48, 11
    v_mfma_f32_16x16x32_bf16 v[204:207], v[100:103], v[120:123], v[204:207]
    s_add_u32 s56, s56, 118784
    v_mfma_f32_16x16x32_bf16 v[200:203], v[104:107], v[112:115], v[200:203]
    v_add_u32 v231, s56, v2
    s_add_u32 s57, s48, 1
    v_mfma_f32_16x16x32_bf16 v[204:207], v[104:107], v[116:119], v[204:207]
    s_lshr_b32 s57, s57, 2
    s_mul_i32 s57, s57, 64512
    v_mfma_f32_16x16x32_bf16 v[204:207], v[108:111], v[112:115], v[204:207]
    s_sub_u32 s56, s56, s57
    v_add_u32 v247, s56, v2
    s_waitcnt lgkmcnt(0)
    s_mov_b32 s55, 0
L_cl64:
    s_waitcnt lgkmcnt(0)
    s_and_b64 s[20:21], s[4:5], s[6:7]
    s_or_b64 s[22:23], s[4:5], s[6:7]
    s_and_b64 s[20:21], s[20:21], s[8:9]
    s_or_b64 s[22:23], s[22:23], s[8:9]
    s_and_b64 s[20:21], s[20:21], s[10:11]
    s_or_b64 s[22:23], s[22:23], s[10:11]
    s_and_b64 s[20:21], s[20:21], s[12:13]
    s_or_b64 s[22:23], s[22:23], s[12:13]
    s_and_b64 s[20:21], s[20:21], s[14:15]
    s_or_b64 s[22:23], s[22:23], s[14:15]
    s_and_b64 s[20:21], s[20:21], s[16:17]
    s_or_b64 s[22:23], s[22:23], s[16:17]
    s_and_b32 s20, s20, s21
    s_or_b32 s21, s22, s23
    s_cmp_eq_u64 s[20:21], s[64:65]
    s_cbranch_scc1 L_ce65
    s_add_u32 s55, s55, 1
    s_cmp_eq_u32 s55, 4
    s_cbranch_scc1 L_cv67
    s_add_u32 s101, s101, 256
    s_load_dwordx16 s[4:19], s[40:41], s101
    s_branch L_cl64
L_cv67:
    v_and_b32 v9, 15, v1
    v_min_u32 v9, 13, v9
    v_and_b32 v250, 48, v1
    v_add_lshl_u32 v9, v9, v250, 2
    v_add_u32 v9, s97, v9
    v_subrev_u32 v9, 16, v9
    s_mov_b32 s55, 0
L_spin68:
    buffer_load_dword v250, v9, s[40:43], 0 offen offset:16 sc1
    s_waitcnt vmcnt(0)
    v_cmp_ne_u32 vcc, s65, v250
    s_cbranch_vccz L_spun69
    s_add_u32 s55, s55, 1
    s_cmp_lt_u32 s55, 1048576
    s_cbranch_scc1 L_spin68
L_spun69:
L_ce65:
    s_barrier
    buffer_load_dwordx4 v[80:83], v241, s[40:43], s82 offen offset:0 sc1
    buffer_load_dwordx4 v[84:87], v241, s[40:43], s82 offen offset:1024 sc1
    ds_write_b128 v230, v[176:179] offset:57344
    buffer_load_dwordx4 v[88:91], v241, s[40:43], s82 offen offset:2048 sc1
    ds_write_b128 v230, v[180:183] offset:58368
    ds_write_b128 v230, v[184:187] offset:59392
    buffer_load_dwordx4 v[92:95], v241, s[40:43], s82 offen offset:3072 sc1
    ds_write_b128 v230, v[188:191] offset:60416
    ds_write_b128 v230, v[192:195] offset:61440
    buffer_load_dwordx4 v[96:99], v241, s[40:43], s83 offen offset:0 sc1
    ds_write_b128 v230, v[196:199] offset:62464
    ds_write_b128 v230, v[200:203] offset:63488
    buffer_load_dwordx4 v[100:103], v241, s[40:43], s83 offen offset:1024 sc1
    ds_write_b128 v230, v[204:207] offset:0
    s_waitcnt lgkmcnt(0)
    s_barrier
    buffer_load_dwordx4 v[104:107], v241, s[40:43], s83 offen offset:2048 sc1
    ds_read_b128 v[176:179], v231 offset:0
    ds_read_b128 v[180:183], v247 offset:1024
    buffer_load_dwordx4 v[108:111], v241, s[40:43], s83 offen offset:3072 sc1
    ds_read_b128 v[184:187], v231 offset:7168
    ds_read_b128 v[188:191], v247 offset:8192
    buffer_load_dwordx4 v[112:115], v241, s[40:43], s84 offen offset:0 sc1
    ds_read_b128 v[192:195], v231 offset:14336
    ds_read_b128 v[196:199], v247 offset:15360
    buffer_load_dwordx4 v[116:119], v241, s[40:43], s84 offen offset:1024 sc1
    ds_read_b128 v[200:203], v231 offset:21504
    ds_read_b128 v[204:207], v247 offset:22528
    s_waitcnt lgkmcnt(0)
    v_pk_add_f32 v[176:177], v[176:177], v[184:185]
    v_pk_add_f32 v[178:179], v[178:179], v[186:187]
    v_pk_add_f32 v[180:181], v[180:181], v[188:189]
    v_pk_add_f32 v[182:183], v[182:183], v[190:191]
    v_pk_add_f32 v[192:193], v[192:193], v[200:201]
    v_pk_add_f32 v[194:195], v[194:195], v[202:203]
    v_pk_add_f32 v[196:197], v[196:197], v[204:205]
    v_pk_add_f32 v[198:199], v[198:199], v[206:207]
    v_pk_add_f32 v[176:177], v[176:177], v[192:193]
    v_pk_add_f32 v[178:179], v[178:179], v[194:195]
    v_pk_add_f32 v[180:181], v[180:181], v[196:197]
    v_pk_add_f32 v[182:183], v[182:183], v[198:199]
    v_cvt_pk_bf16_f32 v184, v176, v177
    v_cvt_pk_bf16_f32 v185, v178, v179
    v_cvt_pk_bf16_f32 v186, v180, v181
    v_cvt_pk_bf16_f32 v187, v182, v183
    s_mov_b32 s56, 6815744
    v_permlane16_swap_b32 v184, v186
    v_permlane16_swap_b32 v185, v187
    buffer_store_dwordx4 v[184:187], v252, s[40:43], s56 offen sc1
    buffer_load_dwordx4 v[120:123], v241, s[40:43], s84 offen offset:2048 sc1
    buffer_load_dwordx4 v[124:127], v241, s[40:43], s84 offen offset:3072 sc1
    buffer_load_dwordx4 v[128:131], v241, s[40:43], s85 offen offset:0 sc1
    buffer_load_dwordx4 v[132:135], v241, s[40:43], s85 offen offset:1024 sc1
    s_waitcnt vmcnt(14)
    v_mfma_f32_32x32x16_bf16 v[48:63], a[0:3], v[80:83], 0
    buffer_load_dwordx4 v[136:139], v241, s[40:43], s85 offen offset:2048 sc1
    ds_read_b64_tr_b16 a[138:139], v3 offset:0
    v_mfma_f32_32x32x16_bf16 v[64:79], a[4:7], v[80:83], 0
    ds_read_b64_tr_b16 a[142:143], v4 offset:0
    ds_read_b64_tr_b16 a[144:145], v3 offset:1024
    s_waitcnt vmcnt(14)
    v_mfma_f32_32x32x16_bf16 v[48:63], a[8:11], v[84:87], v[48:63]
    ds_read_b64_tr_b16 a[148:149], v4 offset:1024
    ds_read_b64_tr_b16 a[146:147], v3 offset:2048
    buffer_load_dwordx4 v[140:143], v241, s[40:43], s85 offen offset:3072 sc1
    v_mfma_f32_32x32x16_bf16 v[64:79], a[12:15], v[84:87], v[64:79]
    ds_read_b64_tr_b16 a[150:151], v4 offset:2048
    s_waitcnt vmcnt(14)
    v_mfma_f32_32x32x16_bf16 v[48:63], a[16:19], v[88:91], v[48:63]
    ds_read_b64_tr_b16 a[152:153], v3 offset:3072
    ds_read_b64_tr_b16 a[156:157], v4 offset:3072
    buffer_load_dwordx4 v[144:147], v241, s[40:43], s86 offen offset:0 sc1
    v_mfma_f32_32x32x16_bf16 v[64:79], a[20:23], v[88:91], v[64:79]
    ds_read_b64_tr_b16 a[154:155], v3 offset:4096
    ds_read_b64_tr_b16 a[158:159], v4 offset:4096
    s_waitcnt vmcnt(14)
    v_mfma_f32_32x32x16_bf16 v[48:63], a[24:27], v[92:95], v[48:63]
    ds_read_b64_tr_b16 a[160:161], v3 offset:5120
    ds_read_b64_tr_b16 a[164:165], v4 offset:5120
    buffer_load_dwordx4 v[148:151], v241, s[40:43], s86 offen offset:1024 sc1
    v_mfma_f32_32x32x16_bf16 v[64:79], a[28:31], v[92:95], v[64:79]
    ds_read_b64_tr_b16 a[162:163], v3 offset:6144
    s_waitcnt vmcnt(14)
    v_mfma_f32_32x32x16_bf16 v[48:63], a[32:35], v[96:99], v[48:63]
    buffer_load_dwordx4 v[152:155], v241, s[40:43], s86 offen offset:2048 sc1
    ds_read_b64_tr_b16 a[166:167], v4 offset:6144
    v_mfma_f32_32x32x16_bf16 v[64:79], a[36:39], v[96:99], v[64:79]
    ds_read_b64_tr_b16 a[168:169], v10 offset:28672
    ds_read_b64_tr_b16 a[172:173], v12 offset:28672
    s_waitcnt vmcnt(14)
    v_mfma_f32_32x32x16_bf16 v[48:63], a[40:43], v[100:103], v[48:63]
    ds_read_b64_tr_b16 a[170:171], v10 offset:29696
    ds_read_b64_tr_b16 a[174:175], v12 offset:29696
    buffer_load_dwordx4 v[156:159], v241, s[40:43], s86 offen offset:3072 sc1
    v_mfma_f32_32x32x16_bf16 v[64:79], a[44:47], v[100:103], v[64:79]
    ds_read_b64_tr_b16 a[176:177], v10 offset:30720
    s_waitcnt vmcnt(14)
    v_mfma_f32_32x32x16_bf16 v[48:63], a[48:51], v[104:107], v[48:63]
    ds_read_b64_tr_b16 a[180:181], v12 offset:30720
    ds_read_b64_tr_b16 a[178:179], v10 offset:31744
    buffer_load_dwordx4 v[160:163], v241, s[40:43], s87 offen offset:0 sc1
    v_mfma_f32_32x32x16_bf16 v[64:79], a[52:55], v[104:107], v[64:79]
    ds_read_b64_tr_b16 a[182:183], v12 offset:31744
    ds_read_b64_tr_b16 a[184:185], v10 offset:32768
    s_waitcnt vmcnt(14)
    v_mfma_f32_32x32x16_bf16 v[48:63], a[56:59], v[108:111], v[48:63]
    ds_read_b64_tr_b16 a[188:189], v12 offset:32768
    buffer_load_dwordx4 v[164:167], v241, s[40:43], s87 offen offset:1024 sc1
    v_mfma_f32_32x32x16_bf16 v[64:79], a[60:63], v[108:111], v[64:79]
    ds_read_b64_tr_b16 a[186:187], v10 offset:33792
    ds_read_b64_tr_b16 a[190:191], v12 offset:33792
    s_waitcnt vmcnt(14)
    v_mfma_f32_32x32x16_bf16 v[48:63], a[64:67], v[112:115], v[48:63]
    ds_read_b64_tr_b16 a[192:193], v10 offset:34816
    ds_read_b64_tr_b16 a[196:197], v12 offset:34816
    buffer_load_dwordx4 v[168:171], v241, s[40:43], s87 offen offset:2048 sc1
    v_mfma_f32_32x32x16_bf16 v[64:79], a[68:71], v[112:115], v[64:79]
    ds_read_b64_tr_b16 a[194:195], v3 offset:28672
    s_waitcnt vmcnt(14)
    v_mfma_f32_32x32x16_bf16 v[48:63], a[72:75], v[116:119], v[48:63]
    ds_read_b64_tr_b16 a[198:199], v4 offset:28672
    buffer_load_dwordx4 v[172:175], v241, s[40:43], s87 offen offset:3072 sc1
    v_mfma_f32_32x32x16_bf16 v[64:79], a[76:79], v[116:119], v[64:79]
    ds_read_b64_tr_b16 a[200:201], v3 offset:29696
    ds_read_b64_tr_b16 a[204:205], v4 offset:29696
    s_waitcnt vmcnt(13)
    v_mfma_f32_32x32x16_bf16 v[48:63], a[80:83], v[120:123], v[48:63]
    buffer_load_dwordx4 v[80:83], v241, s[40:43], s88 offen offset:0 sc1
    ds_read_b64_tr_b16 a[202:203], v3 offset:30720
    ds_read_b64_tr_b16 a[206:207], v4 offset:30720
    s_mov_b64 exec, 1
    buffer_store_dword v13, v8, s[40:43], s100 offen offset:16 sc1
    s_mov_b64 exec, -1
    v_mfma_f32_32x32x16_bf16 v[64:79], a[84:87], v[120:123], v[64:79]
    ds_read_b64_tr_b16 a[208:209], v3 offset:31744
    ds_read_b64_tr_b16 a[212:213], v4 offset:31744
    s_waitcnt vmcnt(14)
    v_mfma_f32_32x32x16_bf16 v[48:63], a[88:91], v[124:127], v[48:63]
    ds_read_b64_tr_b16 a[210:211], v3 offset:32768
    buffer_load_dwordx4 v[84:87], v241, s[40:43], s88 offen offset:1024 sc1
    v_mfma_f32_32x32x16_bf16 v[64:79], a[92:95], v[124:127], v[64:79]
    ds_read_b64_tr_b16 a[214:215], v4 offset:32768
    ds_read_b64_tr_b16 a[216:217], v3 offset:33792
    s_waitcnt vmcnt(14)
    v_mfma_f32_32x32x16_bf16 v[48:63], a[96:99], v[128:131], v[48:63]
    ds_read_b64_tr_b16 a[220:221], v4 offset:33792
    ds_read_b64_tr_b16 a[218:219], v3 offset:34816
    buffer_load_dwordx4 v[88:91], v241, s[40:43], s88 offen offset:2048 sc1
    v_mfma_f32_32x32x16_bf16 v[64:79], a[100:103], v[128:131], v[64:79]
    ds_read_b64_tr_b16 a[222:223], v4 offset:34816
    s_waitcnt vmcnt(14)
    v_mfma_f32_32x32x16_bf16 v[48:63], a[104:107], v[132:135], v[48:63]
    buffer_load_dwordx4 v[92:95], v241, s[40:43], s88 offen offset:3072 sc1
    v_mfma_f32_32x32x16_bf16 v[64:79], a[108:111], v[132:135], v[64:79]
    v_lshrrev_b32 v242, 3, v1
    v_and_b32 v243, 2, v242
    v_lshlrev_b32 v243, 1, v243
    v_and_b32 v244, 7, v1
    s_waitcnt vmcnt(14)
    v_mfma_f32_32x32x16_bf16 v[48:63], a[112:115], v[136:139], v[48:63]
    buffer_load_dwordx4 v[96:99], v240, s[40:43], s82 offen offset:0 sc1
    v_xor_b32 v243, v243, v244
    v_mul_u32_u24 v242, 4224, v242
    v_lshl_add_u32 v242, v243, 4, v242
    v_mfma_f32_32x32x16_bf16 v[64:79], a[116:119], v[136:139], v[64:79]
    s_lshl_b32 s56, s50, 6
    s_lshl_b32 s57, s48, 4
    s_add_u32 s56, s57, s56
    s_waitcnt vmcnt(14)
    v_mfma_f32_32x32x16_bf16 v[48:63], a[120:123], v[140:143], v[48:63]
    buffer_load_dwordx4 v[100:103], v240, s[40:43], s82 offen offset:1024 sc1
    s_mul_i32 s57, s56, 4224
    s_lshl_b32 s58, s49, 7
    s_add_u32 s57, s57, s58
    v_mfma_f32_32x32x16_bf16 v[64:79], a[124:127], v[140:143], v[64:79]
    v_add_u32 v242, s57, v242
    v_lshrrev_b32 v243, 2, v1
    v_mul_u32_u24 v229, 896, v243
    s_waitcnt vmcnt(14)
    v_mfma_f32_32x32x16_bf16 v[48:63], a[128:131], v[144:147], v[48:63]
    buffer_load_dwordx4 v[104:107], v240, s[40:43], s82 offen offset:2048 sc1
    v_mul_u32_u24 v231, 80, v243
    v_add_u32 v243, s56, v243
    v_add_u32 v244, 1344, v243
    v_mul_u32_u24 v244, 9363, v244
    v_mfma_f32_32x32x16_bf16 v[64:79], a[132:135], v[144:147], v[64:79]
    v_lshrrev_b32 v244, 16, v244
    v_min_u32 v243, v243, v244
    v_lshlrev_b32 v243, 7, v243
    s_waitcnt vmcnt(14)
    s_waitcnt lgkmcnt(15)
    v_mfma_f32_32x32x16_bf16 v[48:63], a[136:139], v[148:151], v[48:63]
    buffer_load_dwordx4 v[108:111], v240, s[40:43], s82 offen offset:3072 sc1
    v_and_b32 v244, 3, v1
    v_lshl_add_u32 v243, v244, 2, v243
    v_lshl_add_u32 v229, v244, 4, v229
    v_mfma_f32_32x32x16_bf16 v[64:79], a[140:143], v[148:151], v[64:79]
    v_lshl_add_u32 v231, v244, 4, v231
    s_lshl_b32 s59, s48, 11
    s_and_b32 s56, s48, 1
    s_waitcnt vmcnt(14)
    v_mfma_f32_32x32x16_bf16 v[48:63], a[144:147], v[152:155], v[48:63]
    buffer_load_dwordx4 v[112:115], v240, s[40:43], s83 offen offset:0 sc1
    s_lshr_b32 s57, s48, 1
    s_xor_b32 s58, s56, s57
    s_lshl_b32 s58, s58, 6
    v_mfma_f32_32x32x16_bf16 v[64:79], a[148:151], v[152:155], v[64:79]
    v_xor_b32 v228, s58, v3
    s_lshl_b32 s58, s56, 12
    s_add_u32 s58, s58, 149504
    s_sub_u32 s58, s58, s60
    s_waitcnt vmcnt(14)
    v_mfma_f32_32x32x16_bf16 v[48:63], a[152:155], v[156:159], v[48:63]
    buffer_load_dwordx4 v[116:119], v240, s[40:43], s83 offen offset:1024 sc1
    v_add_u32 v228, s58, v228
    s_lshl_b32 s58, s49, 1
    s_add_u32 s57, s57, s58
    v_mfma_f32_32x32x16_bf16 v[64:79], a[156:159], v[156:159], v[64:79]
    s_mul_i32 s57, s57, 28672
    s_lshl_b32 s56, s56, 6
    s_add_u32 s57, s57, s56
    s_waitcnt vmcnt(14)
    v_mfma_f32_32x32x16_bf16 v[48:63], a[160:163], v[160:163], v[48:63]
    buffer_load_dwordx4 v[120:123], v240, s[40:43], s83 offen offset:2048 sc1
    s_lshl_b32 s56, s50, 7
    s_add_u32 s57, s57, s56
    v_add_u32 v229, s57, v229
    v_mfma_f32_32x32x16_bf16 v[64:79], a[164:167], v[160:163], v[64:79]
    s_add_u32 s56, s60, 90112
    v_add_u32 v231, s56, v231
    v_and_b32 v230, 31, v1
    s_waitcnt vmcnt(14)
    s_waitcnt lgkmcnt(14)
    v_mfma_f32_32x32x16_bf16 v[48:63], a[168:171], v[164:167], v[48:63]
    buffer_load_dwordx4 v[124:127], v240, s[40:43], s83 offen offset:3072 sc1
    v_mul_u32_u24 v230, 80, v230
    v_lshrrev_b32 v244, 5, v1
    v_lshl_add_u32 v230, v244, 3, v230
    v_add_u32 v230, s56, v230
    v_mfma_f32_32x32x16_bf16 v[64:79], a[172:175], v[164:167], v[64:79]
    s_xor_b32 s56, s48, 0
    s_mul_i32 s56, s56, 12288
    v_add_u32 v224, s56, v2
    s_waitcnt vmcnt(14)
    v_mfma_f32_32x32x16_bf16 v[48:63], a[176:179], v[168:171], v[48:63]
    buffer_load_dwordx4 v[128:131], v240, s[40:43], s84 offen offset:0 sc1
    s_xor_b32 s56, s48, 1
    s_mul_i32 s56, s56, 12288
    v_add_u32 v225, s56, v2
    v_mfma_f32_32x32x16_bf16 v[64:79], a[180:183], v[168:171], v[64:79]
    s_xor_b32 s56, s48, 2
    s_mul_i32 s56, s56, 12288
    v_add_u32 v226, s56, v2
    s_waitcnt vmcnt(14)
    v_mfma_f32_32x32x16_bf16 v[48:63], a[184:187], v[172:175], v[48:63]
    buffer_load_dwordx4 v[132:135], v240, s[40:43], s84 offen offset:1024 sc1
    s_xor_b32 s56, s48, 3
    s_mul_i32 s56, s56, 12288
    v_add_u32 v227, s56, v2
    v_mfma_f32_32x32x16_bf16 v[64:79], a[188:191], v[172:175], v[64:79]
    v_accvgpr_read_b32 v16, a240
    v_accvgpr_read_b32 v17, a241
    v_accvgpr_read_b32 v18, a242
    v_accvgpr_read_b32 v19, a243
    s_waitcnt vmcnt(14)
    s_waitcnt lgkmcnt(0)
    v_mfma_f32_32x32x16_bf16 v[48:63], a[192:195], v[80:83], v[48:63]
    buffer_load_dwordx4 v[136:139], v240, s[40:43], s84 offen offset:2048 sc1
    v_accvgpr_read_b32 v20, a244
    v_accvgpr_read_b32 v21, a245
    v_accvgpr_read_b32 v22, a246
    v_mfma_f32_32x32x16_bf16 v[64:79], a[196:199], v[80:83], v[64:79]
    v_accvgpr_read_b32 v23, a247
    v_accvgpr_read_b32 v24, a248
    v_accvgpr_read_b32 v25, a249
    s_waitcnt vmcnt(13)
    v_mfma_f32_32x32x16_bf16 v[48:63], a[200:203], v[84:87], v[48:63]
    buffer_load_dwordx4 v[140:143], v240, s[40:43], s84 offen offset:3072 sc1
    v_accvgpr_read_b32 v26, a250
    v_accvgpr_read_b32 v27, a251
    v_accvgpr_read_b32 v28, a252
    v_mfma_f32_32x32x16_bf16 v[64:79], a[204:207], v[84:87], v[64:79]
    v_accvgpr_read_b32 v29, a253
    v_accvgpr_read_b32 v30, a254
    v_accvgpr_read_b32 v31, a255
    s_waitcnt vmcnt(13)
    v_mfma_f32_32x32x16_bf16 v[48:63], a[208:211], v[88:91], v[48:63]
    buffer_load_dwordx4 v[144:147], v240, s[40:43], s85 offen offset:0 sc1
    v_mfma_f32_32x32x16_bf16 v[64:79], a[212:215], v[88:91], v[64:79]
    s_waitcnt vmcnt(13)
    v_mfma_f32_32x32x16_bf16 v[48:63], a[216:219], v[92:95], v[48:63]
    buffer_load_dwordx4 v[148:151], v240, s[40:43], s85 offen offset:1024 sc1
    s_barrier
    v_mfma_f32_32x32x16_bf16 v[64:79], a[220:223], v[92:95], v[64:79]
    s_waitcnt vmcnt(13)
    v_mfma_f32_32x32x16_bf16 v[32:47], a[4:7], v[96:99], 0
    buffer_load_dwordx4 v[152:155], v240, s[40:43], s85 offen offset:2048 sc1
    s_waitcnt vmcnt(13)
    v_mfma_f32_32x32x16_bf16 v[32:47], a[12:15], v[100:103], v[32:47]
    buffer_load_dwordx4 v[156:159], v240, s[40:43], s85 offen offset:3072 sc1
    s_waitcnt vmcnt(13)
    v_mfma_f32_32x32x16_bf16 v[32:47], a[20:23], v[104:107], v[32:47]
    buffer_load_dwordx4 v[160:163], v240, s[40:43], s86 offen offset:0 sc1
    s_waitcnt vmcnt(13)
    v_mfma_f32_32x32x16_bf16 v[32:47], a[28:31], v[108:111], v[32:47]
    ds_write_b128 v226, v[48:51] offset:4096
    buffer_load_dwordx4 v[164:167], v240, s[40:43], s86 offen offset:1024 sc1
    s_waitcnt vmcnt(13)
    v_mfma_f32_32x32x16_bf16 v[32:47], a[36:39], v[112:115], v[32:47]
    buffer_load_dwordx4 v[168:171], v240, s[40:43], s86 offen offset:2048 sc1
    v_mfma_f32_32x32x16_bf16 v[16:31], a[0:3], v[96:99], v[16:31]
    ds_write_b128 v226, v[52:55] offset:5120
    s_waitcnt vmcnt(13)
    v_mfma_f32_32x32x16_bf16 v[32:47], a[44:47], v[116:119], v[32:47]
    buffer_load_dwordx4 v[172:175], v240, s[40:43], s86 offen offset:3072 sc1
    v_mfma_f32_32x32x16_bf16 v[16:31], a[8:11], v[100:103], v[16:31]
    ds_write_b128 v226, v[56:59] offset:6144
    s_waitcnt vmcnt(13)
    v_mfma_f32_32x32x16_bf16 v[32:47], a[52:55], v[120:123], v[32:47]
    buffer_load_dwordx4 v[80:83], v240, s[40:43], s87 offen offset:0 sc1
    v_mfma_f32_32x32x16_bf16 v[16:31], a[16:19], v[104:107], v[16:31]
    ds_write_b128 v226, v[60:63] offset:7168
    s_waitcnt vmcnt(13)
    v_mfma_f32_32x32x16_bf16 v[32:47], a[60:63], v[124:127], v[32:47]
    buffer_load_dwordx4 v[84:87], v240, s[40:43], s87 offen offset:1024 sc1
    buffer_load_dword v244, v243, s[40:43], s100 offen offset:16 sc1
    v_mfma_f32_32x32x16_bf16 v[16:31], a[24:27], v[108:111], v[16:31]
    ds_write_b128 v227, v[64:67] offset:8192
    s_waitcnt vmcnt(14)
    v_mfma_f32_32x32x16_bf16 v[32:47], a[68:71], v[128:131], v[32:47]
    buffer_load_dwordx4 v[88:91], v240, s[40:43], s87 offen offset:2048 sc1
    v_mfma_f32_32x32x16_bf16 v[16:31], a[32:35], v[112:115], v[16:31]
    ds_write_b128 v227, v[68:71] offset:9216
    s_waitcnt vmcnt(14)
    v_mfma_f32_32x32x16_bf16 v[32:47], a[76:79], v[132:135], v[32:47]
    buffer_load_dwordx4 v[92:95], v240, s[40:43], s87 offen offset:3072 sc1
    v_mfma_f32_32x32x16_bf16 v[16:31], a[40:43], v[116:119], v[16:31]
    ds_write_b128 v227, v[72:75] offset:10240
    s_waitcnt vmcnt(14)
    v_mfma_f32_32x32x16_bf16 v[32:47], a[84:87], v[136:139], v[32:47]
    buffer_load_dwordx4 v[96:99], v240, s[40:43], s88 offen offset:0 sc1
    v_mfma_f32_32x32x16_bf16 v[16:31], a[48:51], v[120:123], v[16:31]
    ds_write_b128 v227, v[76:79] offset:11264
    s_waitcnt vmcnt(14)
    v_mfma_f32_32x32x16_bf16 v[32:47], a[92:95], v[140:143], v[32:47]
    buffer_load_dwordx4 v[100:103], v240, s[40:43], s88 offen offset:1024 sc1
    v_mfma_f32_32x32x16_bf16 v[16:31], a[56:59], v[124:127], v[16:31]
    s_waitcnt vmcnt(14)
    v_mfma_f32_32x32x16_bf16 v[32:47], a[100:103], v[144:147], v[32:47]
    buffer_load_dwordx4 v[104:107], v240, s[40:43], s88 offen offset:2048 sc1
    v_mfma_f32_32x32x16_bf16 v[16:31], a[64:67], v[128:131], v[16:31]
    s_waitcnt vmcnt(14)
    v_mfma_f32_32x32x16_bf16 v[32:47], a[108:111], v[148:151], v[32:47]
    buffer_load_dwordx4 v[108:111], v240, s[40:43], s88 offen offset:3072 sc1
    s_waitcnt lgkmcnt(0)
    s_barrier
    v_mfma_f32_32x32x16_bf16 v[16:31], a[72:75], v[132:135], v[16:31]
    ds_read_b128 v[176:179], v224 offset:4096
    s_waitcnt vmcnt(14)
    v_mfma_f32_32x32x16_bf16 v[32:47], a[116:119], v[152:155], v[32:47]
    ds_read_b128 v[180:183], v224 offset:5120
    v_mfma_f32_32x32x16_bf16 v[16:31], a[80:83], v[136:139], v[16:31]
    ds_read_b128 v[184:187], v224 offset:6144
    s_waitcnt vmcnt(13)
    v_mfma_f32_32x32x16_bf16 v[32:47], a[124:127], v[156:159], v[32:47]
    ds_read_b128 v[188:191], v224 offset:7168
    v_mfma_f32_32x32x16_bf16 v[16:31], a[88:91], v[140:143], v[16:31]
    ds_read_b128 v[192:195], v224 offset:8192
    s_waitcnt vmcnt(12)
    v_mfma_f32_32x32x16_bf16 v[32:47], a[132:135], v[160:163], v[32:47]
    ds_read_b128 v[196:199], v224 offset:9216
    v_mfma_f32_32x32x16_bf16 v[16:31], a[96:99], v[144:147], v[16:31]
    ds_read_b128 v[200:203], v224 offset:10240
    s_waitcnt vmcnt(11)
    v_mfma_f32_32x32x16_bf16 v[32:47], a[140:143], v[164:167], v[32:47]
    ds_read_b128 v[204:207], v224 offset:11264
    v_mfma_f32_32x32x16_bf16 v[16:31], a[104:107], v[148:151], v[16:31]
    s_waitcnt vmcnt(10)
    v_mfma_f32_32x32x16_bf16 v[32:47], a[148:151], v[168:171], v[32:47]
    v_mfma_f32_32x32x16_bf16 v[16:31], a[112:115], v[152:155], v[16:31]
    s_waitcnt vmcnt(9)
    v_mfma_f32_32x32x16_bf16 v[32:47], a[156:159], v[172:175], v[32:47]
    s_waitcnt lgkmcnt(0)
    v_add_f32 v208, v176, v192
    v_add_f32 v209, v177, v193
    v_add_f32 v210, v178, v194
    v_mfma_f32_32x32x16_bf16 v[16:31], a[120:123], v[156:159], v[16:31]
    v_add_f32 v211, v179, v195
    v_add_f32 v212, v180, v196
    v_add_f32 v213, v181, v197
    s_waitcnt vmcnt(8)
    v_mfma_f32_32x32x16_bf16 v[32:47], a[164:167], v[80:83], v[32:47]
    s_waitcnt vmcnt(6)
    v_cmp_ne_u32 vcc, s65, v244
    s_cbranch_vccz L_ok70
    s_mov_b32 s55, 0
L_spin71:
    buffer_load_dword v244, v243, s[40:43], s100 offen offset:16 sc1
    s_waitcnt vmcnt(0)
    v_cmp_ne_u32 vcc, s65, v244
    s_cbranch_vccz L_spun72
    s_sleep 6
    s_add_u32 s55, s55, 1
    s_cmp_lt_u32 s55, 1048576
    s_cbranch_scc1 L_spin71
L_spun72:
L_ok70:
    s_add_u32 m0, s59, 149504
    s_mov_b32 s54, 6815744
    buffer_load_dwordx4 v242, s[40:43], s54 offen sc1 lds
    s_mov_b32 s54, 6848512
    buffer_load_dwordx4 v242, s[40:43], s54 offen offset:1024 sc1 lds
    v_add_f32 v214, v182, v198
    v_add_f32 v215, v183, v199
    v_add_f32 v216, v184, v200
    v_mfma_f32_32x32x16_bf16 v[16:31], a[128:131], v[160:163], v[16:31]
    v_add_f32 v217, v185, v201
    v_add_f32 v218, v186, v202
    v_add_f32 v219, v187, v203
    v_add_f32 v220, v188, v204
    v_mfma_f32_32x32x16_bf16 v[32:47], a[172:175], v[84:87], v[32:47]
    v_add_f32 v221, v189, v205
    v_add_f32 v222, v190, v206
    v_add_f32 v223, v191, v207
    v_mfma_f32_32x32x16_bf16 v[16:31], a[136:139], v[164:167], v[16:31]
    v_accvgpr_read_b32 v176, a224
    v_accvgpr_read_b32 v177, a225
    v_accvgpr_read_b32 v178, a226
    s_waitcnt vmcnt(7)
    v_mfma_f32_32x32x16_bf16 v[32:47], a[180:183], v[88:91], v[32:47]
    v_accvgpr_read_b32 v179, a227
    v_accvgpr_read_b32 v180, a228
    v_accvgpr_read_b32 v181, a229
    v_accvgpr_read_b32 v182, a230
    v_mfma_f32_32x32x16_bf16 v[16:31], a[144:147], v[168:171], v[16:31]
    v_accvgpr_read_b32 v183, a231
    v_accvgpr_read_b32 v184, a232
    v_accvgpr_read_b32 v185, a233
    s_waitcnt vmcnt(6)
    v_mfma_f32_32x32x16_bf16 v[32:47], a[188:191], v[92:95], v[32:47]
    v_accvgpr_read_b32 v186, a234
    v_accvgpr_read_b32 v187, a235
    v_accvgpr_read_b32 v188, a236
    v_mfma_f32_32x32x16_bf16 v[16:31], a[152:155], v[172:175], v[16:31]
    v_accvgpr_read_b32 v189, a237
    v_accvgpr_read_b32 v190, a238
    v_accvgpr_read_b32 v191, a239
    s_waitcnt vmcnt(5)
    v_mfma_f32_32x32x16_bf16 v[32:47], a[196:199], v[96:99], v[32:47]
    v_mfma_f32_32x32x16_bf16 v[16:31], a[160:163], v[80:83], v[16:31]
    s_waitcnt vmcnt(4)
    v_mfma_f32_32x32x16_bf16 v[32:47], a[204:207], v[100:103], v[32:47]
    v_mfma_f32_32x32x16_bf16 v[16:31], a[168:171], v[84:87], v[16:31]
    s_waitcnt vmcnt(3)
    v_mfma_f32_32x32x16_bf16 v[32:47], a[212:215], v[104:107], v[32:47]
    v_mfma_f32_32x32x16_bf16 v[16:31], a[176:179], v[88:91], v[16:31]
    s_waitcnt vmcnt(2)
    v_mfma_f32_32x32x16_bf16 v[32:47], a[220:223], v[108:111], v[32:47]
    v_mfma_f32_32x32x16_bf16 v[16:31], a[184:187], v[92:95], v[16:31]
    v_mfma_f32_32x32x16_bf16 v[16:31], a[192:195], v[96:99], v[16:31]
    v_mfma_f32_32x32x16_bf16 v[16:31], a[200:203], v[100:103], v[16:31]
    s_nop 8
    ds_write_b128 v225, v[32:35] offset:0
    ds_write_b128 v225, v[36:39] offset:1024
    v_mfma_f32_32x32x16_bf16 v[16:31], a[208:211], v[104:107], v[16:31]
    ds_write_b128 v225, v[40:43] offset:2048
    v_mfma_f32_32x32x16_bf16 v[16:31], a[216:219], v[108:111], v[16:31]
    ds_write_b128 v225, v[44:47] offset:3072
    s_waitcnt lgkmcnt(0)
    s_waitcnt vmcnt(0)
    s_barrier
    ds_read_b64_tr_b16 v[80:81], v228 offset:0
    ds_read_b64_tr_b16 v[82:83], v228 offset:1024
    ds_read_b64_tr_b16 v[84:85], v228 offset:2048
    ds_read_b64_tr_b16 v[86:87], v228 offset:3072
    ds_read_b128 v[192:195], v224 offset:0
    ds_read_b128 v[196:199], v224 offset:1024
    ds_read_b128 v[200:203], v224 offset:2048
    ds_read_b128 v[204:207], v224 offset:3072
    v_pk_add_f32 v[16:17], v[16:17], v[208:209]
    v_pk_add_f32 v[18:19], v[18:19], v[210:211]
    v_pk_add_f32 v[20:21], v[20:21], v[212:213]
    v_pk_add_f32 v[22:23], v[22:23], v[214:215]
    v_pk_add_f32 v[24:25], v[24:25], v[216:217]
    v_pk_add_f32 v[26:27], v[26:27], v[218:219]
    v_pk_add_f32 v[28:29], v[28:29], v[220:221]
    v_pk_add_f32 v[30:31], v[30:31], v[222:223]
    s_waitcnt lgkmcnt(4)
    v_lshlrev_b32 v96, 16, v80
    v_and_b32 v97, 0xffff0000, v80
    v_lshlrev_b32 v98, 16, v81
    v_and_b32 v99, 0xffff0000, v81
    v_lshlrev_b32 v100, 16, v82
    v_and_b32 v101, 0xffff0000, v82
    v_lshlrev_b32 v102, 16, v83
    v_and_b32 v103, 0xffff0000, v83
    v_lshlrev_b32 v104, 16, v84
    v_and_b32 v105, 0xffff0000, v84
    v_lshlrev_b32 v106, 16, v85
    v_and_b32 v107, 0xffff0000, v85
    v_lshlrev_b32 v108, 16, v86
    v_and_b32 v109, 0xffff0000, v86
    v_lshlrev_b32 v110, 16, v87
    v_and_b32 v111, 0xffff0000, v87
    v_pk_fma_f32 v[16:17], v[176:177], v[96:97], v[16:17]
    v_pk_fma_f32 v[18:19], v[178:179], v[98:99], v[18:19]
    v_pk_fma_f32 v[20:21], v[180:181], v[100:101], v[20:21]
    v_pk_fma_f32 v[22:23], v[182:183], v[102:103], v[22:23]
    v_pk_fma_f32 v[24:25], v[184:185], v[104:105], v[24:25]
    v_pk_fma_f32 v[26:27], v[186:187], v[106:107], v[26:27]
    v_pk_fma_f32 v[28:29], v[188:189], v[108:109], v[28:29]
    v_pk_fma_f32 v[30:31], v[190:191], v[110:111], v[30:31]
    s_waitcnt lgkmcnt(0)
    v_pk_add_f32 v[16:17], v[16:17], v[192:193]
    v_pk_add_f32 v[18:19], v[18:19], v[194:195]
    v_pk_add_f32 v[20:21], v[20:21], v[196:197]
    v_pk_add_f32 v[22:23], v[22:23], v[198:199]
    v_pk_add_f32 v[24:25], v[24:25], v[200:201]
    v_pk_add_f32 v[26:27], v[26:27], v[202:203]
    v_pk_add_f32 v[28:29], v[28:29], v[204:205]
    v_pk_add_f32 v[30:31], v[30:31], v[206:207]
    v_cvt_pk_bf16_f32 v112, v16, v17
    v_cvt_pk_bf16_f32 v113, v18, v19
    v_cvt_pk_bf16_f32 v114, v20, v21
    v_cvt_pk_bf16_f32 v115, v22, v23
    v_cvt_pk_bf16_f32 v116, v24, v25
    v_cvt_pk_bf16_f32 v117, v26, v27
    v_cvt_pk_bf16_f32 v118, v28, v29
    v_cvt_pk_bf16_f32 v119, v30, v31
    ds_write_b64 v230, v[112:113] offset:0
    ds_write_b64 v230, v[114:115] offset:16
    ds_write_b64 v230, v[116:117] offset:32
    ds_write_b64 v230, v[118:119] offset:48
    ds_read_b128 v[120:123], v231 offset:0
    ds_read_b128 v[124:127], v231 offset:1280
    s_mov_b32 s56, 14336
    s_waitcnt lgkmcnt(1)
    buffer_store_dwordx4 v[120:123], v229, s[36:39], 0 offen nt
    s_waitcnt lgkmcnt(0)
    buffer_store_dwordx4 v[124:127], v229, s[36:39], s56 offen nt
    s_endpgm
L_end:
    s_endpgm
.section .rodata,"a"
.p2align 6
.amdhsa_kernel parallel_sum__ssm_conv_h3__mixer_s_mlp__prompt_kernel
  .amdhsa_next_free_vgpr 512
  .amdhsa_next_free_sgpr 102
  .amdhsa_accum_offset 256
  .amdhsa_group_segment_fixed_size 0
  .amdhsa_kernarg_size 112
  .amdhsa_user_sgpr_count 2
  .amdhsa_user_sgpr_kernarg_segment_ptr 1
  .amdhsa_system_sgpr_workgroup_id_x 1
  .amdhsa_float_denorm_mode_32 3
.end_amdhsa_kernel
```
